```python
import torch

def _softmax(x, axis=-1):
    return torch.softmax(x, dim=axis)
def _gelu(x):
    return torch.nn.functional.gelu(x, approximate="tanh")
def _silu(x):
    return torch.nn.functional.silu(x)
def _sigmoid(x):
    return torch.sigmoid(x)
def _layernorm(x, axis=-1, eps=1e-5):
    m = x.mean(dim=axis, keepdim=True)
    v = x.var(dim=axis, keepdim=True, unbiased=False)
    return (x - m) / torch.sqrt(v + eps)
def _scatter_add(tgt, idx, src, axis=0):
    return tgt.clone().index_add_(axis, idx, src)
def _segment_sum(src, seg, n):
    out = torch.zeros((n,) + src.shape[1:], dtype=src.dtype)
    return out.index_add_(0, seg, src)
def _pad(x, pw):
    flat = tuple(v for pair in reversed(pw) for v in pair)
    return torch.nn.functional.pad(x, flat)

kernel_name = 'recurrent_scan__ssm_conv_s5__glu_gated_geglu__prompt'

def setup_inputs():

    _w = (lambda a: (lambda t: t.to(torch.bfloat16) if t.is_floating_point() else t)(torch.as_tensor(a)))
    def _A_setup():
        B, S, D = 1, 2048, 1024
        P = D
        Lambda_re = -0.5 * (lambda _x: torch.exp(torch.as_tensor(_x)))((lambda *s: torch.randn(*s, dtype=torch.bfloat16) * 0.8)(P))
        Lambda_im = (lambda *s: torch.randn(*s, dtype=torch.bfloat16) * 0.8)(P) * 1.0
        B_re = (lambda *s: torch.randn(*s, dtype=torch.bfloat16) * 1.6)(P, D) * (D ** -0.5)
        B_im = (lambda *s: torch.randn(*s, dtype=torch.bfloat16) * 1.6)(P, D) * (D ** -0.5)
        C_re = (lambda *s: torch.randn(*s, dtype=torch.bfloat16) * 1.6)(D, P) * (P ** -0.5)
        C_im = (lambda *s: torch.randn(*s, dtype=torch.bfloat16) * 1.6)(D, P) * (P ** -0.5)
        log_dt = (lambda *s: torch.randn(*s, dtype=torch.bfloat16) * 0.8)(P) * 0.3 - 2.0
        Dskip = (lambda *s: torch.randn(*s, dtype=torch.bfloat16) * 0.8)(D)
        return {
            "x": _w((lambda *s: torch.randn(*s, dtype=torch.bfloat16) * 0.05)(B, S, D)),
            "Lambda_re": _w(Lambda_re),
            "Lambda_im": _w(Lambda_im),
            "B_re": _w(B_re),
            "B_im": _w(B_im),
            "C_re": _w(C_re),
            "C_im": _w(C_im),
            "log_dt": _w(log_dt),
            "Dskip": _w(Dskip),
        }
    _A_in = _A_setup()

    def _B_setup():
        B, S, Dm, Df = 1, 2048, 1024, 3584
        return {
            "x": _w((lambda *s: torch.randn(*s, dtype=torch.bfloat16) * 0.05)(B, S, Dm)),
            "w_gate": _w((lambda *s: torch.randn(*s, dtype=torch.bfloat16) * 0.2)(Dm, Df) * (Dm ** -0.5)),
            "w_up": _w((lambda *s: torch.randn(*s, dtype=torch.bfloat16) * 0.2)(Dm, Df) * (Dm ** -0.5)),
            "w_down": _w((lambda *s: torch.randn(*s, dtype=torch.bfloat16) * 0.2)(Df, Dm) * (Df ** -0.5)),
        }
    _B_in = _B_setup()

    return {
        "A_x": _A_in["x"],
        "A_Lambda_re": _A_in["Lambda_re"],
        "A_Lambda_im": _A_in["Lambda_im"],
        "A_B_re": _A_in["B_re"],
        "A_B_im": _A_in["B_im"],
        "A_C_re": _A_in["C_re"],
        "A_C_im": _A_in["C_im"],
        "A_log_dt": _A_in["log_dt"],
        "A_Dskip": _A_in["Dskip"],
        "B_x": _B_in["x"],
        "B_w_gate": _B_in["w_gate"],
        "B_w_up": _B_in["w_up"],
        "B_w_down": _B_in["w_down"],
    }

def reference(A_x, A_Lambda_re, A_Lambda_im, A_B_re, A_B_im, A_C_re, A_C_im, A_log_dt, A_Dskip, B_x, B_w_gate, B_w_up, B_w_down):
    def _A_ref(x, Lambda_re, Lambda_im, B_re, B_im, C_re, C_im, log_dt, Dskip):
        Bsz, L, H = x.shape
        Lam = Lambda_re + 1j * Lambda_im
        Bmat = B_re + 1j * B_im
        Cmat = C_re + 1j * C_im
        dt = torch.exp(log_dt)
        Lam_bar = torch.exp(dt * Lam)
        B_bar = ((Lam_bar - 1.0) / Lam)[:, None] * Bmat
        Bu = torch.einsum("bld,pd->blp", x + 0j, B_bar)
        h = torch.zeros_like(Bu[:, 0, :])
        hs = []
        for t in range(L):
            h = Lam_bar[None, :] * h + Bu[:, t, :]
            hs.append(h)
        hseq = torch.stack(hs, 1)
        y = 2.0 * torch.einsum("blp,dp->bld", hseq, Cmat).real + x * Dskip[None, None, :]
        return y

    def _B_ref(x, w_gate, w_up, w_down):
        g = torch.einsum("bsd,df->bsf", x, w_gate)
        u = torch.einsum("bsd,df->bsf", x, w_up)
        h = _gelu(g) * u
        return torch.einsum("bsf,fd->bsd", h, w_down)

    x = A_x
    xn = _layernorm(x, axis=-1)
    s = _A_ref(xn, A_Lambda_re, A_Lambda_im, A_B_re, A_B_im, A_C_re, A_C_im, A_log_dt, A_Dskip)
    g = _silu(_B_ref(xn, B_w_gate, B_w_up, B_w_down))
    return x + s * g
```

```asm
; @launch kernel=recurrent_scan__ssm_conv_s5__glu_gated_geglu__prompt_kernel grid=(256,1,1) block=(512,1,1) lds=163840
.amdgcn_target "amdgcn-amd-amdhsa--gfx950"
.text
.globl recurrent_scan__ssm_conv_s5__glu_gated_geglu__prompt_kernel
.p2align 8
.type recurrent_scan__ssm_conv_s5__glu_gated_geglu__prompt_kernel,@function
recurrent_scan__ssm_conv_s5__glu_gated_geglu__prompt_kernel:
    s_cmp_ge_u32 s2, 256
    s_cbranch_scc1 L3_end
    s_load_dwordx16 s[32:47], s[0:1], 0
    s_load_dwordx16 s[48:63], s[0:1], 64
    v_and_b32 v1, 63, v0
    v_lshrrev_b32 v10, 6, v0
    s_nop 0
    v_readfirstlane_b32 s25, v10
    s_nop 3
    s_and_b32 s3, s25, 3
    s_cbranch_scc1 L2_p0
    s_getpc_b64 s[16:17]
L2_pc0:
    s_cmp_eq_u32 s25, 0
    s_cselect_b32 s3, 0, L2_kind1-L2_pc0
    s_add_u32 s16, s16, s3
    s_addc_u32 s17, s17, 0
    v_lshlrev_b32 v10, 7, v1
    global_load_dword v91, v10, s[16:17]
L2_p0:
    s_lshr_b32 s7, s2, 5
    s_mov_b32 s30, -1
    s_mov_b32 s31, 0xffff
    v_lshrrev_b32 v103, 3, v1
    s_and_b32 s3, s2, 1
    s_lshl_b32 s3, s3, 3
    v_add_u32 v103, s3, v103
    v_and_b32 v104, 7, v1
    s_bfe_u32 s4, s2, 0x20001
    s_bfe_u32 s5, s2, 0x20003
    s_lshl_b32 s3, s7, 8
    s_lshl_b32 s29, s5, 6
    s_add_u32 s3, s3, s29
    s_lshl_b32 s29, s4, 2
    s_add_u32 s3, s3, s29
    v_lshrrev_b32 v100, 2, v103
    v_lshlrev_b32 v100, 4, v100
    v_and_b32 v101, 3, v103
    v_add3_u32 v100, v100, v101, s3
    s_lshl_b32 s3, s25, 8
    v_lshlrev_b32 v101, 11, v100
    v_lshl_add_u32 v101, v104, 4, v101
    v_add_u32 v101, s3, v101
    s_lshl_b32 s20, s7, 14
    s_lshl_b32 s5, s5, 12
    s_add_u32 s20, s20, s5
    s_lshl_b32 s4, s4, 10
    s_add_u32 s20, s20, s4
    s_lshl_b32 s4, s25, 19
    s_add_u32 s20, s20, s4
    s_and_b32 s26, s25, 3
    s_waitcnt lgkmcnt(0)
    s_mov_b32 s80, s32
    s_and_b32 s81, s33, 0xffff
    s_mov_b32 s82, 4194304
    s_mov_b32 s83, 0x20000
    s_mov_b32 s96, s60
    s_and_b32 s97, s61, 0xffff
    s_mov_b32 s98, 256
    s_mov_b32 s99, 0x20000
    s_mov_b32 s8, s62
    s_and_b32 s9, s63, 0xffff
    s_mov_b32 s10, 67108864
    s_mov_b32 s11, 0x20000
    buffer_load_dwordx4 v[108:111], v101, s[80:83], 0 offen
    buffer_load_dwordx4 v[112:115], v101, s[80:83], 0 offen offset:128
    v_lshrrev_b32 v102, 2, v104
    v_lshlrev_b32 v102, 17, v102
    v_and_b32 v105, 3, v104
    v_lshl_add_u32 v102, v105, 8, v102
    v_lshl_add_u32 v102, v103, 4, v102
    v_add_u32 v102, s20, v102
    v_lshrrev_b32 v106, 3, v1
    v_lshlrev_b32 v106, 6, v106
    v_add_u32 v106, 140288, v106
    s_lshl_b32 s3, s25, 3
    v_add_u32 v107, s3, v106
    s_lshl_b32 s3, s26, 12
    v_lshlrev_b32 v4, 4, v1
    v_add_u32 v4, s3, v4
    v_add_u32 v5, 69632, v4
    v_lshrrev_b32 v10, 4, v1
    v_bfe_u32 v11, v1, 2, 2
    v_and_b32 v12, 3, v1
    v_and_b32 v13, 1, v10
    v_lshl_or_b32 v13, v13, 2, v11
    v_lshrrev_b32 v14, 1, v10
    v_lshl_or_b32 v13, v14, 4, v13
    v_mul_u32_u24 v13, 224, v13
    v_lshl_add_u32 v13, v12, 3, v13
    v_add_u32 v6, 16384, v13
    v_add_u32 v7, 69632, v6
    v_and_b32 v13, 15, v1
    v_lshrrev_b32 v14, 2, v13
    v_sub_u32 v14, 0, v14
    v_and_b32 v14, 3, v14
    v_xor_b32 v14, v14, v10
    v_lshlrev_b32 v13, 6, v13
    v_lshl_add_u32 v13, v14, 4, v13
    v_add_u32 v8, 30720, v13
    v_add_u32 v9, 69632, v8
    v_and_b32 v13, 15, v1
    v_and_b32 v14, 7, v1
    v_xor_b32 v14, v14, v10
    v_lshlrev_b32 v13, 7, v13
    v_lshl_add_u32 v13, v14, 4, v13
    v_add_u32 v8, 30720, v13
    v_add_u32 v9, 69632, v8
    v_xor_b32 v88, 64, v8
    v_add_u32 v89, 69632, v88
    v_min_u32 v94, 27, v1
    v_lshlrev_b32 v94, 7, v94
    v_and_b32 v95, 15, v1
    v_lshlrev_b32 v95, 7, v95
    s_cmp_ge_u32 s25, 4
    s_cbranch_scc1 L2_kind1
    s_cmp_eq_u32 s26, 1
    s_cselect_b32 s4, s54, s52
    s_cselect_b32 s5, s55, s53
    s_cmp_eq_u32 s26, 2
    s_cselect_b32 s4, s38, s4
    s_cselect_b32 s5, s39, s5
    s_cmp_eq_u32 s26, 3
    s_cselect_b32 s4, s40, s4
    s_cselect_b32 s5, s41, s5
    s_mov_b32 s84, s4
    s_and_b32 s85, s5, 0xffff
    s_mov_b32 s86, 7340032
    s_mov_b32 s87, 0x20000
    s_mov_b32 s95, 917504
    s_cmp_ge_u32 s26, 2
    s_cselect_b32 s86, 2097152, s86
    s_cselect_b32 s95, 256, s95
    v_min_u32 v10, 27, v1
    v_mul_u32_u24 v11, 9363, v10
    v_lshrrev_b32 v11, 16, v11
    v_mul_u32_u24 v12, 7, v11
    v_sub_u32 v12, v10, v12
    v_mul_u32_u24 v11, 7168, v11
    v_lshl_add_u32 v90, v12, 7, v11
    s_cmp_ge_u32 s26, 2
    s_cbranch_scc0 L2_pf3a
    v_and_b32 v10, 1, v1
    v_bfe_u32 v11, v1, 1, 2
    v_lshlrev_b32 v11, 11, v11
    v_lshl_add_u32 v90, v10, 7, v11
L2_pf3a:
    s_and_b32 s4, s2, 7
    s_lshr_b32 s5, s2, 3
    s_mul_i32 s94, s4, 896
    s_mul_i32 s3, s5, 28672
    s_add_u32 s94, s94, s3
    s_lshl_b32 s4, s4, 18
    s_lshl_b32 s5, s5, 13
    s_add_u32 s4, s4, s5
    s_cmp_ge_u32 s26, 2
    s_cselect_b32 s94, s4, s94
    s_mov_b32 s12, s52
    s_and_b32 s13, s53, 0xffff
    s_mov_b32 s14, 7340032
    s_mov_b32 s15, 0x20000
    s_mov_b32 s16, s54
    s_and_b32 s17, s55, 0xffff
    s_mov_b32 s18, 7340032
    s_mov_b32 s19, 0x20000
    s_mov_b32 s3, 4682
    s_and_b32 s4, s26, 1
    s_lshl_b32 s4, s4, 2
    s_lshr_b32 s5, s26, 1
    s_lshl_b32 s5, s5, 4
    s_or_b32 s4, s4, s5
    v_add_u32 v10, 0, v1
    v_mul_u32_u24 v11, s3, v10
    v_lshrrev_b32 v11, 16, v11
    v_mul_u32_u24 v12, 14, v11
    v_sub_u32 v12, v10, v12
    v_and_b32 v13, 3, v11
    v_lshrrev_b32 v11, 2, v11
    v_lshl_or_b32 v13, v11, 3, v13
    v_or_b32 v13, s4, v13
    v_mul_u32_u24 v13, 7168, v13
    v_lshl_add_u32 v2, v12, 4, v13
    v_add_u32 v10, 64, v1
    v_mul_u32_u24 v11, s3, v10
    v_lshrrev_b32 v11, 16, v11
    v_mul_u32_u24 v12, 14, v11
    v_sub_u32 v12, v10, v12
    v_and_b32 v13, 3, v11
    v_lshrrev_b32 v11, 2, v11
    v_lshl_or_b32 v13, v11, 3, v13
    v_or_b32 v13, s4, v13
    v_mul_u32_u24 v13, 7168, v13
    v_lshl_add_u32 v3, v12, 4, v13
    v_subrev_u32 v3, 1024, v3
    s_mul_i32 s22, s26, 1792
    s_waitcnt vmcnt(0)
    buffer_load_dword v91, v90, s[84:87], s94 offen
    s_add_u32 s94, s94, s95
    v_lshlrev_b32 v116, 16, v108
    v_and_b32 v117, 0xffff0000, v108
    v_lshlrev_b32 v118, 16, v109
    v_and_b32 v119, 0xffff0000, v109
    v_lshlrev_b32 v120, 16, v110
    v_and_b32 v121, 0xffff0000, v110
    v_lshlrev_b32 v122, 16, v111
    v_and_b32 v123, 0xffff0000, v111
    v_lshlrev_b32 v124, 16, v112
    v_and_b32 v125, 0xffff0000, v112
    v_lshlrev_b32 v126, 16, v113
    v_and_b32 v127, 0xffff0000, v113
    v_lshlrev_b32 v128, 16, v114
    v_and_b32 v129, 0xffff0000, v114
    v_lshlrev_b32 v130, 16, v115
    v_and_b32 v131, 0xffff0000, v115
    v_pk_add_f32 v[132:133], v[116:117], v[118:119]
    v_pk_add_f32 v[134:135], v[120:121], v[122:123]
    v_pk_add_f32 v[132:133], v[132:133], v[124:125]
    v_pk_add_f32 v[134:135], v[134:135], v[126:127]
    v_pk_add_f32 v[132:133], v[132:133], v[128:129]
    v_pk_add_f32 v[134:135], v[134:135], v[130:131]
    v_pk_add_f32 v[132:133], v[132:133], v[134:135]
    v_add_f32 v132, v132, v133
    s_nop 1
    v_add_f32_dpp v132, v132, v132 quad_perm:[1,0,3,2] row_mask:0xf bank_mask:0xf
    s_nop 1
    v_add_f32_dpp v132, v132, v132 quad_perm:[2,3,0,1] row_mask:0xf bank_mask:0xf
    s_nop 1
    v_add_f32_dpp v132, v132, v132 row_half_mirror row_mask:0xf bank_mask:0xf
    v_mul_f32 v136, 0x3c000000, v132
    v_pk_add_f32 v[140:141], v[116:117], v[136:137] op_sel_hi:[1,0] neg_lo:[0,1] neg_hi:[0,1]
    v_pk_add_f32 v[142:143], v[118:119], v[136:137] op_sel_hi:[1,0] neg_lo:[0,1] neg_hi:[0,1]
    v_pk_add_f32 v[144:145], v[120:121], v[136:137] op_sel_hi:[1,0] neg_lo:[0,1] neg_hi:[0,1]
    v_pk_add_f32 v[146:147], v[122:123], v[136:137] op_sel_hi:[1,0] neg_lo:[0,1] neg_hi:[0,1]
    v_pk_add_f32 v[148:149], v[124:125], v[136:137] op_sel_hi:[1,0] neg_lo:[0,1] neg_hi:[0,1]
    v_pk_add_f32 v[150:151], v[126:127], v[136:137] op_sel_hi:[1,0] neg_lo:[0,1] neg_hi:[0,1]
    v_pk_add_f32 v[152:153], v[128:129], v[136:137] op_sel_hi:[1,0] neg_lo:[0,1] neg_hi:[0,1]
    v_pk_add_f32 v[154:155], v[130:131], v[136:137] op_sel_hi:[1,0] neg_lo:[0,1] neg_hi:[0,1]
    v_pk_mul_f32 v[132:133], v[140:141], v[140:141]
    v_pk_mul_f32 v[134:135], v[142:143], v[142:143]
    v_pk_fma_f32 v[132:133], v[144:145], v[144:145], v[132:133]
    v_pk_fma_f32 v[134:135], v[146:147], v[146:147], v[134:135]
    v_pk_fma_f32 v[132:133], v[148:149], v[148:149], v[132:133]
    v_pk_fma_f32 v[134:135], v[150:151], v[150:151], v[134:135]
    v_pk_fma_f32 v[132:133], v[152:153], v[152:153], v[132:133]
    v_pk_fma_f32 v[134:135], v[154:155], v[154:155], v[134:135]
    v_pk_add_f32 v[132:133], v[132:133], v[134:135]
    v_add_f32 v137, v132, v133
    s_nop 1
    v_add_f32_dpp v137, v137, v137 quad_perm:[1,0,3,2] row_mask:0xf bank_mask:0xf
    s_nop 1
    v_add_f32_dpp v137, v137, v137 quad_perm:[2,3,0,1] row_mask:0xf bank_mask:0xf
    s_nop 1
    v_add_f32_dpp v137, v137, v137 row_half_mirror row_mask:0xf bank_mask:0xf
    ds_write_b64 v107, v[136:137]
    s_waitcnt lgkmcnt(0)
    s_barrier
    ds_read_b128 v[140:143], v106 offset:0
    ds_read_b128 v[144:147], v106 offset:16
    ds_read_b128 v[148:151], v106 offset:32
    ds_read_b128 v[152:155], v106 offset:48
    s_waitcnt lgkmcnt(0)
    v_pk_add_f32 v[132:133], v[140:141], v[142:143]
    v_pk_add_f32 v[134:135], v[144:145], v[146:147]
    v_pk_add_f32 v[132:133], v[132:133], v[148:149]
    v_pk_add_f32 v[134:135], v[134:135], v[150:151]
    v_pk_add_f32 v[132:133], v[132:133], v[152:153]
    v_pk_add_f32 v[134:135], v[134:135], v[154:155]
    v_pk_add_f32 v[132:133], v[132:133], v[134:135]
    v_mul_f32 v132, 0x3e000000, v132
    v_mul_f32 v133, 0x3a800000, v133
    v_sub_f32 v140, v140, v132
    v_sub_f32 v142, v142, v132
    v_sub_f32 v144, v144, v132
    v_sub_f32 v146, v146, v132
    v_sub_f32 v148, v148, v132
    v_sub_f32 v150, v150, v132
    v_sub_f32 v152, v152, v132
    v_sub_f32 v154, v154, v132
    v_mul_f32 v134, v140, v140
    v_mul_f32 v135, v142, v142
    v_fmac_f32 v134, v144, v144
    v_fmac_f32 v135, v146, v146
    v_fmac_f32 v134, v148, v148
    v_fmac_f32 v135, v150, v150
    v_fmac_f32 v134, v152, v152
    v_fmac_f32 v135, v154, v154
    v_add_f32 v134, v134, v135
    v_fmac_f32 v133, 0x3e000000, v134
    v_cvt_pk_bf16_f32 v134, v132, v133
    v_lshlrev_b32 v132, 16, v134
    v_and_b32 v133, 0xffff0000, v134
    v_add_f32 v133, 0x3727c5ac, v133
    v_cvt_pk_bf16_f32 v133, v133, v133
    v_and_b32 v133, 0xffff0000, v133
    v_sqrt_f32 v133, v133
    s_nop 0
    v_pk_add_f32 v[116:117], v[116:117], v[132:133] op_sel_hi:[1,0] neg_lo:[0,1] neg_hi:[0,1]
    v_pk_add_f32 v[118:119], v[118:119], v[132:133] op_sel_hi:[1,0] neg_lo:[0,1] neg_hi:[0,1]
    v_pk_add_f32 v[120:121], v[120:121], v[132:133] op_sel_hi:[1,0] neg_lo:[0,1] neg_hi:[0,1]
    v_pk_add_f32 v[122:123], v[122:123], v[132:133] op_sel_hi:[1,0] neg_lo:[0,1] neg_hi:[0,1]
    v_pk_add_f32 v[124:125], v[124:125], v[132:133] op_sel_hi:[1,0] neg_lo:[0,1] neg_hi:[0,1]
    v_pk_add_f32 v[126:127], v[126:127], v[132:133] op_sel_hi:[1,0] neg_lo:[0,1] neg_hi:[0,1]
    v_pk_add_f32 v[128:129], v[128:129], v[132:133] op_sel_hi:[1,0] neg_lo:[0,1] neg_hi:[0,1]
    v_pk_add_f32 v[130:131], v[130:131], v[132:133] op_sel_hi:[1,0] neg_lo:[0,1] neg_hi:[0,1]
    v_cvt_pk_bf16_f32 v133, v133, v133
    v_and_b32 v133, 0xffff0000, v133
    v_rcp_f32 v133, v133
    v_cvt_pk_bf16_f32 v156, v116, v117
    v_cvt_pk_bf16_f32 v157, v118, v119
    v_cvt_pk_bf16_f32 v158, v120, v121
    v_cvt_pk_bf16_f32 v159, v122, v123
    v_cvt_pk_bf16_f32 v160, v124, v125
    v_cvt_pk_bf16_f32 v161, v126, v127
    v_cvt_pk_bf16_f32 v162, v128, v129
    v_cvt_pk_bf16_f32 v163, v130, v131
    v_lshlrev_b32 v116, 16, v156
    v_and_b32 v117, 0xffff0000, v156
    v_lshlrev_b32 v118, 16, v157
    v_and_b32 v119, 0xffff0000, v157
    v_lshlrev_b32 v120, 16, v158
    v_and_b32 v121, 0xffff0000, v158
    v_lshlrev_b32 v122, 16, v159
    v_and_b32 v123, 0xffff0000, v159
    v_lshlrev_b32 v124, 16, v160
    v_and_b32 v125, 0xffff0000, v160
    v_lshlrev_b32 v126, 16, v161
    v_and_b32 v127, 0xffff0000, v161
    v_lshlrev_b32 v128, 16, v162
    v_and_b32 v129, 0xffff0000, v162
    v_lshlrev_b32 v130, 16, v163
    v_and_b32 v131, 0xffff0000, v163
    v_pk_mul_f32 v[116:117], v[116:117], v[132:133] op_sel:[0,1]
    v_pk_mul_f32 v[118:119], v[118:119], v[132:133] op_sel:[0,1]
    v_pk_mul_f32 v[120:121], v[120:121], v[132:133] op_sel:[0,1]
    v_pk_mul_f32 v[122:123], v[122:123], v[132:133] op_sel:[0,1]
    v_pk_mul_f32 v[124:125], v[124:125], v[132:133] op_sel:[0,1]
    v_pk_mul_f32 v[126:127], v[126:127], v[132:133] op_sel:[0,1]
    v_pk_mul_f32 v[128:129], v[128:129], v[132:133] op_sel:[0,1]
    v_pk_mul_f32 v[130:131], v[130:131], v[132:133] op_sel:[0,1]
    v_cvt_pk_bf16_f32 v156, v116, v117
    v_cvt_pk_bf16_f32 v157, v118, v119
    v_cvt_pk_bf16_f32 v158, v120, v121
    v_cvt_pk_bf16_f32 v159, v122, v123
    v_cvt_pk_bf16_f32 v160, v124, v125
    v_cvt_pk_bf16_f32 v161, v126, v127
    v_cvt_pk_bf16_f32 v162, v128, v129
    v_cvt_pk_bf16_f32 v163, v130, v131
    s_mov_b32 s3, 0
    s_mov_b32 s4, 262144
    buffer_store_dwordx4 v[156:159], v102, s[8:11], s3 offen sc1
    buffer_store_dwordx4 v[160:163], v102, s[8:11], s4 offen sc1
    s_cmp_lg_u32 s26, 3
    s_cbranch_scc1 L2_lni2
    s_lshl_b32 s3, s2, 7
    s_add_u32 s3, s3, 4456448
    v_mov_b32 v107, 0
    s_mov_b64 exec, 1
    buffer_store_dword v107, off, s[8:11], s3 sc1
    s_mov_b64 exec, -1
L2_lni2:
    s_cmp_lg_u32 s26, 2
    s_cbranch_scc1 L2_lni3
    v_lshlrev_b32 v100, 3, v100
    s_mov_b32 s3, 4194304
    s_mov_b32 exec_lo, 0x01010101
    s_mov_b32 exec_hi, 0x01010101
    buffer_store_dwordx2 v[132:133], v100, s[8:11], s3 offen sc1
    s_mov_b64 exec, -1
L2_lni3:
    s_mov_b32 s68, s42
    s_and_b32 s69, s43, 0xffff
    s_mov_b32 s70, 2097152
    s_mov_b32 s71, 0x20000
    s_mov_b32 s72, s56
    s_and_b32 s73, s57, 0xffff
    s_mov_b32 s74, 7340032
    s_mov_b32 s75, 0x20000
    s_lshl_b32 s3, s2, 3
    s_add_u32 s3, s3, s25
    s_mul_i32 s76, s3, 3584
    s_lshl_b32 s3, s2, 2
    s_add_u32 s3, s3, s26
    s_lshl_b32 s77, s3, 11
    s_sub_u32 s78, 6, s26
    s_lshr_b32 s78, s26, 1
    s_add_u32 s78, s78, 1
    s_waitcnt vmcnt(0) lgkmcnt(0)
    s_barrier
    s_cmp_lg_u32 s26, 0
    s_cbranch_scc1 L2_nosig
    s_lshl_b32 s29, s7, 5
    v_mov_b32 v10, 1
    s_mov_b64 exec, 1
    buffer_atomic_add v10, off, s[96:99], s29 sc1
    s_mov_b64 exec, -1
L2_nosig:
    v_mov_b32 v21, 140800
    ds_read_b32 v20, v21
    s_waitcnt lgkmcnt(0)
    v_readfirstlane_b32 s6, v20
    s_nop 3
    s_and_b32 s6, s6, 255
    s_and_b32 s27, s6, 7
    s_lshl_b32 s27, s27, 2
    s_bfe_u32 s3, s6, 0x20003
    s_add_u32 s27, s27, s3
    s_lshr_b32 s28, s6, 5
    s_mul_i32 s20, s27, 224
    s_add_u32 m0, s22, 16384
    s_nop 0
    buffer_load_dwordx4 v2, s[12:15], s20 offen lds
    s_mov_b64 exec, s[30:31]
    buffer_load_dwordx4 v3, s[12:15], s20 offen offset:1024 lds
    s_mov_b64 exec, -1
    s_add_u32 m0, s22, 23552
    s_nop 0
    buffer_load_dwordx4 v2, s[16:19], s20 offen lds
    s_mov_b64 exec, s[30:31]
    buffer_load_dwordx4 v3, s[16:19], s20 offen offset:1024 lds
    s_mov_b64 exec, -1
    s_add_u32 s20, s20, 229376
    s_add_u32 m0, s22, 51200
    s_nop 0
    buffer_load_dwordx4 v2, s[12:15], s20 offen lds
    s_mov_b64 exec, s[30:31]
    buffer_load_dwordx4 v3, s[12:15], s20 offen offset:1024 lds
    s_mov_b64 exec, -1
    s_add_u32 m0, s22, 58368
    s_nop 0
    buffer_load_dwordx4 v2, s[16:19], s20 offen lds
    s_mov_b64 exec, s[30:31]
    buffer_load_dwordx4 v3, s[16:19], s20 offen offset:1024 lds
    s_mov_b64 exec, -1
    s_add_u32 s20, s20, 229376
    s_add_u32 m0, s22, 86016
    s_nop 0
    buffer_load_dwordx4 v2, s[12:15], s20 offen lds
    s_mov_b64 exec, s[30:31]
    buffer_load_dwordx4 v3, s[12:15], s20 offen offset:1024 lds
    s_mov_b64 exec, -1
    s_add_u32 m0, s22, 93184
    s_nop 0
    buffer_load_dwordx4 v2, s[16:19], s20 offen lds
    s_mov_b64 exec, s[30:31]
    buffer_load_dwordx4 v3, s[16:19], s20 offen offset:1024 lds
    s_mov_b64 exec, -1
    s_add_u32 s20, s20, 229376
    s_add_u32 m0, s22, 120832
    s_nop 0
    buffer_load_dwordx4 v2, s[12:15], s20 offen lds
    s_mov_b64 exec, s[30:31]
    buffer_load_dwordx4 v3, s[12:15], s20 offen offset:1024 lds
    s_mov_b64 exec, -1
    s_add_u32 m0, s22, 128000
    s_nop 0
    buffer_load_dwordx4 v2, s[16:19], s20 offen lds
    s_mov_b64 exec, s[30:31]
    buffer_load_dwordx4 v3, s[16:19], s20 offen offset:1024 lds
    s_mov_b64 exec, -1
    s_add_u32 s20, s20, 229376
    s_lshl_b32 s67, s27, 11
    s_add_u32 s67, s67, 4259840
    s_lshl_b32 s65, s28, 1
    s_lshr_b32 s3, s26, 1
    s_add_u32 s65, s65, s3
    s_lshl_b32 s65, s65, 14
    s_and_b32 s3, s26, 1
    s_lshl_b32 s3, s3, 11
    s_add_u32 s65, s65, s3
    s_add_u32 s65, s65, 8388608
    s_mul_i32 s64, s27, 7
    s_add_u32 s64, s64, 128
    s_and_b32 s4, s6, 7
    s_lshr_b32 s5, s6, 3
    s_mul_i32 s94, s4, 896
    s_mul_i32 s3, s5, 28672
    s_add_u32 s94, s94, s3
    s_lshl_b32 s4, s4, 18
    s_lshl_b32 s5, s5, 13
    s_add_u32 s4, s4, s5
    s_cmp_ge_u32 s26, 2
    s_cselect_b32 s94, s4, s94
    s_mul_i32 s3, s95, 1
    s_add_u32 s94, s94, s3
    s_cmp_lg_u32 s26, 0
    s_cbranch_scc1 L2_xgot
    s_lshl_b32 s29, s28, 5
    s_mov_b32 s5, 0
L2_xpoll:
    s_sleep 16
    buffer_load_dword v10, off, s[96:99], s29 sc1
    s_waitcnt vmcnt(0)
    v_readfirstlane_b32 s3, v10
    s_nop 3
    s_cmp_ge_u32 s3, 32
    s_cbranch_scc1 L2_xgot
    s_add_u32 s5, s5, 1
    s_cmp_lt_u32 s5, 0x10000
    s_cbranch_scc1 L2_xpoll
L2_xgot:
    s_barrier
    s_waitcnt vmcnt(12)
    s_barrier
    buffer_load_dword v91, v90, s[84:87], s94 offen
    s_add_u32 s94, s94, s95
    buffer_load_dword v91, v90, s[84:87], s94 offen
    s_add_u32 s94, s94, s95
    ds_read_b128 v[16:19], v4 offset:0
    ds_read_b128 v[20:23], v4 offset:1024
    ds_read_b128 v[24:27], v4 offset:2048
    ds_read_b128 v[28:31], v4 offset:3072
    ds_read_b64_tr_b16 v[48:49], v6 offset:0
    ds_read_b64_tr_b16 v[50:51], v6 offset:1792
    ds_read_b64_tr_b16 v[52:53], v6 offset:7168
    ds_read_b64_tr_b16 v[54:55], v6 offset:8960
    ds_read_b64_tr_b16 v[56:57], v6 offset:32
    ds_read_b64_tr_b16 v[58:59], v6 offset:1824
    ds_read_b64_tr_b16 v[60:61], v6 offset:7200
    ds_read_b64_tr_b16 v[62:63], v6 offset:8992
    s_mov_b32 s24, 7
    s_waitcnt lgkmcnt(6)
    v_mfma_f32_16x16x32_bf16 v[96:99], v[16:19], v[48:51], 0
    ds_read_b64_tr_b16 v[64:65], v6 offset:64
    v_mfma_f32_16x16x32_bf16 v[100:103], v[20:23], v[48:51], 0
    ds_read_b64_tr_b16 v[66:67], v6 offset:1856
    v_mfma_f32_16x16x32_bf16 v[104:107], v[24:27], v[48:51], 0
    v_mfma_f32_16x16x32_bf16 v[108:111], v[28:31], v[48:51], 0
    s_waitcnt lgkmcnt(6)
    v_mfma_f32_16x16x32_bf16 v[124:127], v[28:31], v[52:55], 0
    ds_read_b64_tr_b16 v[48:49], v6 offset:7232
    v_mfma_f32_16x16x32_bf16 v[120:123], v[24:27], v[52:55], 0
    ds_read_b64_tr_b16 v[50:51], v6 offset:9024
    v_mfma_f32_16x16x32_bf16 v[116:119], v[20:23], v[52:55], 0
    v_mfma_f32_16x16x32_bf16 v[112:115], v[16:19], v[52:55], 0
    s_waitcnt lgkmcnt(6)
    v_mfma_f32_16x16x32_bf16 v[128:131], v[16:19], v[56:59], 0
    ds_read_b64_tr_b16 v[52:53], v6 offset:96
    v_mfma_f32_16x16x32_bf16 v[132:135], v[20:23], v[56:59], 0
    ds_read_b64_tr_b16 v[54:55], v6 offset:1888
    v_mfma_f32_16x16x32_bf16 v[136:139], v[24:27], v[56:59], 0
    v_mfma_f32_16x16x32_bf16 v[140:143], v[28:31], v[56:59], 0
    s_waitcnt lgkmcnt(6)
    v_mfma_f32_16x16x32_bf16 v[156:159], v[28:31], v[60:63], 0
    ds_read_b64_tr_b16 v[56:57], v6 offset:7264
    v_mfma_f32_16x16x32_bf16 v[152:155], v[24:27], v[60:63], 0
    ds_read_b64_tr_b16 v[58:59], v6 offset:9056
    v_mfma_f32_16x16x32_bf16 v[148:151], v[20:23], v[60:63], 0
    v_mfma_f32_16x16x32_bf16 v[144:147], v[16:19], v[60:63], 0
    s_waitcnt lgkmcnt(6)
    v_mfma_f32_16x16x32_bf16 v[160:163], v[16:19], v[64:67], 0
    ds_read_b64_tr_b16 v[60:61], v6 offset:128
    v_mfma_f32_16x16x32_bf16 v[164:167], v[20:23], v[64:67], 0
    ds_read_b64_tr_b16 v[62:63], v6 offset:1920
    v_mfma_f32_16x16x32_bf16 v[168:171], v[24:27], v[64:67], 0
    v_mfma_f32_16x16x32_bf16 v[172:175], v[28:31], v[64:67], 0
    s_waitcnt lgkmcnt(6)
    v_mfma_f32_16x16x32_bf16 v[188:191], v[28:31], v[48:51], 0
    ds_read_b64_tr_b16 v[64:65], v6 offset:7296
    v_mfma_f32_16x16x32_bf16 v[184:187], v[24:27], v[48:51], 0
    ds_read_b64_tr_b16 v[66:67], v6 offset:9088
    v_mfma_f32_16x16x32_bf16 v[180:183], v[20:23], v[48:51], 0
    v_mfma_f32_16x16x32_bf16 v[176:179], v[16:19], v[48:51], 0
    s_waitcnt lgkmcnt(6)
    v_mfma_f32_16x16x32_bf16 v[192:195], v[16:19], v[52:55], 0
    v_mfma_f32_16x16x32_bf16 v[196:199], v[20:23], v[52:55], 0
    v_mfma_f32_16x16x32_bf16 v[200:203], v[24:27], v[52:55], 0
    v_mfma_f32_16x16x32_bf16 v[204:207], v[28:31], v[52:55], 0
    s_waitcnt vmcnt(10) lgkmcnt(0)
    s_barrier
    v_mfma_f32_16x16x32_bf16 v[220:223], v[28:31], v[56:59], 0
    ds_read_b128 v[32:35], v4 offset:34816
    ds_read_b128 v[36:39], v4 offset:35840
    v_mfma_f32_16x16x32_bf16 v[216:219], v[24:27], v[56:59], 0
    ds_read_b128 v[40:43], v4 offset:36864
    ds_read_b128 v[44:47], v4 offset:37888
    v_mfma_f32_16x16x32_bf16 v[212:215], v[20:23], v[56:59], 0
    ds_read_b64_tr_b16 v[48:49], v6 offset:34816
    ds_read_b64_tr_b16 v[50:51], v6 offset:36608
    v_mfma_f32_16x16x32_bf16 v[208:211], v[16:19], v[56:59], 0
    ds_read_b64_tr_b16 v[52:53], v6 offset:41984
    ds_read_b64_tr_b16 v[54:55], v6 offset:43776
    v_mfma_f32_16x16x32_bf16 v[224:227], v[16:19], v[60:63], 0
    ds_read_b64_tr_b16 v[56:57], v6 offset:34848
    v_mfma_f32_16x16x32_bf16 v[228:231], v[20:23], v[60:63], 0
    ds_read_b64_tr_b16 v[58:59], v6 offset:36640
    s_add_u32 m0, s22, 16384
    s_nop 0
    buffer_load_dwordx4 v2, s[12:15], s20 offen lds
    v_mfma_f32_16x16x32_bf16 v[232:235], v[24:27], v[60:63], 0
    v_mfma_f32_16x16x32_bf16 v[236:239], v[28:31], v[60:63], 0
    v_mfma_f32_16x16x32_bf16 v[252:255], v[28:31], v[64:67], 0
    ds_read_b64_tr_b16 v[60:61], v6 offset:42016
    s_mov_b64 exec, s[30:31]
    buffer_load_dwordx4 v3, s[12:15], s20 offen offset:1024 lds
    s_mov_b64 exec, -1
    v_mfma_f32_16x16x32_bf16 v[248:251], v[24:27], v[64:67], 0
    ds_read_b64_tr_b16 v[62:63], v6 offset:43808
    v_mfma_f32_16x16x32_bf16 v[244:247], v[20:23], v[64:67], 0
    v_mfma_f32_16x16x32_bf16 v[240:243], v[16:19], v[64:67], 0
    s_add_u32 m0, s22, 23552
    s_nop 0
    buffer_load_dwordx4 v2, s[16:19], s20 offen lds
    s_waitcnt lgkmcnt(6)
    v_mfma_f32_16x16x32_bf16 v[96:99], v[32:35], v[48:51], v[96:99]
    ds_read_b64_tr_b16 v[64:65], v6 offset:34880
    v_mfma_f32_16x16x32_bf16 v[100:103], v[36:39], v[48:51], v[100:103]
    ds_read_b64_tr_b16 v[66:67], v6 offset:36672
    v_mfma_f32_16x16x32_bf16 v[104:107], v[40:43], v[48:51], v[104:107]
    s_mov_b64 exec, s[30:31]
    buffer_load_dwordx4 v3, s[16:19], s20 offen offset:1024 lds
    s_mov_b64 exec, -1
    s_add_u32 s20, s20, 229376
    v_mfma_f32_16x16x32_bf16 v[108:111], v[44:47], v[48:51], v[108:111]
    s_waitcnt lgkmcnt(6)
    v_mfma_f32_16x16x32_bf16 v[124:127], v[44:47], v[52:55], v[124:127]
    ds_read_b64_tr_b16 v[48:49], v6 offset:42048
    v_mfma_f32_16x16x32_bf16 v[120:123], v[40:43], v[52:55], v[120:123]
    ds_read_b64_tr_b16 v[50:51], v6 offset:43840
    v_mfma_f32_16x16x32_bf16 v[116:119], v[36:39], v[52:55], v[116:119]
    v_mfma_f32_16x16x32_bf16 v[112:115], v[32:35], v[52:55], v[112:115]
    s_waitcnt lgkmcnt(6)
    v_mfma_f32_16x16x32_bf16 v[128:131], v[32:35], v[56:59], v[128:131]
    ds_read_b64_tr_b16 v[52:53], v6 offset:34912
    v_mfma_f32_16x16x32_bf16 v[132:135], v[36:39], v[56:59], v[132:135]
    ds_read_b64_tr_b16 v[54:55], v6 offset:36704
    v_mfma_f32_16x16x32_bf16 v[136:139], v[40:43], v[56:59], v[136:139]
    v_mfma_f32_16x16x32_bf16 v[140:143], v[44:47], v[56:59], v[140:143]
    s_waitcnt lgkmcnt(6)
    v_mfma_f32_16x16x32_bf16 v[156:159], v[44:47], v[60:63], v[156:159]
    ds_read_b64_tr_b16 v[56:57], v6 offset:42080
    v_mfma_f32_16x16x32_bf16 v[152:155], v[40:43], v[60:63], v[152:155]
    ds_read_b64_tr_b16 v[58:59], v6 offset:43872
    v_mfma_f32_16x16x32_bf16 v[148:151], v[36:39], v[60:63], v[148:151]
    v_mfma_f32_16x16x32_bf16 v[144:147], v[32:35], v[60:63], v[144:147]
    s_waitcnt lgkmcnt(6)
    v_mfma_f32_16x16x32_bf16 v[160:163], v[32:35], v[64:67], v[160:163]
    ds_read_b64_tr_b16 v[60:61], v6 offset:34944
    v_mfma_f32_16x16x32_bf16 v[164:167], v[36:39], v[64:67], v[164:167]
    ds_read_b64_tr_b16 v[62:63], v6 offset:36736
    v_mfma_f32_16x16x32_bf16 v[168:171], v[40:43], v[64:67], v[168:171]
    v_mfma_f32_16x16x32_bf16 v[172:175], v[44:47], v[64:67], v[172:175]
    s_waitcnt lgkmcnt(6)
    v_mfma_f32_16x16x32_bf16 v[188:191], v[44:47], v[48:51], v[188:191]
    ds_read_b64_tr_b16 v[64:65], v6 offset:42112
    v_mfma_f32_16x16x32_bf16 v[184:187], v[40:43], v[48:51], v[184:187]
    ds_read_b64_tr_b16 v[66:67], v6 offset:43904
    v_mfma_f32_16x16x32_bf16 v[180:183], v[36:39], v[48:51], v[180:183]
    v_mfma_f32_16x16x32_bf16 v[176:179], v[32:35], v[48:51], v[176:179]
    s_waitcnt lgkmcnt(6)
    v_mfma_f32_16x16x32_bf16 v[192:195], v[32:35], v[52:55], v[192:195]
    v_mfma_f32_16x16x32_bf16 v[196:199], v[36:39], v[52:55], v[196:199]
    v_mfma_f32_16x16x32_bf16 v[200:203], v[40:43], v[52:55], v[200:203]
    v_mfma_f32_16x16x32_bf16 v[204:207], v[44:47], v[52:55], v[204:207]
    s_waitcnt vmcnt(10) lgkmcnt(0)
    s_barrier
    v_mfma_f32_16x16x32_bf16 v[220:223], v[44:47], v[56:59], v[220:223]
    ds_read_b128 v[16:19], v5 offset:0
    ds_read_b128 v[20:23], v5 offset:1024
    v_mfma_f32_16x16x32_bf16 v[216:219], v[40:43], v[56:59], v[216:219]
    ds_read_b128 v[24:27], v5 offset:2048
    ds_read_b128 v[28:31], v5 offset:3072
    v_mfma_f32_16x16x32_bf16 v[212:215], v[36:39], v[56:59], v[212:215]
    ds_read_b64_tr_b16 v[48:49], v7 offset:0
    ds_read_b64_tr_b16 v[50:51], v7 offset:1792
    v_mfma_f32_16x16x32_bf16 v[208:211], v[32:35], v[56:59], v[208:211]
    ds_read_b64_tr_b16 v[52:53], v7 offset:7168
    ds_read_b64_tr_b16 v[54:55], v7 offset:8960
    v_mfma_f32_16x16x32_bf16 v[224:227], v[32:35], v[60:63], v[224:227]
    ds_read_b64_tr_b16 v[56:57], v7 offset:32
    v_mfma_f32_16x16x32_bf16 v[228:231], v[36:39], v[60:63], v[228:231]
    ds_read_b64_tr_b16 v[58:59], v7 offset:1824
    s_add_u32 m0, s22, 51200
    s_nop 0
    buffer_load_dwordx4 v2, s[12:15], s20 offen lds
    v_mfma_f32_16x16x32_bf16 v[232:235], v[40:43], v[60:63], v[232:235]
    v_mfma_f32_16x16x32_bf16 v[236:239], v[44:47], v[60:63], v[236:239]
    v_mfma_f32_16x16x32_bf16 v[252:255], v[44:47], v[64:67], v[252:255]
    ds_read_b64_tr_b16 v[60:61], v7 offset:7200
    s_mov_b64 exec, s[30:31]
    buffer_load_dwordx4 v3, s[12:15], s20 offen offset:1024 lds
    s_mov_b64 exec, -1
    v_mfma_f32_16x16x32_bf16 v[248:251], v[40:43], v[64:67], v[248:251]
    ds_read_b64_tr_b16 v[62:63], v7 offset:8992
    v_mfma_f32_16x16x32_bf16 v[244:247], v[36:39], v[64:67], v[244:247]
    v_mfma_f32_16x16x32_bf16 v[240:243], v[32:35], v[64:67], v[240:243]
    s_add_u32 m0, s22, 58368
    s_nop 0
    buffer_load_dwordx4 v2, s[16:19], s20 offen lds
    s_branch L2_mid0
.p2align 4
L2_loop0:
    s_cmp_lg_u32 s24, 1
    s_cbranch_scc1 L2_ncr
    s_cmp_lg_u32 s26, 3
    s_cbranch_scc1 L2_ncr
    s_getpc_b64 s[100:101]
L2_pc2:
    s_sub_u32 s100, s100, L2_pc2-recurrent_scan__ssm_conv_s5__glu_gated_geglu__prompt_kernel
    s_subb_u32 s101, s101, 0
    s_lshr_b32 s3, s6, 3
    s_lshl_b32 s3, s3, 4
    v_and_b32 v89, 15, v1
    v_add_u32 v89, s3, v89
    v_lshlrev_b32 v89, 7, v89
    s_mov_b32 s3, L3_end-recurrent_scan__ssm_conv_s5__glu_gated_geglu__prompt_kernel
    v_min_u32 v89, s3, v89
    global_load_dword v91, v89, s[100:101]
L2_ncr:
    s_cmp_lt_u32 s24, 2
    s_cbranch_scc1 L2_npf3
    buffer_load_dword v91, v90, s[84:87], s94 offen
    s_add_u32 s94, s94, s95
L2_npf3:
    s_waitcnt lgkmcnt(6)
    v_mfma_f32_16x16x32_bf16 v[96:99], v[16:19], v[48:51], v[96:99]
    ds_read_b64_tr_b16 v[64:65], v6 offset:64
    v_mfma_f32_16x16x32_bf16 v[100:103], v[20:23], v[48:51], v[100:103]
    ds_read_b64_tr_b16 v[66:67], v6 offset:1856
    v_mfma_f32_16x16x32_bf16 v[104:107], v[24:27], v[48:51], v[104:107]
    s_mov_b64 exec, s[30:31]
    buffer_load_dwordx4 v3, s[16:19], s20 offen offset:1024 lds
    s_mov_b64 exec, -1
    s_add_u32 s20, s20, 229376
    v_mfma_f32_16x16x32_bf16 v[108:111], v[28:31], v[48:51], v[108:111]
    s_waitcnt lgkmcnt(6)
    v_mfma_f32_16x16x32_bf16 v[124:127], v[28:31], v[52:55], v[124:127]
    ds_read_b64_tr_b16 v[48:49], v6 offset:7232
    v_mfma_f32_16x16x32_bf16 v[120:123], v[24:27], v[52:55], v[120:123]
    ds_read_b64_tr_b16 v[50:51], v6 offset:9024
    v_mfma_f32_16x16x32_bf16 v[116:119], v[20:23], v[52:55], v[116:119]
    v_mfma_f32_16x16x32_bf16 v[112:115], v[16:19], v[52:55], v[112:115]
    s_waitcnt lgkmcnt(6)
    v_mfma_f32_16x16x32_bf16 v[128:131], v[16:19], v[56:59], v[128:131]
    ds_read_b64_tr_b16 v[52:53], v6 offset:96
    v_mfma_f32_16x16x32_bf16 v[132:135], v[20:23], v[56:59], v[132:135]
    ds_read_b64_tr_b16 v[54:55], v6 offset:1888
    v_mfma_f32_16x16x32_bf16 v[136:139], v[24:27], v[56:59], v[136:139]
    v_mfma_f32_16x16x32_bf16 v[140:143], v[28:31], v[56:59], v[140:143]
    s_waitcnt lgkmcnt(6)
    v_mfma_f32_16x16x32_bf16 v[156:159], v[28:31], v[60:63], v[156:159]
    ds_read_b64_tr_b16 v[56:57], v6 offset:7264
    v_mfma_f32_16x16x32_bf16 v[152:155], v[24:27], v[60:63], v[152:155]
    ds_read_b64_tr_b16 v[58:59], v6 offset:9056
    v_mfma_f32_16x16x32_bf16 v[148:151], v[20:23], v[60:63], v[148:151]
    v_mfma_f32_16x16x32_bf16 v[144:147], v[16:19], v[60:63], v[144:147]
    s_waitcnt lgkmcnt(6)
    v_mfma_f32_16x16x32_bf16 v[160:163], v[16:19], v[64:67], v[160:163]
    ds_read_b64_tr_b16 v[60:61], v6 offset:128
    v_mfma_f32_16x16x32_bf16 v[164:167], v[20:23], v[64:67], v[164:167]
    ds_read_b64_tr_b16 v[62:63], v6 offset:1920
    v_mfma_f32_16x16x32_bf16 v[168:171], v[24:27], v[64:67], v[168:171]
    v_mfma_f32_16x16x32_bf16 v[172:175], v[28:31], v[64:67], v[172:175]
    s_waitcnt lgkmcnt(6)
    v_mfma_f32_16x16x32_bf16 v[188:191], v[28:31], v[48:51], v[188:191]
    ds_read_b64_tr_b16 v[64:65], v6 offset:7296
    v_mfma_f32_16x16x32_bf16 v[184:187], v[24:27], v[48:51], v[184:187]
    ds_read_b64_tr_b16 v[66:67], v6 offset:9088
    v_mfma_f32_16x16x32_bf16 v[180:183], v[20:23], v[48:51], v[180:183]
    v_mfma_f32_16x16x32_bf16 v[176:179], v[16:19], v[48:51], v[176:179]
    s_waitcnt lgkmcnt(6)
    v_mfma_f32_16x16x32_bf16 v[192:195], v[16:19], v[52:55], v[192:195]
    v_mfma_f32_16x16x32_bf16 v[196:199], v[20:23], v[52:55], v[196:199]
    v_mfma_f32_16x16x32_bf16 v[200:203], v[24:27], v[52:55], v[200:203]
    v_mfma_f32_16x16x32_bf16 v[204:207], v[28:31], v[52:55], v[204:207]
    s_waitcnt vmcnt(8) lgkmcnt(0)
    s_barrier
    v_mfma_f32_16x16x32_bf16 v[220:223], v[28:31], v[56:59], v[220:223]
    ds_read_b128 v[32:35], v4 offset:34816
    ds_read_b128 v[36:39], v4 offset:35840
    v_mfma_f32_16x16x32_bf16 v[216:219], v[24:27], v[56:59], v[216:219]
    ds_read_b128 v[40:43], v4 offset:36864
    ds_read_b128 v[44:47], v4 offset:37888
    v_mfma_f32_16x16x32_bf16 v[212:215], v[20:23], v[56:59], v[212:215]
    ds_read_b64_tr_b16 v[48:49], v6 offset:34816
    ds_read_b64_tr_b16 v[50:51], v6 offset:36608
    v_mfma_f32_16x16x32_bf16 v[208:211], v[16:19], v[56:59], v[208:211]
    ds_read_b64_tr_b16 v[52:53], v6 offset:41984
    ds_read_b64_tr_b16 v[54:55], v6 offset:43776
    v_mfma_f32_16x16x32_bf16 v[224:227], v[16:19], v[60:63], v[224:227]
    ds_read_b64_tr_b16 v[56:57], v6 offset:34848
    v_mfma_f32_16x16x32_bf16 v[228:231], v[20:23], v[60:63], v[228:231]
    ds_read_b64_tr_b16 v[58:59], v6 offset:36640
    s_add_u32 m0, s22, 16384
    s_nop 0
    buffer_load_dwordx4 v2, s[12:15], s20 offen lds
    v_mfma_f32_16x16x32_bf16 v[232:235], v[24:27], v[60:63], v[232:235]
    v_mfma_f32_16x16x32_bf16 v[236:239], v[28:31], v[60:63], v[236:239]
    v_mfma_f32_16x16x32_bf16 v[252:255], v[28:31], v[64:67], v[252:255]
    ds_read_b64_tr_b16 v[60:61], v6 offset:42016
    s_mov_b64 exec, s[30:31]
    buffer_load_dwordx4 v3, s[12:15], s20 offen offset:1024 lds
    s_mov_b64 exec, -1
    v_mfma_f32_16x16x32_bf16 v[248:251], v[24:27], v[64:67], v[248:251]
    ds_read_b64_tr_b16 v[62:63], v6 offset:43808
    v_mfma_f32_16x16x32_bf16 v[244:247], v[20:23], v[64:67], v[244:247]
    v_mfma_f32_16x16x32_bf16 v[240:243], v[16:19], v[64:67], v[240:243]
    s_add_u32 m0, s22, 23552
    s_nop 0
    buffer_load_dwordx4 v2, s[16:19], s20 offen lds
    s_waitcnt lgkmcnt(6)
    v_mfma_f32_16x16x32_bf16 v[96:99], v[32:35], v[48:51], v[96:99]
    ds_read_b64_tr_b16 v[64:65], v6 offset:34880
    v_mfma_f32_16x16x32_bf16 v[100:103], v[36:39], v[48:51], v[100:103]
    ds_read_b64_tr_b16 v[66:67], v6 offset:36672
    v_mfma_f32_16x16x32_bf16 v[104:107], v[40:43], v[48:51], v[104:107]
    s_mov_b64 exec, s[30:31]
    buffer_load_dwordx4 v3, s[16:19], s20 offen offset:1024 lds
    s_mov_b64 exec, -1
    s_add_u32 s20, s20, 229376
    v_mfma_f32_16x16x32_bf16 v[108:111], v[44:47], v[48:51], v[108:111]
    s_waitcnt lgkmcnt(6)
    v_mfma_f32_16x16x32_bf16 v[124:127], v[44:47], v[52:55], v[124:127]
    ds_read_b64_tr_b16 v[48:49], v6 offset:42048
    v_mfma_f32_16x16x32_bf16 v[120:123], v[40:43], v[52:55], v[120:123]
    ds_read_b64_tr_b16 v[50:51], v6 offset:43840
    v_mfma_f32_16x16x32_bf16 v[116:119], v[36:39], v[52:55], v[116:119]
    v_mfma_f32_16x16x32_bf16 v[112:115], v[32:35], v[52:55], v[112:115]
    s_waitcnt lgkmcnt(6)
    v_mfma_f32_16x16x32_bf16 v[128:131], v[32:35], v[56:59], v[128:131]
    ds_read_b64_tr_b16 v[52:53], v6 offset:34912
    v_mfma_f32_16x16x32_bf16 v[132:135], v[36:39], v[56:59], v[132:135]
    ds_read_b64_tr_b16 v[54:55], v6 offset:36704
    v_mfma_f32_16x16x32_bf16 v[136:139], v[40:43], v[56:59], v[136:139]
    v_mfma_f32_16x16x32_bf16 v[140:143], v[44:47], v[56:59], v[140:143]
    s_waitcnt lgkmcnt(6)
    v_mfma_f32_16x16x32_bf16 v[156:159], v[44:47], v[60:63], v[156:159]
    ds_read_b64_tr_b16 v[56:57], v6 offset:42080
    v_mfma_f32_16x16x32_bf16 v[152:155], v[40:43], v[60:63], v[152:155]
    ds_read_b64_tr_b16 v[58:59], v6 offset:43872
    v_mfma_f32_16x16x32_bf16 v[148:151], v[36:39], v[60:63], v[148:151]
    v_mfma_f32_16x16x32_bf16 v[144:147], v[32:35], v[60:63], v[144:147]
    s_waitcnt lgkmcnt(6)
    v_mfma_f32_16x16x32_bf16 v[160:163], v[32:35], v[64:67], v[160:163]
    ds_read_b64_tr_b16 v[60:61], v6 offset:34944
    v_mfma_f32_16x16x32_bf16 v[164:167], v[36:39], v[64:67], v[164:167]
    ds_read_b64_tr_b16 v[62:63], v6 offset:36736
    v_mfma_f32_16x16x32_bf16 v[168:171], v[40:43], v[64:67], v[168:171]
    v_mfma_f32_16x16x32_bf16 v[172:175], v[44:47], v[64:67], v[172:175]
    s_waitcnt lgkmcnt(6)
    v_mfma_f32_16x16x32_bf16 v[188:191], v[44:47], v[48:51], v[188:191]
    ds_read_b64_tr_b16 v[64:65], v6 offset:42112
    v_mfma_f32_16x16x32_bf16 v[184:187], v[40:43], v[48:51], v[184:187]
    ds_read_b64_tr_b16 v[66:67], v6 offset:43904
    v_mfma_f32_16x16x32_bf16 v[180:183], v[36:39], v[48:51], v[180:183]
    v_mfma_f32_16x16x32_bf16 v[176:179], v[32:35], v[48:51], v[176:179]
    s_waitcnt lgkmcnt(6)
    v_mfma_f32_16x16x32_bf16 v[192:195], v[32:35], v[52:55], v[192:195]
    v_mfma_f32_16x16x32_bf16 v[196:199], v[36:39], v[52:55], v[196:199]
    v_mfma_f32_16x16x32_bf16 v[200:203], v[40:43], v[52:55], v[200:203]
    v_mfma_f32_16x16x32_bf16 v[204:207], v[44:47], v[52:55], v[204:207]
    s_waitcnt vmcnt(8) lgkmcnt(0)
    s_barrier
    v_mfma_f32_16x16x32_bf16 v[220:223], v[44:47], v[56:59], v[220:223]
    ds_read_b128 v[16:19], v5 offset:0
    ds_read_b128 v[20:23], v5 offset:1024
    v_mfma_f32_16x16x32_bf16 v[216:219], v[40:43], v[56:59], v[216:219]
    ds_read_b128 v[24:27], v5 offset:2048
    ds_read_b128 v[28:31], v5 offset:3072
    v_mfma_f32_16x16x32_bf16 v[212:215], v[36:39], v[56:59], v[212:215]
    ds_read_b64_tr_b16 v[48:49], v7 offset:0
    ds_read_b64_tr_b16 v[50:51], v7 offset:1792
    v_mfma_f32_16x16x32_bf16 v[208:211], v[32:35], v[56:59], v[208:211]
    ds_read_b64_tr_b16 v[52:53], v7 offset:7168
    ds_read_b64_tr_b16 v[54:55], v7 offset:8960
    v_mfma_f32_16x16x32_bf16 v[224:227], v[32:35], v[60:63], v[224:227]
    ds_read_b64_tr_b16 v[56:57], v7 offset:32
    v_mfma_f32_16x16x32_bf16 v[228:231], v[36:39], v[60:63], v[228:231]
    ds_read_b64_tr_b16 v[58:59], v7 offset:1824
    s_add_u32 m0, s22, 51200
    s_nop 0
    buffer_load_dwordx4 v2, s[12:15], s20 offen lds
    v_mfma_f32_16x16x32_bf16 v[232:235], v[40:43], v[60:63], v[232:235]
    v_mfma_f32_16x16x32_bf16 v[236:239], v[44:47], v[60:63], v[236:239]
    v_mfma_f32_16x16x32_bf16 v[252:255], v[44:47], v[64:67], v[252:255]
    ds_read_b64_tr_b16 v[60:61], v7 offset:7200
    s_mov_b64 exec, s[30:31]
    buffer_load_dwordx4 v3, s[12:15], s20 offen offset:1024 lds
    s_mov_b64 exec, -1
    v_mfma_f32_16x16x32_bf16 v[248:251], v[40:43], v[64:67], v[248:251]
    ds_read_b64_tr_b16 v[62:63], v7 offset:8992
    v_mfma_f32_16x16x32_bf16 v[244:247], v[36:39], v[64:67], v[244:247]
    v_mfma_f32_16x16x32_bf16 v[240:243], v[32:35], v[64:67], v[240:243]
    s_add_u32 m0, s22, 58368
    s_nop 0
    buffer_load_dwordx4 v2, s[16:19], s20 offen lds
L2_mid0:
    s_waitcnt lgkmcnt(6)
    v_mfma_f32_16x16x32_bf16 v[96:99], v[16:19], v[48:51], v[96:99]
    ds_read_b64_tr_b16 v[64:65], v7 offset:64
    v_mfma_f32_16x16x32_bf16 v[100:103], v[20:23], v[48:51], v[100:103]
    ds_read_b64_tr_b16 v[66:67], v7 offset:1856
    v_mfma_f32_16x16x32_bf16 v[104:107], v[24:27], v[48:51], v[104:107]
    s_mov_b64 exec, s[30:31]
    buffer_load_dwordx4 v3, s[16:19], s20 offen offset:1024 lds
    s_mov_b64 exec, -1
    s_add_u32 s20, s20, 229376
    v_mfma_f32_16x16x32_bf16 v[108:111], v[28:31], v[48:51], v[108:111]
    s_waitcnt lgkmcnt(6)
    v_mfma_f32_16x16x32_bf16 v[124:127], v[28:31], v[52:55], v[124:127]
    ds_read_b64_tr_b16 v[48:49], v7 offset:7232
    v_mfma_f32_16x16x32_bf16 v[120:123], v[24:27], v[52:55], v[120:123]
    ds_read_b64_tr_b16 v[50:51], v7 offset:9024
    v_mfma_f32_16x16x32_bf16 v[116:119], v[20:23], v[52:55], v[116:119]
    v_mfma_f32_16x16x32_bf16 v[112:115], v[16:19], v[52:55], v[112:115]
    s_waitcnt lgkmcnt(6)
    v_mfma_f32_16x16x32_bf16 v[128:131], v[16:19], v[56:59], v[128:131]
    ds_read_b64_tr_b16 v[52:53], v7 offset:96
    v_mfma_f32_16x16x32_bf16 v[132:135], v[20:23], v[56:59], v[132:135]
    ds_read_b64_tr_b16 v[54:55], v7 offset:1888
    v_mfma_f32_16x16x32_bf16 v[136:139], v[24:27], v[56:59], v[136:139]
    v_mfma_f32_16x16x32_bf16 v[140:143], v[28:31], v[56:59], v[140:143]
    s_waitcnt lgkmcnt(6)
    v_mfma_f32_16x16x32_bf16 v[156:159], v[28:31], v[60:63], v[156:159]
    ds_read_b64_tr_b16 v[56:57], v7 offset:7264
    v_mfma_f32_16x16x32_bf16 v[152:155], v[24:27], v[60:63], v[152:155]
    ds_read_b64_tr_b16 v[58:59], v7 offset:9056
    v_mfma_f32_16x16x32_bf16 v[148:151], v[20:23], v[60:63], v[148:151]
    v_mfma_f32_16x16x32_bf16 v[144:147], v[16:19], v[60:63], v[144:147]
    s_waitcnt lgkmcnt(6)
    v_mfma_f32_16x16x32_bf16 v[160:163], v[16:19], v[64:67], v[160:163]
    ds_read_b64_tr_b16 v[60:61], v7 offset:128
    v_mfma_f32_16x16x32_bf16 v[164:167], v[20:23], v[64:67], v[164:167]
    ds_read_b64_tr_b16 v[62:63], v7 offset:1920
    v_mfma_f32_16x16x32_bf16 v[168:171], v[24:27], v[64:67], v[168:171]
    v_mfma_f32_16x16x32_bf16 v[172:175], v[28:31], v[64:67], v[172:175]
    s_waitcnt lgkmcnt(6)
    v_mfma_f32_16x16x32_bf16 v[188:191], v[28:31], v[48:51], v[188:191]
    ds_read_b64_tr_b16 v[64:65], v7 offset:7296
    v_mfma_f32_16x16x32_bf16 v[184:187], v[24:27], v[48:51], v[184:187]
    ds_read_b64_tr_b16 v[66:67], v7 offset:9088
    v_mfma_f32_16x16x32_bf16 v[180:183], v[20:23], v[48:51], v[180:183]
    v_mfma_f32_16x16x32_bf16 v[176:179], v[16:19], v[48:51], v[176:179]
    s_waitcnt lgkmcnt(6)
    v_mfma_f32_16x16x32_bf16 v[192:195], v[16:19], v[52:55], v[192:195]
    v_mfma_f32_16x16x32_bf16 v[196:199], v[20:23], v[52:55], v[196:199]
    v_mfma_f32_16x16x32_bf16 v[200:203], v[24:27], v[52:55], v[200:203]
    v_mfma_f32_16x16x32_bf16 v[204:207], v[28:31], v[52:55], v[204:207]
    s_waitcnt vmcnt(8) lgkmcnt(0)
    s_barrier
    v_mfma_f32_16x16x32_bf16 v[220:223], v[28:31], v[56:59], v[220:223]
    ds_read_b128 v[32:35], v5 offset:34816
    ds_read_b128 v[36:39], v5 offset:35840
    v_mfma_f32_16x16x32_bf16 v[216:219], v[24:27], v[56:59], v[216:219]
    ds_read_b128 v[40:43], v5 offset:36864
    ds_read_b128 v[44:47], v5 offset:37888
    v_mfma_f32_16x16x32_bf16 v[212:215], v[20:23], v[56:59], v[212:215]
    ds_read_b64_tr_b16 v[48:49], v7 offset:34816
    ds_read_b64_tr_b16 v[50:51], v7 offset:36608
    v_mfma_f32_16x16x32_bf16 v[208:211], v[16:19], v[56:59], v[208:211]
    ds_read_b64_tr_b16 v[52:53], v7 offset:41984
    ds_read_b64_tr_b16 v[54:55], v7 offset:43776
    v_mfma_f32_16x16x32_bf16 v[224:227], v[16:19], v[60:63], v[224:227]
    ds_read_b64_tr_b16 v[56:57], v7 offset:34848
    v_mfma_f32_16x16x32_bf16 v[228:231], v[20:23], v[60:63], v[228:231]
    ds_read_b64_tr_b16 v[58:59], v7 offset:36640
    s_add_u32 m0, s22, 86016
    s_nop 0
    buffer_load_dwordx4 v2, s[12:15], s20 offen lds
    v_mfma_f32_16x16x32_bf16 v[232:235], v[24:27], v[60:63], v[232:235]
    v_mfma_f32_16x16x32_bf16 v[236:239], v[28:31], v[60:63], v[236:239]
    v_mfma_f32_16x16x32_bf16 v[252:255], v[28:31], v[64:67], v[252:255]
    ds_read_b64_tr_b16 v[60:61], v7 offset:42016
    s_mov_b64 exec, s[30:31]
    buffer_load_dwordx4 v3, s[12:15], s20 offen offset:1024 lds
    s_mov_b64 exec, -1
    v_mfma_f32_16x16x32_bf16 v[248:251], v[24:27], v[64:67], v[248:251]
    ds_read_b64_tr_b16 v[62:63], v7 offset:43808
    v_mfma_f32_16x16x32_bf16 v[244:247], v[20:23], v[64:67], v[244:247]
    v_mfma_f32_16x16x32_bf16 v[240:243], v[16:19], v[64:67], v[240:243]
    s_add_u32 m0, s22, 93184
    s_nop 0
    buffer_load_dwordx4 v2, s[16:19], s20 offen lds
    s_waitcnt lgkmcnt(6)
    v_mfma_f32_16x16x32_bf16 v[96:99], v[32:35], v[48:51], v[96:99]
    ds_read_b64_tr_b16 v[64:65], v7 offset:34880
    v_mfma_f32_16x16x32_bf16 v[100:103], v[36:39], v[48:51], v[100:103]
    ds_read_b64_tr_b16 v[66:67], v7 offset:36672
    v_mfma_f32_16x16x32_bf16 v[104:107], v[40:43], v[48:51], v[104:107]
    s_mov_b64 exec, s[30:31]
    buffer_load_dwordx4 v3, s[16:19], s20 offen offset:1024 lds
    s_mov_b64 exec, -1
    s_add_u32 s20, s20, 229376
    v_mfma_f32_16x16x32_bf16 v[108:111], v[44:47], v[48:51], v[108:111]
    s_waitcnt lgkmcnt(6)
    v_mfma_f32_16x16x32_bf16 v[124:127], v[44:47], v[52:55], v[124:127]
    ds_read_b64_tr_b16 v[48:49], v7 offset:42048
    v_mfma_f32_16x16x32_bf16 v[120:123], v[40:43], v[52:55], v[120:123]
    ds_read_b64_tr_b16 v[50:51], v7 offset:43840
    v_mfma_f32_16x16x32_bf16 v[116:119], v[36:39], v[52:55], v[116:119]
    v_mfma_f32_16x16x32_bf16 v[112:115], v[32:35], v[52:55], v[112:115]
    s_waitcnt lgkmcnt(6)
    v_mfma_f32_16x16x32_bf16 v[128:131], v[32:35], v[56:59], v[128:131]
    ds_read_b64_tr_b16 v[52:53], v7 offset:34912
    v_mfma_f32_16x16x32_bf16 v[132:135], v[36:39], v[56:59], v[132:135]
    ds_read_b64_tr_b16 v[54:55], v7 offset:36704
    v_mfma_f32_16x16x32_bf16 v[136:139], v[40:43], v[56:59], v[136:139]
    v_mfma_f32_16x16x32_bf16 v[140:143], v[44:47], v[56:59], v[140:143]
    s_waitcnt lgkmcnt(6)
    v_mfma_f32_16x16x32_bf16 v[156:159], v[44:47], v[60:63], v[156:159]
    ds_read_b64_tr_b16 v[56:57], v7 offset:42080
    v_mfma_f32_16x16x32_bf16 v[152:155], v[40:43], v[60:63], v[152:155]
    ds_read_b64_tr_b16 v[58:59], v7 offset:43872
    v_mfma_f32_16x16x32_bf16 v[148:151], v[36:39], v[60:63], v[148:151]
    v_mfma_f32_16x16x32_bf16 v[144:147], v[32:35], v[60:63], v[144:147]
    s_waitcnt lgkmcnt(6)
    v_mfma_f32_16x16x32_bf16 v[160:163], v[32:35], v[64:67], v[160:163]
    ds_read_b64_tr_b16 v[60:61], v7 offset:34944
    v_mfma_f32_16x16x32_bf16 v[164:167], v[36:39], v[64:67], v[164:167]
    ds_read_b64_tr_b16 v[62:63], v7 offset:36736
    v_mfma_f32_16x16x32_bf16 v[168:171], v[40:43], v[64:67], v[168:171]
    v_mfma_f32_16x16x32_bf16 v[172:175], v[44:47], v[64:67], v[172:175]
    s_waitcnt lgkmcnt(6)
    v_mfma_f32_16x16x32_bf16 v[188:191], v[44:47], v[48:51], v[188:191]
    ds_read_b64_tr_b16 v[64:65], v7 offset:42112
    v_mfma_f32_16x16x32_bf16 v[184:187], v[40:43], v[48:51], v[184:187]
    ds_read_b64_tr_b16 v[66:67], v7 offset:43904
    v_mfma_f32_16x16x32_bf16 v[180:183], v[36:39], v[48:51], v[180:183]
    v_mfma_f32_16x16x32_bf16 v[176:179], v[32:35], v[48:51], v[176:179]
    s_waitcnt lgkmcnt(6)
    v_mfma_f32_16x16x32_bf16 v[192:195], v[32:35], v[52:55], v[192:195]
    v_mfma_f32_16x16x32_bf16 v[196:199], v[36:39], v[52:55], v[196:199]
    v_mfma_f32_16x16x32_bf16 v[200:203], v[40:43], v[52:55], v[200:203]
    v_mfma_f32_16x16x32_bf16 v[204:207], v[44:47], v[52:55], v[204:207]
    s_waitcnt vmcnt(8) lgkmcnt(0)
    s_barrier
    v_mfma_f32_16x16x32_bf16 v[220:223], v[44:47], v[56:59], v[220:223]
    ds_read_b128 v[16:19], v4 offset:0
    ds_read_b128 v[20:23], v4 offset:1024
    v_mfma_f32_16x16x32_bf16 v[216:219], v[40:43], v[56:59], v[216:219]
    ds_read_b128 v[24:27], v4 offset:2048
    ds_read_b128 v[28:31], v4 offset:3072
    v_mfma_f32_16x16x32_bf16 v[212:215], v[36:39], v[56:59], v[212:215]
    ds_read_b64_tr_b16 v[48:49], v6 offset:0
    ds_read_b64_tr_b16 v[50:51], v6 offset:1792
    v_mfma_f32_16x16x32_bf16 v[208:211], v[32:35], v[56:59], v[208:211]
    ds_read_b64_tr_b16 v[52:53], v6 offset:7168
    ds_read_b64_tr_b16 v[54:55], v6 offset:8960
    v_mfma_f32_16x16x32_bf16 v[224:227], v[32:35], v[60:63], v[224:227]
    ds_read_b64_tr_b16 v[56:57], v6 offset:32
    v_mfma_f32_16x16x32_bf16 v[228:231], v[36:39], v[60:63], v[228:231]
    ds_read_b64_tr_b16 v[58:59], v6 offset:1824
    s_add_u32 m0, s22, 120832
    s_nop 0
    buffer_load_dwordx4 v2, s[12:15], s20 offen lds
    v_mfma_f32_16x16x32_bf16 v[232:235], v[40:43], v[60:63], v[232:235]
    v_mfma_f32_16x16x32_bf16 v[236:239], v[44:47], v[60:63], v[236:239]
    v_mfma_f32_16x16x32_bf16 v[252:255], v[44:47], v[64:67], v[252:255]
    ds_read_b64_tr_b16 v[60:61], v6 offset:7200
    s_mov_b64 exec, s[30:31]
    buffer_load_dwordx4 v3, s[12:15], s20 offen offset:1024 lds
    s_mov_b64 exec, -1
    v_mfma_f32_16x16x32_bf16 v[248:251], v[40:43], v[64:67], v[248:251]
    ds_read_b64_tr_b16 v[62:63], v6 offset:8992
    v_mfma_f32_16x16x32_bf16 v[244:247], v[36:39], v[64:67], v[244:247]
    v_mfma_f32_16x16x32_bf16 v[240:243], v[32:35], v[64:67], v[240:243]
    s_add_u32 m0, s22, 128000
    s_nop 0
    buffer_load_dwordx4 v2, s[16:19], s20 offen lds
    s_sub_u32 s24, s24, 1
    s_cmp_lg_u32 s24, 0
    s_cbranch_scc1 L2_loop0
    s_waitcnt lgkmcnt(6)
    v_mfma_f32_16x16x32_bf16 v[96:99], v[16:19], v[48:51], v[96:99]
    ds_read_b64_tr_b16 v[64:65], v6 offset:64
    v_mfma_f32_16x16x32_bf16 v[100:103], v[20:23], v[48:51], v[100:103]
    ds_read_b64_tr_b16 v[66:67], v6 offset:1856
    v_mfma_f32_16x16x32_bf16 v[104:107], v[24:27], v[48:51], v[104:107]
    s_mov_b64 exec, s[30:31]
    buffer_load_dwordx4 v3, s[16:19], s20 offen offset:1024 lds
    s_mov_b64 exec, -1
    s_add_u32 s20, s20, 229376
    v_mfma_f32_16x16x32_bf16 v[108:111], v[28:31], v[48:51], v[108:111]
    s_waitcnt lgkmcnt(6)
    v_mfma_f32_16x16x32_bf16 v[124:127], v[28:31], v[52:55], v[124:127]
    ds_read_b64_tr_b16 v[48:49], v6 offset:7232
    v_mfma_f32_16x16x32_bf16 v[120:123], v[24:27], v[52:55], v[120:123]
    ds_read_b64_tr_b16 v[50:51], v6 offset:9024
    v_mfma_f32_16x16x32_bf16 v[116:119], v[20:23], v[52:55], v[116:119]
    v_mfma_f32_16x16x32_bf16 v[112:115], v[16:19], v[52:55], v[112:115]
    s_waitcnt lgkmcnt(6)
    v_mfma_f32_16x16x32_bf16 v[128:131], v[16:19], v[56:59], v[128:131]
    ds_read_b64_tr_b16 v[52:53], v6 offset:96
    v_mfma_f32_16x16x32_bf16 v[132:135], v[20:23], v[56:59], v[132:135]
    ds_read_b64_tr_b16 v[54:55], v6 offset:1888
    v_mfma_f32_16x16x32_bf16 v[136:139], v[24:27], v[56:59], v[136:139]
    v_mfma_f32_16x16x32_bf16 v[140:143], v[28:31], v[56:59], v[140:143]
    s_waitcnt lgkmcnt(6)
    v_mfma_f32_16x16x32_bf16 v[156:159], v[28:31], v[60:63], v[156:159]
    ds_read_b64_tr_b16 v[56:57], v6 offset:7264
    v_mfma_f32_16x16x32_bf16 v[152:155], v[24:27], v[60:63], v[152:155]
    ds_read_b64_tr_b16 v[58:59], v6 offset:9056
    v_mfma_f32_16x16x32_bf16 v[148:151], v[20:23], v[60:63], v[148:151]
    v_mfma_f32_16x16x32_bf16 v[144:147], v[16:19], v[60:63], v[144:147]
    s_waitcnt lgkmcnt(6)
    v_mfma_f32_16x16x32_bf16 v[160:163], v[16:19], v[64:67], v[160:163]
    ds_read_b64_tr_b16 v[60:61], v6 offset:128
    v_mfma_f32_16x16x32_bf16 v[164:167], v[20:23], v[64:67], v[164:167]
    ds_read_b64_tr_b16 v[62:63], v6 offset:1920
    v_mfma_f32_16x16x32_bf16 v[168:171], v[24:27], v[64:67], v[168:171]
    v_mfma_f32_16x16x32_bf16 v[172:175], v[28:31], v[64:67], v[172:175]
    s_waitcnt lgkmcnt(6)
    v_mfma_f32_16x16x32_bf16 v[188:191], v[28:31], v[48:51], v[188:191]
    ds_read_b64_tr_b16 v[64:65], v6 offset:7296
    v_mfma_f32_16x16x32_bf16 v[184:187], v[24:27], v[48:51], v[184:187]
    ds_read_b64_tr_b16 v[66:67], v6 offset:9088
    v_mfma_f32_16x16x32_bf16 v[180:183], v[20:23], v[48:51], v[180:183]
    v_mfma_f32_16x16x32_bf16 v[176:179], v[16:19], v[48:51], v[176:179]
    s_waitcnt lgkmcnt(6)
    v_mfma_f32_16x16x32_bf16 v[192:195], v[16:19], v[52:55], v[192:195]
    v_mfma_f32_16x16x32_bf16 v[196:199], v[20:23], v[52:55], v[196:199]
    v_mfma_f32_16x16x32_bf16 v[200:203], v[24:27], v[52:55], v[200:203]
    v_mfma_f32_16x16x32_bf16 v[204:207], v[28:31], v[52:55], v[204:207]
    s_waitcnt vmcnt(8) lgkmcnt(0)
    s_barrier
    buffer_load_dword v92, v94, s[72:75], s76 offen
    buffer_load_dword v93, v95, s[68:71], s77 offen
    v_mfma_f32_16x16x32_bf16 v[220:223], v[28:31], v[56:59], v[220:223]
    ds_read_b128 v[32:35], v4 offset:34816
    ds_read_b128 v[36:39], v4 offset:35840
    v_mfma_f32_16x16x32_bf16 v[216:219], v[24:27], v[56:59], v[216:219]
    ds_read_b128 v[40:43], v4 offset:36864
    ds_read_b128 v[44:47], v4 offset:37888
    v_mfma_f32_16x16x32_bf16 v[212:215], v[20:23], v[56:59], v[212:215]
    ds_read_b64_tr_b16 v[48:49], v6 offset:34816
    ds_read_b64_tr_b16 v[50:51], v6 offset:36608
    v_mfma_f32_16x16x32_bf16 v[208:211], v[16:19], v[56:59], v[208:211]
    ds_read_b64_tr_b16 v[52:53], v6 offset:41984
    ds_read_b64_tr_b16 v[54:55], v6 offset:43776
    v_mfma_f32_16x16x32_bf16 v[224:227], v[16:19], v[60:63], v[224:227]
    ds_read_b64_tr_b16 v[56:57], v6 offset:34848
    v_mfma_f32_16x16x32_bf16 v[228:231], v[20:23], v[60:63], v[228:231]
    ds_read_b64_tr_b16 v[58:59], v6 offset:36640
    v_mfma_f32_16x16x32_bf16 v[232:235], v[24:27], v[60:63], v[232:235]
    v_mfma_f32_16x16x32_bf16 v[236:239], v[28:31], v[60:63], v[236:239]
    v_mfma_f32_16x16x32_bf16 v[252:255], v[28:31], v[64:67], v[252:255]
    ds_read_b64_tr_b16 v[60:61], v6 offset:42016
    v_mfma_f32_16x16x32_bf16 v[248:251], v[24:27], v[64:67], v[248:251]
    ds_read_b64_tr_b16 v[62:63], v6 offset:43808
    v_mfma_f32_16x16x32_bf16 v[244:247], v[20:23], v[64:67], v[244:247]
    v_mfma_f32_16x16x32_bf16 v[240:243], v[16:19], v[64:67], v[240:243]
    s_waitcnt lgkmcnt(6)
    v_mfma_f32_16x16x32_bf16 v[96:99], v[32:35], v[48:51], v[96:99]
    ds_read_b64_tr_b16 v[64:65], v6 offset:34880
    v_and_b32 v12, 3, v1
    v_mfma_f32_16x16x32_bf16 v[100:103], v[36:39], v[48:51], v[100:103]
    ds_read_b64_tr_b16 v[66:67], v6 offset:36672
    v_bfe_u32 v13, v1, 3, 1
    v_mfma_f32_16x16x32_bf16 v[104:107], v[40:43], v[48:51], v[104:107]
    v_lshl_or_b32 v12, v13, 2, v12
    v_mfma_f32_16x16x32_bf16 v[108:111], v[44:47], v[48:51], v[108:111]
    v_bfe_u32 v13, v1, 2, 1
    s_waitcnt lgkmcnt(6)
    v_mfma_f32_16x16x32_bf16 v[124:127], v[44:47], v[52:55], v[124:127]
    ds_read_b64_tr_b16 v[48:49], v6 offset:42048
    v_lshl_or_b32 v12, v13, 3, v12
    v_mfma_f32_16x16x32_bf16 v[120:123], v[40:43], v[52:55], v[120:123]
    ds_read_b64_tr_b16 v[50:51], v6 offset:43840
    v_and_b32 v13, 48, v1
    v_mfma_f32_16x16x32_bf16 v[116:119], v[36:39], v[52:55], v[116:119]
    v_or_b32 v12, v12, v13
    v_mfma_f32_16x16x32_bf16 v[112:115], v[32:35], v[52:55], v[112:115]
    v_lshlrev_b32 v10, 4, v12
    s_waitcnt lgkmcnt(6)
    v_mfma_f32_16x16x32_bf16 v[128:131], v[32:35], v[56:59], v[128:131]
    ds_read_b64_tr_b16 v[52:53], v6 offset:34912
    v_xor_b32 v11, 128, v10
    v_mfma_f32_16x16x32_bf16 v[132:135], v[36:39], v[56:59], v[132:135]
    ds_read_b64_tr_b16 v[54:55], v6 offset:36704
    v_add_u32 v11, 1024, v11
    v_mfma_f32_16x16x32_bf16 v[136:139], v[40:43], v[56:59], v[136:139]
    v_and_b32 v12, 15, v1
    v_mfma_f32_16x16x32_bf16 v[140:143], v[44:47], v[56:59], v[140:143]
    v_lshlrev_b32 v12, 4, v12
    s_waitcnt lgkmcnt(6)
    v_mfma_f32_16x16x32_bf16 v[156:159], v[44:47], v[60:63], v[156:159]
    ds_read_b64_tr_b16 v[56:57], v6 offset:42080
    v_add_u32 v13, 139264, v12
    v_mfma_f32_16x16x32_bf16 v[152:155], v[40:43], v[60:63], v[152:155]
    ds_read_b64_tr_b16 v[58:59], v6 offset:43872
    s_lshl_b32 s3, s26, 8
    v_mfma_f32_16x16x32_bf16 v[148:151], v[36:39], v[60:63], v[148:151]
    v_add_u32 v14, s3, v13
    v_mfma_f32_16x16x32_bf16 v[144:147], v[32:35], v[60:63], v[144:147]
    s_waitcnt lgkmcnt(6)
    v_mfma_f32_16x16x32_bf16 v[160:163], v[32:35], v[64:67], v[160:163]
    ds_read_b64_tr_b16 v[60:61], v6 offset:34944
    v_mfma_f32_16x16x32_bf16 v[164:167], v[36:39], v[64:67], v[164:167]
    ds_read_b64_tr_b16 v[62:63], v6 offset:36736
    v_mfma_f32_16x16x32_bf16 v[168:171], v[40:43], v[64:67], v[168:171]
    v_mfma_f32_16x16x32_bf16 v[172:175], v[44:47], v[64:67], v[172:175]
    s_waitcnt lgkmcnt(6)
    v_mfma_f32_16x16x32_bf16 v[188:191], v[44:47], v[48:51], v[188:191]
    ds_read_b64_tr_b16 v[64:65], v6 offset:42112
    v_mfma_f32_16x16x32_bf16 v[184:187], v[40:43], v[48:51], v[184:187]
    ds_read_b64_tr_b16 v[66:67], v6 offset:43904
    v_mfma_f32_16x16x32_bf16 v[180:183], v[36:39], v[48:51], v[180:183]
    v_mfma_f32_16x16x32_bf16 v[176:179], v[32:35], v[48:51], v[176:179]
    s_waitcnt lgkmcnt(6)
    v_mfma_f32_16x16x32_bf16 v[192:195], v[32:35], v[52:55], v[192:195]
    v_mfma_f32_16x16x32_bf16 v[196:199], v[36:39], v[52:55], v[196:199]
    v_mfma_f32_16x16x32_bf16 v[200:203], v[40:43], v[52:55], v[200:203]
    v_mfma_f32_16x16x32_bf16 v[204:207], v[44:47], v[52:55], v[204:207]
    s_waitcnt vmcnt(2) lgkmcnt(0)
    s_barrier
    v_mfma_f32_16x16x32_bf16 v[220:223], v[44:47], v[56:59], v[220:223]
    ds_read_b128 v[16:19], v5 offset:0
    ds_read_b128 v[20:23], v5 offset:1024
    v_mfma_f32_16x16x32_bf16 v[216:219], v[40:43], v[56:59], v[216:219]
    ds_read_b128 v[24:27], v5 offset:2048
    ds_read_b128 v[28:31], v5 offset:3072
    v_mfma_f32_16x16x32_bf16 v[212:215], v[36:39], v[56:59], v[212:215]
    ds_read_b64_tr_b16 v[48:49], v7 offset:0
    ds_read_b64_tr_b16 v[50:51], v7 offset:1792
    v_mfma_f32_16x16x32_bf16 v[208:211], v[32:35], v[56:59], v[208:211]
    ds_read_b64_tr_b16 v[52:53], v7 offset:7168
    ds_read_b64_tr_b16 v[54:55], v7 offset:8960
    v_mfma_f32_16x16x32_bf16 v[224:227], v[32:35], v[60:63], v[224:227]
    ds_read_b64_tr_b16 v[56:57], v7 offset:32
    v_mfma_f32_16x16x32_bf16 v[228:231], v[36:39], v[60:63], v[228:231]
    ds_read_b64_tr_b16 v[58:59], v7 offset:1824
    v_mfma_f32_16x16x32_bf16 v[232:235], v[40:43], v[60:63], v[232:235]
    v_mfma_f32_16x16x32_bf16 v[236:239], v[44:47], v[60:63], v[236:239]
    v_mfma_f32_16x16x32_bf16 v[252:255], v[44:47], v[64:67], v[252:255]
    ds_read_b64_tr_b16 v[60:61], v7 offset:7200
    v_mfma_f32_16x16x32_bf16 v[248:251], v[40:43], v[64:67], v[248:251]
    ds_read_b64_tr_b16 v[62:63], v7 offset:8992
    v_mfma_f32_16x16x32_bf16 v[244:247], v[36:39], v[64:67], v[244:247]
    v_mfma_f32_16x16x32_bf16 v[240:243], v[32:35], v[64:67], v[240:243]
    s_waitcnt lgkmcnt(6)
    v_mfma_f32_16x16x32_bf16 v[96:99], v[16:19], v[48:51], v[96:99]
    ds_read_b64_tr_b16 v[64:65], v7 offset:64
    v_mfma_f32_16x16x32_bf16 v[100:103], v[20:23], v[48:51], v[100:103]
    ds_read_b64_tr_b16 v[66:67], v7 offset:1856
    v_mfma_f32_16x16x32_bf16 v[104:107], v[24:27], v[48:51], v[104:107]
    v_mfma_f32_16x16x32_bf16 v[108:111], v[28:31], v[48:51], v[108:111]
    s_waitcnt lgkmcnt(6)
    v_mfma_f32_16x16x32_bf16 v[124:127], v[28:31], v[52:55], v[124:127]
    ds_read_b64_tr_b16 v[48:49], v7 offset:7232
    v_mfma_f32_16x16x32_bf16 v[120:123], v[24:27], v[52:55], v[120:123]
    ds_read_b64_tr_b16 v[50:51], v7 offset:9024
    v_mfma_f32_16x16x32_bf16 v[116:119], v[20:23], v[52:55], v[116:119]
    v_mfma_f32_16x16x32_bf16 v[112:115], v[16:19], v[52:55], v[112:115]
    s_waitcnt lgkmcnt(6)
    v_mfma_f32_16x16x32_bf16 v[128:131], v[16:19], v[56:59], v[128:131]
    ds_read_b64_tr_b16 v[52:53], v7 offset:96
    v_mfma_f32_16x16x32_bf16 v[132:135], v[20:23], v[56:59], v[132:135]
    ds_read_b64_tr_b16 v[54:55], v7 offset:1888
    v_mfma_f32_16x16x32_bf16 v[136:139], v[24:27], v[56:59], v[136:139]
    v_mfma_f32_16x16x32_bf16 v[140:143], v[28:31], v[56:59], v[140:143]
    s_waitcnt lgkmcnt(6)
    v_mfma_f32_16x16x32_bf16 v[156:159], v[28:31], v[60:63], v[156:159]
    ds_read_b64_tr_b16 v[56:57], v7 offset:7264
    v_mfma_f32_16x16x32_bf16 v[152:155], v[24:27], v[60:63], v[152:155]
    ds_read_b64_tr_b16 v[58:59], v7 offset:9056
    v_mfma_f32_16x16x32_bf16 v[148:151], v[20:23], v[60:63], v[148:151]
    v_mfma_f32_16x16x32_bf16 v[144:147], v[16:19], v[60:63], v[144:147]
    s_waitcnt lgkmcnt(6)
    v_mfma_f32_16x16x32_bf16 v[160:163], v[16:19], v[64:67], v[160:163]
    ds_read_b64_tr_b16 v[60:61], v7 offset:128
    v_mfma_f32_16x16x32_bf16 v[164:167], v[20:23], v[64:67], v[164:167]
    ds_read_b64_tr_b16 v[62:63], v7 offset:1920
    v_mfma_f32_16x16x32_bf16 v[168:171], v[24:27], v[64:67], v[168:171]
    v_mfma_f32_16x16x32_bf16 v[172:175], v[28:31], v[64:67], v[172:175]
    s_waitcnt lgkmcnt(6)
    v_mfma_f32_16x16x32_bf16 v[188:191], v[28:31], v[48:51], v[188:191]
    ds_read_b64_tr_b16 v[64:65], v7 offset:7296
    v_mfma_f32_16x16x32_bf16 v[184:187], v[24:27], v[48:51], v[184:187]
    ds_read_b64_tr_b16 v[66:67], v7 offset:9088
    v_mfma_f32_16x16x32_bf16 v[180:183], v[20:23], v[48:51], v[180:183]
    v_mfma_f32_16x16x32_bf16 v[176:179], v[16:19], v[48:51], v[176:179]
    s_waitcnt lgkmcnt(6)
    v_mfma_f32_16x16x32_bf16 v[192:195], v[16:19], v[52:55], v[192:195]
    v_mfma_f32_16x16x32_bf16 v[196:199], v[20:23], v[52:55], v[196:199]
    v_mfma_f32_16x16x32_bf16 v[200:203], v[24:27], v[52:55], v[200:203]
    v_mfma_f32_16x16x32_bf16 v[204:207], v[28:31], v[52:55], v[204:207]
    s_waitcnt lgkmcnt(4)
    v_mfma_f32_16x16x32_bf16 v[220:223], v[28:31], v[56:59], v[220:223]
    ds_read_b128 v[32:35], v5 offset:34816
    ds_read_b128 v[36:39], v5 offset:35840
    v_mfma_f32_16x16x32_bf16 v[216:219], v[24:27], v[56:59], v[216:219]
    ds_read_b128 v[40:43], v5 offset:36864
    ds_read_b128 v[44:47], v5 offset:37888
    v_mfma_f32_16x16x32_bf16 v[212:215], v[20:23], v[56:59], v[212:215]
    ds_read_b64_tr_b16 v[48:49], v7 offset:34816
    ds_read_b64_tr_b16 v[50:51], v7 offset:36608
    v_mfma_f32_16x16x32_bf16 v[208:211], v[16:19], v[56:59], v[208:211]
    ds_read_b64_tr_b16 v[52:53], v7 offset:41984
    ds_read_b64_tr_b16 v[54:55], v7 offset:43776
    s_waitcnt lgkmcnt(10)
    v_mfma_f32_16x16x32_bf16 v[224:227], v[16:19], v[60:63], v[224:227]
    ds_read_b64_tr_b16 v[56:57], v7 offset:34848
    v_mfma_f32_16x16x32_bf16 v[228:231], v[20:23], v[60:63], v[228:231]
    ds_read_b64_tr_b16 v[58:59], v7 offset:36640
    v_mfma_f32_16x16x32_bf16 v[232:235], v[24:27], v[60:63], v[232:235]
    v_mfma_f32_16x16x32_bf16 v[236:239], v[28:31], v[60:63], v[236:239]
    s_waitcnt lgkmcnt(10)
    v_mfma_f32_16x16x32_bf16 v[252:255], v[28:31], v[64:67], v[252:255]
    ds_read_b64_tr_b16 v[60:61], v7 offset:42016
    v_mfma_f32_16x16x32_bf16 v[248:251], v[24:27], v[64:67], v[248:251]
    ds_read_b64_tr_b16 v[62:63], v7 offset:43808
    v_mfma_f32_16x16x32_bf16 v[244:247], v[20:23], v[64:67], v[244:247]
    v_mfma_f32_16x16x32_bf16 v[240:243], v[16:19], v[64:67], v[240:243]
    s_waitcnt lgkmcnt(6)
    v_mfma_f32_16x16x32_bf16 v[96:99], v[32:35], v[48:51], v[96:99]
    ds_read_b64_tr_b16 v[64:65], v7 offset:34880
    v_mfma_f32_16x16x32_bf16 v[100:103], v[36:39], v[48:51], v[100:103]
    ds_read_b64_tr_b16 v[66:67], v7 offset:36672
    v_mfma_f32_16x16x32_bf16 v[104:107], v[40:43], v[48:51], v[104:107]
    v_mfma_f32_16x16x32_bf16 v[108:111], v[44:47], v[48:51], v[108:111]
    s_waitcnt lgkmcnt(6)
    v_mfma_f32_16x16x32_bf16 v[124:127], v[44:47], v[52:55], v[124:127]
    ds_read_b64_tr_b16 v[48:49], v7 offset:42048
    v_mfma_f32_16x16x32_bf16 v[120:123], v[40:43], v[52:55], v[120:123]
    ds_read_b64_tr_b16 v[50:51], v7 offset:43840
    v_mfma_f32_16x16x32_bf16 v[116:119], v[36:39], v[52:55], v[116:119]
    v_mfma_f32_16x16x32_bf16 v[112:115], v[32:35], v[52:55], v[112:115]
    s_waitcnt lgkmcnt(6)
    v_mfma_f32_16x16x32_bf16 v[128:131], v[32:35], v[56:59], v[128:131]
    ds_read_b64_tr_b16 v[52:53], v7 offset:34912
    v_mfma_f32_16x16x32_bf16 v[132:135], v[36:39], v[56:59], v[132:135]
    ds_read_b64_tr_b16 v[54:55], v7 offset:36704
    v_mfma_f32_16x16x32_bf16 v[136:139], v[40:43], v[56:59], v[136:139]
    v_mfma_f32_16x16x32_bf16 v[140:143], v[44:47], v[56:59], v[140:143]
    s_waitcnt lgkmcnt(6)
    v_mfma_f32_16x16x32_bf16 v[156:159], v[44:47], v[60:63], v[156:159]
    ds_read_b64_tr_b16 v[56:57], v7 offset:42080
    v_mfma_f32_16x16x32_bf16 v[152:155], v[40:43], v[60:63], v[152:155]
    ds_read_b64_tr_b16 v[58:59], v7 offset:43872
    v_mfma_f32_16x16x32_bf16 v[148:151], v[36:39], v[60:63], v[148:151]
    v_mfma_f32_16x16x32_bf16 v[144:147], v[32:35], v[60:63], v[144:147]
    s_waitcnt lgkmcnt(6)
    v_mfma_f32_16x16x32_bf16 v[160:163], v[32:35], v[64:67], v[160:163]
    ds_read_b64_tr_b16 v[60:61], v7 offset:34944
    v_mfma_f32_16x16x32_bf16 v[164:167], v[36:39], v[64:67], v[164:167]
    ds_read_b64_tr_b16 v[62:63], v7 offset:36736
    v_mfma_f32_16x16x32_bf16 v[168:171], v[40:43], v[64:67], v[168:171]
    v_mfma_f32_16x16x32_bf16 v[172:175], v[44:47], v[64:67], v[172:175]
    s_waitcnt lgkmcnt(6)
    v_mfma_f32_16x16x32_bf16 v[188:191], v[44:47], v[48:51], v[188:191]
    ds_read_b64_tr_b16 v[64:65], v7 offset:42112
    v_mfma_f32_16x16x32_bf16 v[184:187], v[40:43], v[48:51], v[184:187]
    ds_read_b64_tr_b16 v[66:67], v7 offset:43904
    v_mfma_f32_16x16x32_bf16 v[180:183], v[36:39], v[48:51], v[180:183]
    v_mfma_f32_16x16x32_bf16 v[176:179], v[32:35], v[48:51], v[176:179]
    s_waitcnt lgkmcnt(6)
    v_mfma_f32_16x16x32_bf16 v[192:195], v[32:35], v[52:55], v[192:195]
    v_mfma_f32_16x16x32_bf16 v[196:199], v[36:39], v[52:55], v[196:199]
    v_mfma_f32_16x16x32_bf16 v[200:203], v[40:43], v[52:55], v[200:203]
    v_mfma_f32_16x16x32_bf16 v[204:207], v[44:47], v[52:55], v[204:207]
    s_waitcnt lgkmcnt(4)
    v_mfma_f32_16x16x32_bf16 v[220:223], v[44:47], v[56:59], v[220:223]
    v_mfma_f32_16x16x32_bf16 v[216:219], v[40:43], v[56:59], v[216:219]
    v_mfma_f32_16x16x32_bf16 v[212:215], v[36:39], v[56:59], v[212:215]
    v_mfma_f32_16x16x32_bf16 v[208:211], v[32:35], v[56:59], v[208:211]
    s_waitcnt lgkmcnt(2)
    v_mfma_f32_16x16x32_bf16 v[224:227], v[32:35], v[60:63], v[224:227]
    v_mfma_f32_16x16x32_bf16 v[228:231], v[36:39], v[60:63], v[228:231]
    v_mfma_f32_16x16x32_bf16 v[232:235], v[40:43], v[60:63], v[232:235]
    v_mfma_f32_16x16x32_bf16 v[236:239], v[44:47], v[60:63], v[236:239]
    s_waitcnt lgkmcnt(0)
    v_mfma_f32_16x16x32_bf16 v[252:255], v[44:47], v[64:67], v[252:255]
    v_mfma_f32_16x16x32_bf16 v[248:251], v[40:43], v[64:67], v[248:251]
    v_mfma_f32_16x16x32_bf16 v[244:247], v[36:39], v[64:67], v[244:247]
    v_mfma_f32_16x16x32_bf16 v[240:243], v[32:35], v[64:67], v[240:243]
    v_mov_b32 v36, 0xbdd2d3e8
    v_mov_b32 v37, 0xbdd2d3e8
    v_mov_b32 v38, 0xc0135761
    v_mov_b32 v39, 0xc0135761
    s_lshr_b32 s66, s64, 2
    s_lshl_b32 s66, s66, 18
    s_and_b32 s3, s64, 3
    s_lshl_b32 s3, s3, 12
    s_add_u32 s66, s66, s3
    s_add_u32 s66, s66, s65
    s_add_u32 s64, s64, 1
    v_pk_mul_f32 v[16:17], v[96:97], v[96:97]
    v_pk_mul_f32 v[18:19], v[98:99], v[98:99]
    v_pk_mul_f32 v[20:21], v[100:101], v[100:101]
    v_pk_mul_f32 v[22:23], v[102:103], v[102:103]
    v_pk_fma_f32 v[16:17], v[16:17], v[36:37], v[38:39]
    v_pk_fma_f32 v[18:19], v[18:19], v[36:37], v[38:39]
    v_pk_fma_f32 v[20:21], v[20:21], v[36:37], v[38:39]
    v_pk_fma_f32 v[22:23], v[22:23], v[36:37], v[38:39]
    v_pk_mul_f32 v[16:17], v[16:17], v[96:97]
    v_pk_mul_f32 v[18:19], v[18:19], v[98:99]
    v_pk_mul_f32 v[20:21], v[20:21], v[100:101]
    v_pk_mul_f32 v[22:23], v[22:23], v[102:103]
    v_exp_f32 v16, v16
    v_exp_f32 v17, v17
    v_pk_mul_f32 v[24:25], v[96:97], v[112:113]
    v_exp_f32 v18, v18
    v_exp_f32 v19, v19
    v_pk_mul_f32 v[26:27], v[98:99], v[114:115]
    v_exp_f32 v20, v20
    v_exp_f32 v21, v21
    v_pk_mul_f32 v[28:29], v[100:101], v[116:117]
    v_exp_f32 v22, v22
    v_exp_f32 v23, v23
    v_pk_mul_f32 v[30:31], v[102:103], v[118:119]
    v_pk_add_f32 v[16:17], v[16:17], 1.0 op_sel_hi:[1,0]
    v_pk_add_f32 v[18:19], v[18:19], 1.0 op_sel_hi:[1,0]
    v_pk_add_f32 v[20:21], v[20:21], 1.0 op_sel_hi:[1,0]
    v_pk_add_f32 v[22:23], v[22:23], 1.0 op_sel_hi:[1,0]
    v_rcp_f32 v16, v16
    v_rcp_f32 v17, v17
    v_rcp_f32 v18, v18
    v_rcp_f32 v19, v19
    v_rcp_f32 v20, v20
    v_rcp_f32 v21, v21
    v_rcp_f32 v22, v22
    v_rcp_f32 v23, v23
    v_pk_mul_f32 v[24:25], v[24:25], v[16:17]
    v_pk_mul_f32 v[26:27], v[26:27], v[18:19]
    v_pk_mul_f32 v[28:29], v[28:29], v[20:21]
    v_pk_mul_f32 v[30:31], v[30:31], v[22:23]
    v_cvt_pk_bf16_f32 v96, v24, v25
    v_cvt_pk_bf16_f32 v97, v26, v27
    v_cvt_pk_bf16_f32 v98, v28, v29
    v_cvt_pk_bf16_f32 v99, v30, v31
    buffer_store_dwordx4 v[96:99], v10, s[8:11], s66 offen sc1
    v_pk_mul_f32 v[16:17], v[104:105], v[104:105]
    v_pk_mul_f32 v[18:19], v[106:107], v[106:107]
    v_pk_mul_f32 v[20:21], v[108:109], v[108:109]
    v_pk_mul_f32 v[22:23], v[110:111], v[110:111]
    v_pk_fma_f32 v[16:17], v[16:17], v[36:37], v[38:39]
    v_pk_fma_f32 v[18:19], v[18:19], v[36:37], v[38:39]
    v_pk_fma_f32 v[20:21], v[20:21], v[36:37], v[38:39]
    v_pk_fma_f32 v[22:23], v[22:23], v[36:37], v[38:39]
    v_pk_mul_f32 v[16:17], v[16:17], v[104:105]
    v_pk_mul_f32 v[18:19], v[18:19], v[106:107]
    v_pk_mul_f32 v[20:21], v[20:21], v[108:109]
    v_pk_mul_f32 v[22:23], v[22:23], v[110:111]
    v_exp_f32 v16, v16
    v_exp_f32 v17, v17
    v_pk_mul_f32 v[24:25], v[104:105], v[120:121]
    v_exp_f32 v18, v18
    v_exp_f32 v19, v19
    v_pk_mul_f32 v[26:27], v[106:107], v[122:123]
    v_exp_f32 v20, v20
    v_exp_f32 v21, v21
    v_pk_mul_f32 v[28:29], v[108:109], v[124:125]
    v_exp_f32 v22, v22
    v_exp_f32 v23, v23
    v_pk_mul_f32 v[30:31], v[110:111], v[126:127]
    v_pk_add_f32 v[16:17], v[16:17], 1.0 op_sel_hi:[1,0]
    v_pk_add_f32 v[18:19], v[18:19], 1.0 op_sel_hi:[1,0]
    v_pk_add_f32 v[20:21], v[20:21], 1.0 op_sel_hi:[1,0]
    v_pk_add_f32 v[22:23], v[22:23], 1.0 op_sel_hi:[1,0]
    v_rcp_f32 v16, v16
    v_rcp_f32 v17, v17
    v_rcp_f32 v18, v18
    v_rcp_f32 v19, v19
    v_rcp_f32 v20, v20
    v_rcp_f32 v21, v21
    v_rcp_f32 v22, v22
    v_rcp_f32 v23, v23
    v_pk_mul_f32 v[24:25], v[24:25], v[16:17]
    v_pk_mul_f32 v[26:27], v[26:27], v[18:19]
    v_pk_mul_f32 v[28:29], v[28:29], v[20:21]
    v_pk_mul_f32 v[30:31], v[30:31], v[22:23]
    v_cvt_pk_bf16_f32 v104, v24, v25
    v_cvt_pk_bf16_f32 v105, v26, v27
    v_cvt_pk_bf16_f32 v106, v28, v29
    v_cvt_pk_bf16_f32 v107, v30, v31
    buffer_store_dwordx4 v[104:107], v11, s[8:11], s66 offen sc1
    s_lshr_b32 s66, s64, 2
    s_lshl_b32 s66, s66, 18
    s_and_b32 s3, s64, 3
    s_lshl_b32 s3, s3, 12
    s_add_u32 s66, s66, s3
    s_add_u32 s66, s66, s65
    s_add_u32 s64, s64, 1
    v_pk_mul_f32 v[16:17], v[128:129], v[128:129]
    v_pk_mul_f32 v[18:19], v[130:131], v[130:131]
    v_pk_mul_f32 v[20:21], v[132:133], v[132:133]
    v_pk_mul_f32 v[22:23], v[134:135], v[134:135]
    v_pk_fma_f32 v[16:17], v[16:17], v[36:37], v[38:39]
    v_pk_fma_f32 v[18:19], v[18:19], v[36:37], v[38:39]
    v_pk_fma_f32 v[20:21], v[20:21], v[36:37], v[38:39]
    v_pk_fma_f32 v[22:23], v[22:23], v[36:37], v[38:39]
    v_pk_mul_f32 v[16:17], v[16:17], v[128:129]
    v_pk_mul_f32 v[18:19], v[18:19], v[130:131]
    v_pk_mul_f32 v[20:21], v[20:21], v[132:133]
    v_pk_mul_f32 v[22:23], v[22:23], v[134:135]
    v_exp_f32 v16, v16
    v_exp_f32 v17, v17
    v_pk_mul_f32 v[24:25], v[128:129], v[144:145]
    v_exp_f32 v18, v18
    v_exp_f32 v19, v19
    v_pk_mul_f32 v[26:27], v[130:131], v[146:147]
    v_exp_f32 v20, v20
    v_exp_f32 v21, v21
    v_pk_mul_f32 v[28:29], v[132:133], v[148:149]
    v_exp_f32 v22, v22
    v_exp_f32 v23, v23
    v_pk_mul_f32 v[30:31], v[134:135], v[150:151]
    v_pk_add_f32 v[16:17], v[16:17], 1.0 op_sel_hi:[1,0]
    v_pk_add_f32 v[18:19], v[18:19], 1.0 op_sel_hi:[1,0]
    v_pk_add_f32 v[20:21], v[20:21], 1.0 op_sel_hi:[1,0]
    v_pk_add_f32 v[22:23], v[22:23], 1.0 op_sel_hi:[1,0]
    v_rcp_f32 v16, v16
    v_rcp_f32 v17, v17
    v_rcp_f32 v18, v18
    v_rcp_f32 v19, v19
    v_rcp_f32 v20, v20
    v_rcp_f32 v21, v21
    v_rcp_f32 v22, v22
    v_rcp_f32 v23, v23
    v_pk_mul_f32 v[24:25], v[24:25], v[16:17]
    v_pk_mul_f32 v[26:27], v[26:27], v[18:19]
    v_pk_mul_f32 v[28:29], v[28:29], v[20:21]
    v_pk_mul_f32 v[30:31], v[30:31], v[22:23]
    v_cvt_pk_bf16_f32 v128, v24, v25
    v_cvt_pk_bf16_f32 v129, v26, v27
    v_cvt_pk_bf16_f32 v130, v28, v29
    v_cvt_pk_bf16_f32 v131, v30, v31
    buffer_store_dwordx4 v[128:131], v10, s[8:11], s66 offen sc1
    v_pk_mul_f32 v[16:17], v[136:137], v[136:137]
    v_pk_mul_f32 v[18:19], v[138:139], v[138:139]
    v_pk_mul_f32 v[20:21], v[140:141], v[140:141]
    v_pk_mul_f32 v[22:23], v[142:143], v[142:143]
    v_pk_fma_f32 v[16:17], v[16:17], v[36:37], v[38:39]
    v_pk_fma_f32 v[18:19], v[18:19], v[36:37], v[38:39]
    v_pk_fma_f32 v[20:21], v[20:21], v[36:37], v[38:39]
    v_pk_fma_f32 v[22:23], v[22:23], v[36:37], v[38:39]
    v_pk_mul_f32 v[16:17], v[16:17], v[136:137]
    v_pk_mul_f32 v[18:19], v[18:19], v[138:139]
    v_pk_mul_f32 v[20:21], v[20:21], v[140:141]
    v_pk_mul_f32 v[22:23], v[22:23], v[142:143]
    v_exp_f32 v16, v16
    v_exp_f32 v17, v17
    v_pk_mul_f32 v[24:25], v[136:137], v[152:153]
    v_exp_f32 v18, v18
    v_exp_f32 v19, v19
    v_pk_mul_f32 v[26:27], v[138:139], v[154:155]
    v_exp_f32 v20, v20
    v_exp_f32 v21, v21
    v_pk_mul_f32 v[28:29], v[140:141], v[156:157]
    v_exp_f32 v22, v22
    v_exp_f32 v23, v23
    v_pk_mul_f32 v[30:31], v[142:143], v[158:159]
    v_pk_add_f32 v[16:17], v[16:17], 1.0 op_sel_hi:[1,0]
    v_pk_add_f32 v[18:19], v[18:19], 1.0 op_sel_hi:[1,0]
    v_pk_add_f32 v[20:21], v[20:21], 1.0 op_sel_hi:[1,0]
    v_pk_add_f32 v[22:23], v[22:23], 1.0 op_sel_hi:[1,0]
    v_rcp_f32 v16, v16
    v_rcp_f32 v17, v17
    v_rcp_f32 v18, v18
    v_rcp_f32 v19, v19
    v_rcp_f32 v20, v20
    v_rcp_f32 v21, v21
    v_rcp_f32 v22, v22
    v_rcp_f32 v23, v23
    v_pk_mul_f32 v[24:25], v[24:25], v[16:17]
    v_pk_mul_f32 v[26:27], v[26:27], v[18:19]
    v_pk_mul_f32 v[28:29], v[28:29], v[20:21]
    v_pk_mul_f32 v[30:31], v[30:31], v[22:23]
    v_cvt_pk_bf16_f32 v136, v24, v25
    v_cvt_pk_bf16_f32 v137, v26, v27
    v_cvt_pk_bf16_f32 v138, v28, v29
    v_cvt_pk_bf16_f32 v139, v30, v31
    buffer_store_dwordx4 v[136:139], v11, s[8:11], s66 offen sc1
    s_lshr_b32 s66, s64, 2
    s_lshl_b32 s66, s66, 18
    s_and_b32 s3, s64, 3
    s_lshl_b32 s3, s3, 12
    s_add_u32 s66, s66, s3
    s_add_u32 s66, s66, s65
    s_add_u32 s64, s64, 1
    v_pk_mul_f32 v[16:17], v[160:161], v[160:161]
    v_pk_mul_f32 v[18:19], v[162:163], v[162:163]
    v_pk_mul_f32 v[20:21], v[164:165], v[164:165]
    v_pk_mul_f32 v[22:23], v[166:167], v[166:167]
    v_pk_fma_f32 v[16:17], v[16:17], v[36:37], v[38:39]
    v_pk_fma_f32 v[18:19], v[18:19], v[36:37], v[38:39]
    v_pk_fma_f32 v[20:21], v[20:21], v[36:37], v[38:39]
    v_pk_fma_f32 v[22:23], v[22:23], v[36:37], v[38:39]
    v_pk_mul_f32 v[16:17], v[16:17], v[160:161]
    v_pk_mul_f32 v[18:19], v[18:19], v[162:163]
    v_pk_mul_f32 v[20:21], v[20:21], v[164:165]
    v_pk_mul_f32 v[22:23], v[22:23], v[166:167]
    v_exp_f32 v16, v16
    v_exp_f32 v17, v17
    v_pk_mul_f32 v[24:25], v[160:161], v[176:177]
    v_exp_f32 v18, v18
    v_exp_f32 v19, v19
    v_pk_mul_f32 v[26:27], v[162:163], v[178:179]
    v_exp_f32 v20, v20
    v_exp_f32 v21, v21
    v_pk_mul_f32 v[28:29], v[164:165], v[180:181]
    v_exp_f32 v22, v22
    v_exp_f32 v23, v23
    v_pk_mul_f32 v[30:31], v[166:167], v[182:183]
    v_pk_add_f32 v[16:17], v[16:17], 1.0 op_sel_hi:[1,0]
    v_pk_add_f32 v[18:19], v[18:19], 1.0 op_sel_hi:[1,0]
    v_pk_add_f32 v[20:21], v[20:21], 1.0 op_sel_hi:[1,0]
    v_pk_add_f32 v[22:23], v[22:23], 1.0 op_sel_hi:[1,0]
    v_rcp_f32 v16, v16
    v_rcp_f32 v17, v17
    v_rcp_f32 v18, v18
    v_rcp_f32 v19, v19
    v_rcp_f32 v20, v20
    v_rcp_f32 v21, v21
    v_rcp_f32 v22, v22
    v_rcp_f32 v23, v23
    v_pk_mul_f32 v[24:25], v[24:25], v[16:17]
    v_pk_mul_f32 v[26:27], v[26:27], v[18:19]
    v_pk_mul_f32 v[28:29], v[28:29], v[20:21]
    v_pk_mul_f32 v[30:31], v[30:31], v[22:23]
    v_cvt_pk_bf16_f32 v160, v24, v25
    v_cvt_pk_bf16_f32 v161, v26, v27
    v_cvt_pk_bf16_f32 v162, v28, v29
    v_cvt_pk_bf16_f32 v163, v30, v31
    buffer_store_dwordx4 v[160:163], v10, s[8:11], s66 offen sc1
    v_pk_mul_f32 v[16:17], v[168:169], v[168:169]
    v_pk_mul_f32 v[18:19], v[170:171], v[170:171]
    v_pk_mul_f32 v[20:21], v[172:173], v[172:173]
    v_pk_mul_f32 v[22:23], v[174:175], v[174:175]
    v_pk_fma_f32 v[16:17], v[16:17], v[36:37], v[38:39]
    v_pk_fma_f32 v[18:19], v[18:19], v[36:37], v[38:39]
    v_pk_fma_f32 v[20:21], v[20:21], v[36:37], v[38:39]
    v_pk_fma_f32 v[22:23], v[22:23], v[36:37], v[38:39]
    v_pk_mul_f32 v[16:17], v[16:17], v[168:169]
    v_pk_mul_f32 v[18:19], v[18:19], v[170:171]
    v_pk_mul_f32 v[20:21], v[20:21], v[172:173]
    v_pk_mul_f32 v[22:23], v[22:23], v[174:175]
    v_exp_f32 v16, v16
    v_exp_f32 v17, v17
    v_pk_mul_f32 v[24:25], v[168:169], v[184:185]
    v_exp_f32 v18, v18
    v_exp_f32 v19, v19
    v_pk_mul_f32 v[26:27], v[170:171], v[186:187]
    v_exp_f32 v20, v20
    v_exp_f32 v21, v21
    v_pk_mul_f32 v[28:29], v[172:173], v[188:189]
    v_exp_f32 v22, v22
    v_exp_f32 v23, v23
    v_pk_mul_f32 v[30:31], v[174:175], v[190:191]
    v_pk_add_f32 v[16:17], v[16:17], 1.0 op_sel_hi:[1,0]
    v_pk_add_f32 v[18:19], v[18:19], 1.0 op_sel_hi:[1,0]
    v_pk_add_f32 v[20:21], v[20:21], 1.0 op_sel_hi:[1,0]
    v_pk_add_f32 v[22:23], v[22:23], 1.0 op_sel_hi:[1,0]
    v_rcp_f32 v16, v16
    v_rcp_f32 v17, v17
    v_rcp_f32 v18, v18
    v_rcp_f32 v19, v19
    v_rcp_f32 v20, v20
    v_rcp_f32 v21, v21
    v_rcp_f32 v22, v22
    v_rcp_f32 v23, v23
    v_pk_mul_f32 v[24:25], v[24:25], v[16:17]
    v_pk_mul_f32 v[26:27], v[26:27], v[18:19]
    v_pk_mul_f32 v[28:29], v[28:29], v[20:21]
    v_pk_mul_f32 v[30:31], v[30:31], v[22:23]
    v_cvt_pk_bf16_f32 v168, v24, v25
    v_cvt_pk_bf16_f32 v169, v26, v27
    v_cvt_pk_bf16_f32 v170, v28, v29
    v_cvt_pk_bf16_f32 v171, v30, v31
    buffer_store_dwordx4 v[168:171], v11, s[8:11], s66 offen sc1
    s_lshr_b32 s66, s64, 2
    s_lshl_b32 s66, s66, 18
    s_and_b32 s3, s64, 3
    s_lshl_b32 s3, s3, 12
    s_add_u32 s66, s66, s3
    s_add_u32 s66, s66, s65
    s_add_u32 s64, s64, 1
    v_pk_mul_f32 v[16:17], v[192:193], v[192:193]
    v_pk_mul_f32 v[18:19], v[194:195], v[194:195]
    v_pk_mul_f32 v[20:21], v[196:197], v[196:197]
    v_pk_mul_f32 v[22:23], v[198:199], v[198:199]
    v_pk_fma_f32 v[16:17], v[16:17], v[36:37], v[38:39]
    v_pk_fma_f32 v[18:19], v[18:19], v[36:37], v[38:39]
    v_pk_fma_f32 v[20:21], v[20:21], v[36:37], v[38:39]
    v_pk_fma_f32 v[22:23], v[22:23], v[36:37], v[38:39]
    v_pk_mul_f32 v[16:17], v[16:17], v[192:193]
    v_pk_mul_f32 v[18:19], v[18:19], v[194:195]
    v_pk_mul_f32 v[20:21], v[20:21], v[196:197]
    v_pk_mul_f32 v[22:23], v[22:23], v[198:199]
    v_exp_f32 v16, v16
    v_exp_f32 v17, v17
    v_pk_mul_f32 v[24:25], v[192:193], v[208:209]
    v_exp_f32 v18, v18
    v_exp_f32 v19, v19
    v_pk_mul_f32 v[26:27], v[194:195], v[210:211]
    v_exp_f32 v20, v20
    v_exp_f32 v21, v21
    v_pk_mul_f32 v[28:29], v[196:197], v[212:213]
    v_exp_f32 v22, v22
    v_exp_f32 v23, v23
    v_pk_mul_f32 v[30:31], v[198:199], v[214:215]
    v_pk_add_f32 v[16:17], v[16:17], 1.0 op_sel_hi:[1,0]
    v_pk_add_f32 v[18:19], v[18:19], 1.0 op_sel_hi:[1,0]
    v_pk_add_f32 v[20:21], v[20:21], 1.0 op_sel_hi:[1,0]
    v_pk_add_f32 v[22:23], v[22:23], 1.0 op_sel_hi:[1,0]
    v_rcp_f32 v16, v16
    v_rcp_f32 v17, v17
    v_rcp_f32 v18, v18
    v_rcp_f32 v19, v19
    v_rcp_f32 v20, v20
    v_rcp_f32 v21, v21
    v_rcp_f32 v22, v22
    v_rcp_f32 v23, v23
    v_pk_mul_f32 v[24:25], v[24:25], v[16:17]
    v_pk_mul_f32 v[26:27], v[26:27], v[18:19]
    v_pk_mul_f32 v[28:29], v[28:29], v[20:21]
    v_pk_mul_f32 v[30:31], v[30:31], v[22:23]
    v_cvt_pk_bf16_f32 v192, v24, v25
    v_cvt_pk_bf16_f32 v193, v26, v27
    v_cvt_pk_bf16_f32 v194, v28, v29
    v_cvt_pk_bf16_f32 v195, v30, v31
    buffer_store_dwordx4 v[192:195], v10, s[8:11], s66 offen sc1
    v_pk_mul_f32 v[16:17], v[200:201], v[200:201]
    v_pk_mul_f32 v[18:19], v[202:203], v[202:203]
    v_pk_mul_f32 v[20:21], v[204:205], v[204:205]
    v_pk_mul_f32 v[22:23], v[206:207], v[206:207]
    v_pk_fma_f32 v[16:17], v[16:17], v[36:37], v[38:39]
    v_pk_fma_f32 v[18:19], v[18:19], v[36:37], v[38:39]
    v_pk_fma_f32 v[20:21], v[20:21], v[36:37], v[38:39]
    v_pk_fma_f32 v[22:23], v[22:23], v[36:37], v[38:39]
    v_pk_mul_f32 v[16:17], v[16:17], v[200:201]
    v_pk_mul_f32 v[18:19], v[18:19], v[202:203]
    v_pk_mul_f32 v[20:21], v[20:21], v[204:205]
    v_pk_mul_f32 v[22:23], v[22:23], v[206:207]
    v_exp_f32 v16, v16
    v_exp_f32 v17, v17
    v_pk_mul_f32 v[24:25], v[200:201], v[216:217]
    v_exp_f32 v18, v18
    v_exp_f32 v19, v19
    v_pk_mul_f32 v[26:27], v[202:203], v[218:219]
    v_exp_f32 v20, v20
    v_exp_f32 v21, v21
    v_pk_mul_f32 v[28:29], v[204:205], v[220:221]
    v_exp_f32 v22, v22
    v_exp_f32 v23, v23
    v_pk_mul_f32 v[30:31], v[206:207], v[222:223]
    v_pk_add_f32 v[16:17], v[16:17], 1.0 op_sel_hi:[1,0]
    v_pk_add_f32 v[18:19], v[18:19], 1.0 op_sel_hi:[1,0]
    v_pk_add_f32 v[20:21], v[20:21], 1.0 op_sel_hi:[1,0]
    v_pk_add_f32 v[22:23], v[22:23], 1.0 op_sel_hi:[1,0]
    v_rcp_f32 v16, v16
    v_rcp_f32 v17, v17
    v_rcp_f32 v18, v18
    v_rcp_f32 v19, v19
    v_rcp_f32 v20, v20
    v_rcp_f32 v21, v21
    v_rcp_f32 v22, v22
    v_rcp_f32 v23, v23
    v_pk_mul_f32 v[24:25], v[24:25], v[16:17]
    v_pk_mul_f32 v[26:27], v[26:27], v[18:19]
    v_pk_mul_f32 v[28:29], v[28:29], v[20:21]
    v_pk_mul_f32 v[30:31], v[30:31], v[22:23]
    v_cvt_pk_bf16_f32 v200, v24, v25
    v_cvt_pk_bf16_f32 v201, v26, v27
    v_cvt_pk_bf16_f32 v202, v28, v29
    v_cvt_pk_bf16_f32 v203, v30, v31
    buffer_store_dwordx4 v[200:203], v11, s[8:11], s66 offen sc1
    s_lshr_b32 s66, s64, 2
    s_lshl_b32 s66, s66, 18
    s_and_b32 s3, s64, 3
    s_lshl_b32 s3, s3, 12
    s_add_u32 s66, s66, s3
    s_add_u32 s66, s66, s65
    s_add_u32 s64, s64, 1
    v_pk_mul_f32 v[16:17], v[224:225], v[224:225]
    v_pk_mul_f32 v[18:19], v[226:227], v[226:227]
    v_pk_mul_f32 v[20:21], v[228:229], v[228:229]
    v_pk_mul_f32 v[22:23], v[230:231], v[230:231]
    v_pk_fma_f32 v[16:17], v[16:17], v[36:37], v[38:39]
    v_pk_fma_f32 v[18:19], v[18:19], v[36:37], v[38:39]
    v_pk_fma_f32 v[20:21], v[20:21], v[36:37], v[38:39]
    v_pk_fma_f32 v[22:23], v[22:23], v[36:37], v[38:39]
    v_pk_mul_f32 v[16:17], v[16:17], v[224:225]
    v_pk_mul_f32 v[18:19], v[18:19], v[226:227]
    v_pk_mul_f32 v[20:21], v[20:21], v[228:229]
    v_pk_mul_f32 v[22:23], v[22:23], v[230:231]
    v_exp_f32 v16, v16
    v_exp_f32 v17, v17
    v_pk_mul_f32 v[24:25], v[224:225], v[240:241]
    v_exp_f32 v18, v18
    v_exp_f32 v19, v19
    v_pk_mul_f32 v[26:27], v[226:227], v[242:243]
    v_exp_f32 v20, v20
    v_exp_f32 v21, v21
    v_pk_mul_f32 v[28:29], v[228:229], v[244:245]
    v_exp_f32 v22, v22
    v_exp_f32 v23, v23
    v_pk_mul_f32 v[30:31], v[230:231], v[246:247]
    v_pk_add_f32 v[16:17], v[16:17], 1.0 op_sel_hi:[1,0]
    v_pk_add_f32 v[18:19], v[18:19], 1.0 op_sel_hi:[1,0]
    v_pk_add_f32 v[20:21], v[20:21], 1.0 op_sel_hi:[1,0]
    v_pk_add_f32 v[22:23], v[22:23], 1.0 op_sel_hi:[1,0]
    v_rcp_f32 v16, v16
    v_rcp_f32 v17, v17
    v_rcp_f32 v18, v18
    v_rcp_f32 v19, v19
    v_rcp_f32 v20, v20
    v_rcp_f32 v21, v21
    v_rcp_f32 v22, v22
    v_rcp_f32 v23, v23
    v_pk_mul_f32 v[24:25], v[24:25], v[16:17]
    v_pk_mul_f32 v[26:27], v[26:27], v[18:19]
    v_pk_mul_f32 v[28:29], v[28:29], v[20:21]
    v_pk_mul_f32 v[30:31], v[30:31], v[22:23]
    v_cvt_pk_bf16_f32 v224, v24, v25
    v_cvt_pk_bf16_f32 v225, v26, v27
    v_cvt_pk_bf16_f32 v226, v28, v29
    v_cvt_pk_bf16_f32 v227, v30, v31
    buffer_store_dwordx4 v[224:227], v10, s[8:11], s66 offen sc1
    v_pk_mul_f32 v[16:17], v[232:233], v[232:233]
    v_pk_mul_f32 v[18:19], v[234:235], v[234:235]
    v_pk_mul_f32 v[20:21], v[236:237], v[236:237]
    v_pk_mul_f32 v[22:23], v[238:239], v[238:239]
    v_pk_fma_f32 v[16:17], v[16:17], v[36:37], v[38:39]
    v_pk_fma_f32 v[18:19], v[18:19], v[36:37], v[38:39]
    v_pk_fma_f32 v[20:21], v[20:21], v[36:37], v[38:39]
    v_pk_fma_f32 v[22:23], v[22:23], v[36:37], v[38:39]
    v_pk_mul_f32 v[16:17], v[16:17], v[232:233]
    v_pk_mul_f32 v[18:19], v[18:19], v[234:235]
    v_pk_mul_f32 v[20:21], v[20:21], v[236:237]
    v_pk_mul_f32 v[22:23], v[22:23], v[238:239]
    v_exp_f32 v16, v16
    v_exp_f32 v17, v17
    v_pk_mul_f32 v[24:25], v[232:233], v[248:249]
    v_exp_f32 v18, v18
    v_exp_f32 v19, v19
    v_pk_mul_f32 v[26:27], v[234:235], v[250:251]
    v_exp_f32 v20, v20
    v_exp_f32 v21, v21
    v_pk_mul_f32 v[28:29], v[236:237], v[252:253]
    v_exp_f32 v22, v22
    v_exp_f32 v23, v23
    v_pk_mul_f32 v[30:31], v[238:239], v[254:255]
    v_pk_add_f32 v[16:17], v[16:17], 1.0 op_sel_hi:[1,0]
    v_pk_add_f32 v[18:19], v[18:19], 1.0 op_sel_hi:[1,0]
    v_pk_add_f32 v[20:21], v[20:21], 1.0 op_sel_hi:[1,0]
    v_pk_add_f32 v[22:23], v[22:23], 1.0 op_sel_hi:[1,0]
    v_rcp_f32 v16, v16
    v_rcp_f32 v17, v17
    v_rcp_f32 v18, v18
    v_rcp_f32 v19, v19
    v_rcp_f32 v20, v20
    v_rcp_f32 v21, v21
    v_rcp_f32 v22, v22
    v_rcp_f32 v23, v23
    v_pk_mul_f32 v[24:25], v[24:25], v[16:17]
    v_pk_mul_f32 v[26:27], v[26:27], v[18:19]
    v_pk_mul_f32 v[28:29], v[28:29], v[20:21]
    v_pk_mul_f32 v[30:31], v[30:31], v[22:23]
    v_cvt_pk_bf16_f32 v232, v24, v25
    v_cvt_pk_bf16_f32 v233, v26, v27
    v_cvt_pk_bf16_f32 v234, v28, v29
    v_cvt_pk_bf16_f32 v235, v30, v31
    buffer_store_dwordx4 v[232:235], v11, s[8:11], s66 offen sc1
    s_branch L2_end
L2_kind1:
    v_lshlrev_b32 v10, 2, v1
    s_cmp_eq_u32 s26, 1
    s_cbranch_scc1 L2_in1
    s_cmp_eq_u32 s26, 2
    s_cbranch_scc1 L2_in2
    s_cmp_eq_u32 s26, 3
    s_cbranch_scc1 L2_in3
    s_lshl_b32 s3, s2, 8
    s_add_u32 s3, s3, 4259840
    v_mov_b32 v11, -1
    buffer_store_dword v11, v10, s[8:11], s3 offen sc1
    s_branch L2_in4
L2_in1:
    s_lshl_b32 s3, s2, 5
    s_add_u32 s3, s3, 4390912
    v_mov_b32 v11, 0
    s_mov_b64 exec, 0xff
    buffer_store_dword v11, v10, s[8:11], s3 offen sc1
    s_mov_b64 exec, -1
    s_branch L2_in4
L2_in2:
    s_getpc_b64 s[16:17]
L2_pc:
    s_sub_u32 s16, s16, L2_pc-recurrent_scan__ssm_conv_s5__glu_gated_geglu__prompt_kernel
    s_subb_u32 s17, s17, 0
    s_lshr_b32 s3, s2, 3
    s_lshl_b32 s3, s3, 4
    v_and_b32 v11, 15, v1
    v_add_u32 v11, s3, v11
    v_lshlrev_b32 v11, 7, v11
    s_mov_b32 s3, L3_end-recurrent_scan__ssm_conv_s5__glu_gated_geglu__prompt_kernel
    v_min_u32 v11, s3, v11
    global_load_dword v91, v11, s[16:17]
    s_branch L2_in4
L2_in3:
    s_getreg_b32 s3, hwreg(HW_REG_XCC_ID)
    s_and_b32 s3, s3, 7
    s_lshl_b32 s5, s3, 5
    s_add_u32 s5, s5, 16
    v_mov_b32 v20, 1
    s_mov_b64 exec, 1
    buffer_atomic_add v20, off, s[96:99], s5 sc0 sc1
    s_mov_b64 exec, -1
    s_mov_b32 s79, s3
L2_in4:
    s_lshl_b32 s3, s26, 8
    s_add_u32 s3, s3, 139264
    v_add_u32 v13, s3, v10
    v_mov_b32 v14, -1
    ds_write_b32 v13, v14
    s_cmp_ge_u32 s26, 2
    s_cselect_b32 s4, s40, s38
    s_cselect_b32 s5, s41, s39
    s_mov_b32 s12, s4
    s_and_b32 s13, s5, 0xffff
    s_mov_b32 s14, 2097152
    s_mov_b32 s15, 0x20000
    v_mov_b32 v2, v4
    v_lshrrev_b32 v10, 2, v1
    v_lshrrev_b32 v11, 4, v1
    v_sub_u32 v11, 0, v11
    v_xor_b32 v11, v11, v1
    v_and_b32 v11, 3, v11
    s_and_b32 s4, s26, 1
    s_lshl_b32 s4, s4, 4
    v_add_u32 v10, s4, v10
    v_lshlrev_b32 v10, 11, v10
    v_lshl_add_u32 v3, v11, 4, v10
    s_lshl_b32 s22, s26, 12
    s_lshl_b32 s23, s26, 10
    v_lshrrev_b32 v10, 3, v1
    v_and_b32 v11, 7, v1
    v_xor_b32 v11, v11, v10
    v_add_u32 v10, s4, v10
    v_lshlrev_b32 v10, 11, v10
    v_lshl_add_u32 v3, v11, 4, v10
    v_add_u32 v90, 15360, v3
    s_lshr_b32 s23, s26, 1
    s_mul_i32 s23, s23, 34816
    s_lshl_b32 s3, s4, 7
    s_add_u32 s23, s23, s3
    s_waitcnt vmcnt(1)
    v_lshlrev_b32 v116, 16, v108
    v_and_b32 v117, 0xffff0000, v108
    v_lshlrev_b32 v118, 16, v109
    v_and_b32 v119, 0xffff0000, v109
    v_lshlrev_b32 v120, 16, v110
    v_and_b32 v121, 0xffff0000, v110
    v_lshlrev_b32 v122, 16, v111
    v_and_b32 v123, 0xffff0000, v111
    v_lshlrev_b32 v124, 16, v112
    v_and_b32 v125, 0xffff0000, v112
    v_lshlrev_b32 v126, 16, v113
    v_and_b32 v127, 0xffff0000, v113
    v_lshlrev_b32 v128, 16, v114
    v_and_b32 v129, 0xffff0000, v114
    v_lshlrev_b32 v130, 16, v115
    v_and_b32 v131, 0xffff0000, v115
    v_pk_add_f32 v[132:133], v[116:117], v[118:119]
    v_pk_add_f32 v[134:135], v[120:121], v[122:123]
    v_pk_add_f32 v[132:133], v[132:133], v[124:125]
    v_pk_add_f32 v[134:135], v[134:135], v[126:127]
    v_pk_add_f32 v[132:133], v[132:133], v[128:129]
    v_pk_add_f32 v[134:135], v[134:135], v[130:131]
    v_pk_add_f32 v[132:133], v[132:133], v[134:135]
    v_add_f32 v132, v132, v133
    s_nop 1
    v_add_f32_dpp v132, v132, v132 quad_perm:[1,0,3,2] row_mask:0xf bank_mask:0xf
    s_nop 1
    v_add_f32_dpp v132, v132, v132 quad_perm:[2,3,0,1] row_mask:0xf bank_mask:0xf
    s_nop 1
    v_add_f32_dpp v132, v132, v132 row_half_mirror row_mask:0xf bank_mask:0xf
    v_mul_f32 v136, 0x3c000000, v132
    v_pk_add_f32 v[140:141], v[116:117], v[136:137] op_sel_hi:[1,0] neg_lo:[0,1] neg_hi:[0,1]
    v_pk_add_f32 v[142:143], v[118:119], v[136:137] op_sel_hi:[1,0] neg_lo:[0,1] neg_hi:[0,1]
    v_pk_add_f32 v[144:145], v[120:121], v[136:137] op_sel_hi:[1,0] neg_lo:[0,1] neg_hi:[0,1]
    v_pk_add_f32 v[146:147], v[122:123], v[136:137] op_sel_hi:[1,0] neg_lo:[0,1] neg_hi:[0,1]
    v_pk_add_f32 v[148:149], v[124:125], v[136:137] op_sel_hi:[1,0] neg_lo:[0,1] neg_hi:[0,1]
    v_pk_add_f32 v[150:151], v[126:127], v[136:137] op_sel_hi:[1,0] neg_lo:[0,1] neg_hi:[0,1]
    v_pk_add_f32 v[152:153], v[128:129], v[136:137] op_sel_hi:[1,0] neg_lo:[0,1] neg_hi:[0,1]
    v_pk_add_f32 v[154:155], v[130:131], v[136:137] op_sel_hi:[1,0] neg_lo:[0,1] neg_hi:[0,1]
    v_pk_mul_f32 v[132:133], v[140:141], v[140:141]
    v_pk_mul_f32 v[134:135], v[142:143], v[142:143]
    v_pk_fma_f32 v[132:133], v[144:145], v[144:145], v[132:133]
    v_pk_fma_f32 v[134:135], v[146:147], v[146:147], v[134:135]
    v_pk_fma_f32 v[132:133], v[148:149], v[148:149], v[132:133]
    v_pk_fma_f32 v[134:135], v[150:151], v[150:151], v[134:135]
    v_pk_fma_f32 v[132:133], v[152:153], v[152:153], v[132:133]
    v_pk_fma_f32 v[134:135], v[154:155], v[154:155], v[134:135]
    v_pk_add_f32 v[132:133], v[132:133], v[134:135]
    v_add_f32 v137, v132, v133
    s_nop 1
    v_add_f32_dpp v137, v137, v137 quad_perm:[1,0,3,2] row_mask:0xf bank_mask:0xf
    s_nop 1
    v_add_f32_dpp v137, v137, v137 quad_perm:[2,3,0,1] row_mask:0xf bank_mask:0xf
    s_nop 1
    v_add_f32_dpp v137, v137, v137 row_half_mirror row_mask:0xf bank_mask:0xf
    ds_write_b64 v107, v[136:137]
    s_waitcnt lgkmcnt(0)
    s_barrier
    ds_read_b128 v[140:143], v106 offset:0
    ds_read_b128 v[144:147], v106 offset:16
    ds_read_b128 v[148:151], v106 offset:32
    ds_read_b128 v[152:155], v106 offset:48
    s_waitcnt lgkmcnt(0)
    v_pk_add_f32 v[132:133], v[140:141], v[142:143]
    v_pk_add_f32 v[134:135], v[144:145], v[146:147]
    v_pk_add_f32 v[132:133], v[132:133], v[148:149]
    v_pk_add_f32 v[134:135], v[134:135], v[150:151]
    v_pk_add_f32 v[132:133], v[132:133], v[152:153]
    v_pk_add_f32 v[134:135], v[134:135], v[154:155]
    v_pk_add_f32 v[132:133], v[132:133], v[134:135]
    v_mul_f32 v132, 0x3e000000, v132
    v_mul_f32 v133, 0x3a800000, v133
    v_sub_f32 v140, v140, v132
    v_sub_f32 v142, v142, v132
    v_sub_f32 v144, v144, v132
    v_sub_f32 v146, v146, v132
    v_sub_f32 v148, v148, v132
    v_sub_f32 v150, v150, v132
    v_sub_f32 v152, v152, v132
    v_sub_f32 v154, v154, v132
    v_mul_f32 v134, v140, v140
    v_mul_f32 v135, v142, v142
    v_fmac_f32 v134, v144, v144
    v_fmac_f32 v135, v146, v146
    v_fmac_f32 v134, v148, v148
    v_fmac_f32 v135, v150, v150
    v_fmac_f32 v134, v152, v152
    v_fmac_f32 v135, v154, v154
    v_add_f32 v134, v134, v135
    v_fmac_f32 v133, 0x3e000000, v134
    v_cvt_pk_bf16_f32 v134, v132, v133
    v_lshlrev_b32 v132, 16, v134
    v_and_b32 v133, 0xffff0000, v134
    v_add_f32 v133, 0x3727c5ac, v133
    v_cvt_pk_bf16_f32 v133, v133, v133
    v_and_b32 v133, 0xffff0000, v133
    v_sqrt_f32 v133, v133
    s_nop 0
    v_pk_add_f32 v[116:117], v[116:117], v[132:133] op_sel_hi:[1,0] neg_lo:[0,1] neg_hi:[0,1]
    v_pk_add_f32 v[118:119], v[118:119], v[132:133] op_sel_hi:[1,0] neg_lo:[0,1] neg_hi:[0,1]
    v_pk_add_f32 v[120:121], v[120:121], v[132:133] op_sel_hi:[1,0] neg_lo:[0,1] neg_hi:[0,1]
    v_pk_add_f32 v[122:123], v[122:123], v[132:133] op_sel_hi:[1,0] neg_lo:[0,1] neg_hi:[0,1]
    v_pk_add_f32 v[124:125], v[124:125], v[132:133] op_sel_hi:[1,0] neg_lo:[0,1] neg_hi:[0,1]
    v_pk_add_f32 v[126:127], v[126:127], v[132:133] op_sel_hi:[1,0] neg_lo:[0,1] neg_hi:[0,1]
    v_pk_add_f32 v[128:129], v[128:129], v[132:133] op_sel_hi:[1,0] neg_lo:[0,1] neg_hi:[0,1]
    v_pk_add_f32 v[130:131], v[130:131], v[132:133] op_sel_hi:[1,0] neg_lo:[0,1] neg_hi:[0,1]
    v_cvt_pk_bf16_f32 v133, v133, v133
    v_and_b32 v133, 0xffff0000, v133
    v_rcp_f32 v133, v133
    v_cvt_pk_bf16_f32 v156, v116, v117
    v_cvt_pk_bf16_f32 v157, v118, v119
    v_cvt_pk_bf16_f32 v158, v120, v121
    v_cvt_pk_bf16_f32 v159, v122, v123
    v_cvt_pk_bf16_f32 v160, v124, v125
    v_cvt_pk_bf16_f32 v161, v126, v127
    v_cvt_pk_bf16_f32 v162, v128, v129
    v_cvt_pk_bf16_f32 v163, v130, v131
    v_lshlrev_b32 v116, 16, v156
    v_and_b32 v117, 0xffff0000, v156
    v_lshlrev_b32 v118, 16, v157
    v_and_b32 v119, 0xffff0000, v157
    v_lshlrev_b32 v120, 16, v158
    v_and_b32 v121, 0xffff0000, v158
    v_lshlrev_b32 v122, 16, v159
    v_and_b32 v123, 0xffff0000, v159
    v_lshlrev_b32 v124, 16, v160
    v_and_b32 v125, 0xffff0000, v160
    v_lshlrev_b32 v126, 16, v161
    v_and_b32 v127, 0xffff0000, v161
    v_lshlrev_b32 v128, 16, v162
    v_and_b32 v129, 0xffff0000, v162
    v_lshlrev_b32 v130, 16, v163
    v_and_b32 v131, 0xffff0000, v163
    v_pk_mul_f32 v[116:117], v[116:117], v[132:133] op_sel:[0,1]
    v_pk_mul_f32 v[118:119], v[118:119], v[132:133] op_sel:[0,1]
    v_pk_mul_f32 v[120:121], v[120:121], v[132:133] op_sel:[0,1]
    v_pk_mul_f32 v[122:123], v[122:123], v[132:133] op_sel:[0,1]
    v_pk_mul_f32 v[124:125], v[124:125], v[132:133] op_sel:[0,1]
    v_pk_mul_f32 v[126:127], v[126:127], v[132:133] op_sel:[0,1]
    v_pk_mul_f32 v[128:129], v[128:129], v[132:133] op_sel:[0,1]
    v_pk_mul_f32 v[130:131], v[130:131], v[132:133] op_sel:[0,1]
    v_cvt_pk_bf16_f32 v156, v116, v117
    v_cvt_pk_bf16_f32 v157, v118, v119
    v_cvt_pk_bf16_f32 v158, v120, v121
    v_cvt_pk_bf16_f32 v159, v122, v123
    v_cvt_pk_bf16_f32 v160, v124, v125
    v_cvt_pk_bf16_f32 v161, v126, v127
    v_cvt_pk_bf16_f32 v162, v128, v129
    v_cvt_pk_bf16_f32 v163, v130, v131
    s_mov_b32 s3, 0
    s_mov_b32 s4, 262144
    buffer_store_dwordx4 v[156:159], v102, s[8:11], s3 offen sc1
    buffer_store_dwordx4 v[160:163], v102, s[8:11], s4 offen sc1
    s_mov_b32 s68, s44
    s_and_b32 s69, s45, 0xffff
    s_mov_b32 s70, 2097152
    s_mov_b32 s71, 0x20000
    s_mov_b32 s72, s56
    s_and_b32 s73, s57, 0xffff
    s_mov_b32 s74, 7340032
    s_mov_b32 s75, 0x20000
    s_lshl_b32 s3, s2, 3
    s_add_u32 s3, s3, s25
    s_mul_i32 s76, s3, 3584
    s_lshl_b32 s3, s2, 2
    s_add_u32 s3, s3, s26
    s_lshl_b32 s77, s3, 11
    s_sub_u32 s78, 6, s26
    s_lshr_b32 s78, s26, 1
    s_add_u32 s78, s78, 1
    s_cmp_lg_u32 s26, 3
    s_cbranch_scc1 L2_notk
    s_mov_b32 s3, s79
    s_mov_b32 s4, 0
    s_waitcnt vmcnt(0)
L2_tk_chk:
    v_readfirstlane_b32 s29, v20
    s_nop 3
    s_cmp_lt_u32 s29, 32
    s_cbranch_scc1 L2_tk_ok
    s_add_u32 s4, s4, 1
    s_cmp_ge_u32 s4, 8
    s_cbranch_scc1 L2_tk_ok
    s_add_u32 s3, s3, 1
    s_and_b32 s3, s3, 7
    s_lshl_b32 s5, s3, 5
    s_add_u32 s5, s5, 16
    v_mov_b32 v20, 1
    s_mov_b64 exec, 1
    buffer_atomic_add v20, off, s[96:99], s5 sc0 sc1
    s_mov_b64 exec, -1
    s_waitcnt vmcnt(0)
    s_branch L2_tk_chk
L2_tk_ok:
    s_lshl_b32 s29, s29, 3
    s_add_u32 s29, s29, s3
    s_and_b32 s29, s29, 255
    v_mov_b32 v20, s29
    v_mov_b32 v21, 140800
    ds_write_b32 v21, v20
    s_waitcnt lgkmcnt(0)
L2_notk:
    s_waitcnt vmcnt(0) lgkmcnt(0)
    s_barrier
    v_mov_b32 v21, 140800
    ds_read_b32 v20, v21
    s_waitcnt lgkmcnt(0)
    v_readfirstlane_b32 s6, v20
    s_nop 3
    s_and_b32 s6, s6, 255
    s_and_b32 s27, s6, 7
    s_lshl_b32 s27, s27, 2
    s_bfe_u32 s3, s6, 0x20003
    s_add_u32 s27, s27, s3
    s_lshr_b32 s28, s6, 5
    s_lshl_b32 s20, s28, 14
    s_add_u32 s20, s20, 0
    s_lshl_b32 s21, s27, 16
    s_lshl_b32 s67, s27, 11
    s_add_u32 s67, s67, 4259840
    s_lshl_b32 s65, s28, 1
    s_lshr_b32 s3, s26, 1
    s_add_u32 s65, s65, s3
    s_lshl_b32 s65, s65, 14
    s_and_b32 s3, s26, 1
    s_lshl_b32 s3, s3, 11
    s_add_u32 s65, s65, s3
    s_add_u32 s65, s65, 8388608
    s_mul_i32 s64, s27, 7
    s_add_u32 s64, s64, 133
    v_and_b32 v10, 15, v1
    s_lshl_b32 s3, s27, 5
    v_add_u32 v10, s3, v10
    v_lshlrev_b32 v10, 1, v10
    s_mov_b32 s16, s34
    s_and_b32 s17, s35, 0xffff
    s_mov_b32 s18, 2048
    s_mov_b32 s19, 0x20000
    buffer_load_ushort v80, v10, s[16:19], 0 offen offset:0
    buffer_load_ushort v83, v10, s[16:19], 0 offen offset:32
    s_mov_b32 s16, s36
    s_and_b32 s17, s37, 0xffff
    s_mov_b32 s18, 2048
    s_mov_b32 s19, 0x20000
    buffer_load_ushort v81, v10, s[16:19], 0 offen offset:0
    buffer_load_ushort v84, v10, s[16:19], 0 offen offset:32
    s_mov_b32 s16, s46
    s_and_b32 s17, s47, 0xffff
    s_mov_b32 s18, 2048
    s_mov_b32 s19, 0x20000
    buffer_load_ushort v82, v10, s[16:19], 0 offen offset:0
    buffer_load_ushort v85, v10, s[16:19], 0 offen offset:32
    s_add_u32 m0, s23, 30720
    s_nop 0
    buffer_load_dwordx4 v3, s[12:15], s21 offen lds
    buffer_load_dwordx4 v90, s[12:15], s21 offen offset:1024 lds
    s_add_u32 s21, s21, 128
    s_add_u32 m0, s23, 100352
    s_nop 0
    buffer_load_dwordx4 v3, s[12:15], s21 offen lds
    buffer_load_dwordx4 v90, s[12:15], s21 offen offset:1024 lds
    s_add_u32 s21, s21, 128
    s_waitcnt vmcnt(4)
    v_lshlrev_b32 v80, 16, v80
    v_lshlrev_b32 v81, 16, v81
    v_lshlrev_b32 v82, 16, v82
    v_mul_f32 v82, 0x3fb8aa3b, v82
    v_exp_f32 v82, v82
    v_mul_f32 v14, v80, v80
    v_cvt_pk_bf16_f32 v82, v82, v82
    v_and_b32 v82, 0xffff0000, v82
    v_mul_f32 v10, v82, v80
    v_mul_f32 v10, 0x3fb8aa3b, v10
    v_exp_f32 v10, v10
    v_mul_f32 v11, v82, v81
    v_mul_f32 v11, 0x3e22f983, v11
    v_rndne_f32 v12, v11
    v_sub_f32 v11, v11, v12
    v_cos_f32 v12, v11
    v_sin_f32 v13, v11
    v_fmac_f32 v14, v81, v81
    v_rcp_f32 v11, v14
    v_mul_f32 v224, v10, v12
    v_mul_f32 v226, v10, v13
    v_add_f32 v10, -1.0, v224
    v_add_f32 v11, v11, v11
    v_mul_f32 v12, v10, v80
    v_fmac_f32 v12, v226, v81
    v_mul_f32 v236, v12, v11
    v_mul_f32 v12, v226, v80
    v_fma_f32 v12, -v10, v81, v12
    v_mul_f32 v237, v12, v11
    v_mul_f32 v14, v226, v226
    v_mul_f32 v15, v224, v226
    v_fma_f32 v225, v224, v224, -v14
    v_add_f32 v227, v15, v15
    v_mul_f32 v14, v227, v227
    v_mul_f32 v15, v225, v227
    v_fma_f32 v12, v225, v225, -v14
    v_add_f32 v13, v15, v15
    v_mul_f32 v14, v13, v13
    v_mul_f32 v15, v12, v13
    v_fma_f32 v10, v12, v12, -v14
    v_add_f32 v11, v15, v15
    v_mul_f32 v14, v11, v11
    v_mul_f32 v15, v10, v11
    v_fma_f32 v228, v10, v10, -v14
    v_add_f32 v229, v15, v15
    v_mul_f32 v14, v229, v229
    v_mul_f32 v15, v228, v229
    v_fma_f32 v230, v228, v228, -v14
    v_add_f32 v231, v15, v15
    v_mul_f32 v14, v231, v231
    v_mul_f32 v15, v230, v231
    v_fma_f32 v232, v230, v230, -v14
    v_add_f32 v233, v15, v15
    v_mul_f32 v14, v233, v233
    v_mul_f32 v15, v232, v233
    v_fma_f32 v10, v232, v232, -v14
    v_add_f32 v11, v15, v15
    v_mul_f32 v14, v11, v11
    v_mul_f32 v15, v10, v11
    v_fma_f32 v234, v10, v10, -v14
    v_add_f32 v235, v15, v15
    v_and_b32 v14, 32, v1
    v_cmp_ne_u32 vcc, 0, v14
    v_mov_b32 v14, 1.0
    v_mov_b32 v15, 0
    v_cndmask_b32 v10, v14, v230, vcc
    v_cndmask_b32 v11, v15, v231, vcc
    v_and_b32 v14, 16, v1
    v_cmp_ne_u32 vcc, 0, v14
    v_mul_f32 v12, v10, v228
    v_fma_f32 v12, -v11, v229, v12
    v_mul_f32 v13, v10, v229
    v_fmac_f32 v13, v11, v228
    v_cndmask_b32 v238, v10, v12, vcc
    v_cndmask_b32 v239, v11, v13, vcc
    v_lshlrev_b32 v83, 16, v83
    v_lshlrev_b32 v84, 16, v84
    v_lshlrev_b32 v85, 16, v85
    v_mul_f32 v85, 0x3fb8aa3b, v85
    v_exp_f32 v85, v85
    v_mul_f32 v14, v83, v83
    v_cvt_pk_bf16_f32 v85, v85, v85
    v_and_b32 v85, 0xffff0000, v85
    v_mul_f32 v10, v85, v83
    v_mul_f32 v10, 0x3fb8aa3b, v10
    v_exp_f32 v10, v10
    v_mul_f32 v11, v85, v84
    v_mul_f32 v11, 0x3e22f983, v11
    v_rndne_f32 v12, v11
    v_sub_f32 v11, v11, v12
    v_cos_f32 v12, v11
    v_sin_f32 v13, v11
    v_fmac_f32 v14, v84, v84
    v_rcp_f32 v11, v14
    v_mul_f32 v240, v10, v12
    v_mul_f32 v242, v10, v13
    v_add_f32 v10, -1.0, v240
    v_add_f32 v11, v11, v11
    v_mul_f32 v12, v10, v83
    v_fmac_f32 v12, v242, v84
    v_mul_f32 v252, v12, v11
    v_mul_f32 v12, v242, v83
    v_fma_f32 v12, -v10, v84, v12
    v_mul_f32 v253, v12, v11
    v_mul_f32 v14, v242, v242
    v_mul_f32 v15, v240, v242
    v_fma_f32 v241, v240, v240, -v14
    v_add_f32 v243, v15, v15
    v_mul_f32 v14, v243, v243
    v_mul_f32 v15, v241, v243
    v_fma_f32 v12, v241, v241, -v14
    v_add_f32 v13, v15, v15
    v_mul_f32 v14, v13, v13
    v_mul_f32 v15, v12, v13
    v_fma_f32 v10, v12, v12, -v14
    v_add_f32 v11, v15, v15
    v_mul_f32 v14, v11, v11
    v_mul_f32 v15, v10, v11
    v_fma_f32 v244, v10, v10, -v14
    v_add_f32 v245, v15, v15
    v_mul_f32 v14, v245, v245
    v_mul_f32 v15, v244, v245
    v_fma_f32 v246, v244, v244, -v14
    v_add_f32 v247, v15, v15
    v_mul_f32 v14, v247, v247
    v_mul_f32 v15, v246, v247
    v_fma_f32 v248, v246, v246, -v14
    v_add_f32 v249, v15, v15
    v_mul_f32 v14, v249, v249
    v_mul_f32 v15, v248, v249
    v_fma_f32 v10, v248, v248, -v14
    v_add_f32 v11, v15, v15
    v_mul_f32 v14, v11, v11
    v_mul_f32 v15, v10, v11
    v_fma_f32 v250, v10, v10, -v14
    v_add_f32 v251, v15, v15
    v_and_b32 v14, 32, v1
    v_cmp_ne_u32 vcc, 0, v14
    v_mov_b32 v14, 1.0
    v_mov_b32 v15, 0
    v_cndmask_b32 v10, v14, v246, vcc
    v_cndmask_b32 v11, v15, v247, vcc
    v_and_b32 v14, 16, v1
    v_cmp_ne_u32 vcc, 0, v14
    v_mul_f32 v12, v10, v244
    v_fma_f32 v12, -v11, v245, v12
    v_mul_f32 v13, v10, v245
    v_fmac_f32 v13, v11, v244
    v_cndmask_b32 v254, v10, v12, vcc
    v_cndmask_b32 v255, v11, v13, vcc
    s_barrier
    s_add_u32 m0, s22, 0
    s_nop 0
    buffer_load_dwordx4 v2, s[8:11], s20 offen sc1 lds
    buffer_load_dwordx4 v2, s[8:11], s20 offen offset:1024 sc1 lds
    buffer_load_dwordx4 v2, s[8:11], s20 offen offset:2048 sc1 lds
    buffer_load_dwordx4 v2, s[8:11], s20 offen offset:3072 sc1 lds
    s_add_u32 s20, s20, 131072
    s_add_u32 m0, s22, 34816
    s_nop 0
    buffer_load_dwordx4 v2, s[8:11], s20 offen sc1 lds
    buffer_load_dwordx4 v2, s[8:11], s20 offen offset:1024 sc1 lds
    buffer_load_dwordx4 v2, s[8:11], s20 offen offset:2048 sc1 lds
    buffer_load_dwordx4 v2, s[8:11], s20 offen offset:3072 sc1 lds
    s_add_u32 s20, s20, 131072
    s_waitcnt vmcnt(4)
    s_barrier
    ds_read_b128 v[16:19], v4 offset:0
    ds_read_b128 v[20:23], v4 offset:1024
    ds_read_b128 v[24:27], v4 offset:2048
    ds_read_b128 v[28:31], v4 offset:3072
    ds_read_b64_tr_b16 v[48:49], v6 offset:160
    ds_read_b64_tr_b16 v[50:51], v6 offset:1952
    ds_read_b64_tr_b16 v[52:53], v6 offset:7328
    ds_read_b64_tr_b16 v[54:55], v6 offset:9120
    ds_read_b64_tr_b16 v[56:57], v6 offset:192
    ds_read_b64_tr_b16 v[58:59], v6 offset:1984
    ds_read_b64_tr_b16 v[60:61], v6 offset:7360
    ds_read_b64_tr_b16 v[62:63], v6 offset:9152
    s_mov_b32 s24, 7
    s_waitcnt lgkmcnt(6)
    v_mfma_f32_16x16x32_bf16 v[96:99], v[16:19], v[48:51], 0
    ds_read_b128 v[64:67], v8 offset:0
    v_mfma_f32_16x16x32_bf16 v[100:103], v[20:23], v[48:51], 0
    v_mfma_f32_16x16x32_bf16 v[104:107], v[24:27], v[48:51], 0
    v_mfma_f32_16x16x32_bf16 v[108:111], v[28:31], v[48:51], 0
    s_add_u32 m0, s22, 69632
    s_nop 0
    buffer_load_dwordx4 v2, s[8:11], s20 offen sc1 lds
    s_waitcnt lgkmcnt(5)
    v_mfma_f32_16x16x32_bf16 v[124:127], v[28:31], v[52:55], 0
    ds_read_b128 v[68:71], v8 offset:34816
    v_mfma_f32_16x16x32_bf16 v[120:123], v[24:27], v[52:55], 0
    v_mfma_f32_16x16x32_bf16 v[116:119], v[20:23], v[52:55], 0
    v_mfma_f32_16x16x32_bf16 v[112:115], v[16:19], v[52:55], 0
    buffer_load_dwordx4 v2, s[8:11], s20 offen offset:1024 sc1 lds
    s_waitcnt lgkmcnt(4)
    v_mfma_f32_16x16x32_bf16 v[128:131], v[16:19], v[56:59], 0
    ds_read_b128 v[72:75], v8 offset:2048
    v_mfma_f32_16x16x32_bf16 v[132:135], v[20:23], v[56:59], 0
    v_mfma_f32_16x16x32_bf16 v[136:139], v[24:27], v[56:59], 0
    v_mfma_f32_16x16x32_bf16 v[140:143], v[28:31], v[56:59], 0
    buffer_load_dwordx4 v2, s[8:11], s20 offen offset:2048 sc1 lds
    s_waitcnt lgkmcnt(3)
    v_mfma_f32_16x16x32_bf16 v[156:159], v[28:31], v[60:63], 0
    ds_read_b128 v[76:79], v8 offset:36864
    v_mfma_f32_16x16x32_bf16 v[152:155], v[24:27], v[60:63], 0
    v_mfma_f32_16x16x32_bf16 v[148:151], v[20:23], v[60:63], 0
    v_mfma_f32_16x16x32_bf16 v[144:147], v[16:19], v[60:63], 0
    buffer_load_dwordx4 v2, s[8:11], s20 offen offset:3072 sc1 lds
    s_add_u32 s20, s20, 131072
    s_waitcnt lgkmcnt(3)
    v_mfma_f32_16x16x32_bf16 v[160:163], v[16:19], v[64:67], 0
    v_mfma_f32_16x16x32_bf16 v[164:167], v[20:23], v[64:67], 0
    v_mfma_f32_16x16x32_bf16 v[168:171], v[24:27], v[64:67], 0
    v_mfma_f32_16x16x32_bf16 v[172:175], v[28:31], v[64:67], 0
    s_waitcnt vmcnt(4) lgkmcnt(0)
    s_barrier
    v_mfma_f32_16x16x32_bf16 v[188:191], v[28:31], v[68:71], 0
    ds_read_b128 v[32:35], v4 offset:34816
    ds_read_b128 v[36:39], v4 offset:35840
    v_mfma_f32_16x16x32_bf16 v[184:187], v[24:27], v[68:71], 0
    ds_read_b128 v[40:43], v4 offset:36864
    ds_read_b128 v[44:47], v4 offset:37888
    v_mfma_f32_16x16x32_bf16 v[180:183], v[20:23], v[68:71], 0
    ds_read_b64_tr_b16 v[48:49], v6 offset:34976
    ds_read_b64_tr_b16 v[50:51], v6 offset:36768
    v_mfma_f32_16x16x32_bf16 v[176:179], v[16:19], v[68:71], 0
    ds_read_b64_tr_b16 v[52:53], v6 offset:42144
    ds_read_b64_tr_b16 v[54:55], v6 offset:43936
    v_mfma_f32_16x16x32_bf16 v[192:195], v[16:19], v[72:75], 0
    ds_read_b64_tr_b16 v[56:57], v6 offset:35008
    v_mfma_f32_16x16x32_bf16 v[196:199], v[20:23], v[72:75], 0
    ds_read_b64_tr_b16 v[58:59], v6 offset:36800
    s_add_u32 m0, s22, 104448
    s_nop 0
    buffer_load_dwordx4 v2, s[8:11], s20 offen sc1 lds
    v_mfma_f32_16x16x32_bf16 v[200:203], v[24:27], v[72:75], 0
    v_mfma_f32_16x16x32_bf16 v[204:207], v[28:31], v[72:75], 0
    buffer_load_dwordx4 v2, s[8:11], s20 offen offset:1024 sc1 lds
    v_mfma_f32_16x16x32_bf16 v[220:223], v[28:31], v[76:79], 0
    ds_read_b64_tr_b16 v[60:61], v6 offset:42176
    v_mfma_f32_16x16x32_bf16 v[216:219], v[24:27], v[76:79], 0
    ds_read_b64_tr_b16 v[62:63], v6 offset:43968
    buffer_load_dwordx4 v2, s[8:11], s20 offen offset:2048 sc1 lds
    v_mfma_f32_16x16x32_bf16 v[212:215], v[20:23], v[76:79], 0
    v_mfma_f32_16x16x32_bf16 v[208:211], v[16:19], v[76:79], 0
    buffer_load_dwordx4 v2, s[8:11], s20 offen offset:3072 sc1 lds
    s_add_u32 s20, s20, 131072
    s_waitcnt lgkmcnt(6)
    v_mfma_f32_16x16x32_bf16 v[96:99], v[32:35], v[48:51], v[96:99]
    ds_read_b128 v[64:67], v88 offset:0
    v_mfma_f32_16x16x32_bf16 v[100:103], v[36:39], v[48:51], v[100:103]
    v_mfma_f32_16x16x32_bf16 v[104:107], v[40:43], v[48:51], v[104:107]
    v_mfma_f32_16x16x32_bf16 v[108:111], v[44:47], v[48:51], v[108:111]
    s_add_u32 m0, s22, 0
    s_nop 0
    buffer_load_dwordx4 v2, s[8:11], s20 offen sc1 lds
    s_waitcnt lgkmcnt(5)
    v_mfma_f32_16x16x32_bf16 v[124:127], v[44:47], v[52:55], v[124:127]
    ds_read_b128 v[68:71], v88 offset:34816
    v_mfma_f32_16x16x32_bf16 v[120:123], v[40:43], v[52:55], v[120:123]
    v_mfma_f32_16x16x32_bf16 v[116:119], v[36:39], v[52:55], v[116:119]
    v_mfma_f32_16x16x32_bf16 v[112:115], v[32:35], v[52:55], v[112:115]
    buffer_load_dwordx4 v2, s[8:11], s20 offen offset:1024 sc1 lds
    s_waitcnt lgkmcnt(4)
    v_mfma_f32_16x16x32_bf16 v[128:131], v[32:35], v[56:59], v[128:131]
    ds_read_b128 v[72:75], v88 offset:2048
    v_mfma_f32_16x16x32_bf16 v[132:135], v[36:39], v[56:59], v[132:135]
    v_mfma_f32_16x16x32_bf16 v[136:139], v[40:43], v[56:59], v[136:139]
    v_mfma_f32_16x16x32_bf16 v[140:143], v[44:47], v[56:59], v[140:143]
    buffer_load_dwordx4 v2, s[8:11], s20 offen offset:2048 sc1 lds
    s_waitcnt lgkmcnt(3)
    v_mfma_f32_16x16x32_bf16 v[156:159], v[44:47], v[60:63], v[156:159]
    ds_read_b128 v[76:79], v88 offset:36864
    v_mfma_f32_16x16x32_bf16 v[152:155], v[40:43], v[60:63], v[152:155]
    v_mfma_f32_16x16x32_bf16 v[148:151], v[36:39], v[60:63], v[148:151]
    v_mfma_f32_16x16x32_bf16 v[144:147], v[32:35], v[60:63], v[144:147]
    buffer_load_dwordx4 v2, s[8:11], s20 offen offset:3072 sc1 lds
    s_add_u32 s20, s20, 131072
    s_waitcnt lgkmcnt(3)
    v_mfma_f32_16x16x32_bf16 v[160:163], v[32:35], v[64:67], v[160:163]
    v_mfma_f32_16x16x32_bf16 v[164:167], v[36:39], v[64:67], v[164:167]
    v_mfma_f32_16x16x32_bf16 v[168:171], v[40:43], v[64:67], v[168:171]
    v_mfma_f32_16x16x32_bf16 v[172:175], v[44:47], v[64:67], v[172:175]
    s_waitcnt vmcnt(8) lgkmcnt(0)
    s_barrier
    v_mfma_f32_16x16x32_bf16 v[188:191], v[44:47], v[68:71], v[188:191]
    ds_read_b128 v[16:19], v5 offset:0
    ds_read_b128 v[20:23], v5 offset:1024
    v_mfma_f32_16x16x32_bf16 v[184:187], v[40:43], v[68:71], v[184:187]
    ds_read_b128 v[24:27], v5 offset:2048
    ds_read_b128 v[28:31], v5 offset:3072
    v_mfma_f32_16x16x32_bf16 v[180:183], v[36:39], v[68:71], v[180:183]
    ds_read_b64_tr_b16 v[48:49], v7 offset:160
    ds_read_b64_tr_b16 v[50:51], v7 offset:1952
    v_mfma_f32_16x16x32_bf16 v[176:179], v[32:35], v[68:71], v[176:179]
    ds_read_b64_tr_b16 v[52:53], v7 offset:7328
    ds_read_b64_tr_b16 v[54:55], v7 offset:9120
    v_mfma_f32_16x16x32_bf16 v[192:195], v[32:35], v[72:75], v[192:195]
    ds_read_b64_tr_b16 v[56:57], v7 offset:192
    v_mfma_f32_16x16x32_bf16 v[196:199], v[36:39], v[72:75], v[196:199]
    ds_read_b64_tr_b16 v[58:59], v7 offset:1984
    v_mfma_f32_16x16x32_bf16 v[200:203], v[40:43], v[72:75], v[200:203]
    v_mfma_f32_16x16x32_bf16 v[204:207], v[44:47], v[72:75], v[204:207]
    v_mfma_f32_16x16x32_bf16 v[220:223], v[44:47], v[76:79], v[220:223]
    ds_read_b64_tr_b16 v[60:61], v7 offset:7360
    v_mfma_f32_16x16x32_bf16 v[216:219], v[40:43], v[76:79], v[216:219]
    ds_read_b64_tr_b16 v[62:63], v7 offset:9152
    v_mfma_f32_16x16x32_bf16 v[212:215], v[36:39], v[76:79], v[212:215]
    s_add_u32 m0, s23, 30720
    s_nop 0
    buffer_load_dwordx4 v3, s[12:15], s21 offen lds
    v_mfma_f32_16x16x32_bf16 v[208:211], v[32:35], v[76:79], v[208:211]
    s_branch L2_mid1
.p2align 4
L2_loop1:
    s_cmp_lg_u32 s24, s78
    s_cbranch_scc1 L2_npf1
    buffer_load_dword v92, v94, s[72:75], s76 offen
    buffer_load_dword v93, v95, s[68:71], s77 offen
L2_npf1:
    s_waitcnt lgkmcnt(6)
    v_mfma_f32_16x16x32_bf16 v[96:99], v[16:19], v[48:51], v[96:99]
    ds_read_b128 v[64:67], v8 offset:0
    v_mfma_f32_16x16x32_bf16 v[100:103], v[20:23], v[48:51], v[100:103]
    buffer_load_dwordx4 v90, s[12:15], s21 offen offset:1024 lds
    s_add_u32 s21, s21, 128
    v_mfma_f32_16x16x32_bf16 v[104:107], v[24:27], v[48:51], v[104:107]
    v_mfma_f32_16x16x32_bf16 v[108:111], v[28:31], v[48:51], v[108:111]
    s_waitcnt lgkmcnt(5)
    v_mfma_f32_16x16x32_bf16 v[124:127], v[28:31], v[52:55], v[124:127]
    ds_read_b128 v[68:71], v8 offset:34816
    v_mfma_f32_16x16x32_bf16 v[120:123], v[24:27], v[52:55], v[120:123]
    s_add_u32 m0, s22, 104448
    s_nop 0
    buffer_load_dwordx4 v2, s[8:11], s20 offen sc1 lds
    v_mfma_f32_16x16x32_bf16 v[116:119], v[20:23], v[52:55], v[116:119]
    v_mfma_f32_16x16x32_bf16 v[112:115], v[16:19], v[52:55], v[112:115]
    s_waitcnt lgkmcnt(4)
    v_mfma_f32_16x16x32_bf16 v[128:131], v[16:19], v[56:59], v[128:131]
    ds_read_b128 v[72:75], v8 offset:2048
    v_mfma_f32_16x16x32_bf16 v[132:135], v[20:23], v[56:59], v[132:135]
    buffer_load_dwordx4 v2, s[8:11], s20 offen offset:1024 sc1 lds
    v_mfma_f32_16x16x32_bf16 v[136:139], v[24:27], v[56:59], v[136:139]
    v_mfma_f32_16x16x32_bf16 v[140:143], v[28:31], v[56:59], v[140:143]
    s_waitcnt lgkmcnt(3)
    v_mfma_f32_16x16x32_bf16 v[156:159], v[28:31], v[60:63], v[156:159]
    ds_read_b128 v[76:79], v8 offset:36864
    v_mfma_f32_16x16x32_bf16 v[152:155], v[24:27], v[60:63], v[152:155]
    buffer_load_dwordx4 v2, s[8:11], s20 offen offset:2048 sc1 lds
    v_mfma_f32_16x16x32_bf16 v[148:151], v[20:23], v[60:63], v[148:151]
    v_mfma_f32_16x16x32_bf16 v[144:147], v[16:19], v[60:63], v[144:147]
    s_waitcnt lgkmcnt(3)
    v_mfma_f32_16x16x32_bf16 v[160:163], v[16:19], v[64:67], v[160:163]
    v_mfma_f32_16x16x32_bf16 v[164:167], v[20:23], v[64:67], v[164:167]
    buffer_load_dwordx4 v2, s[8:11], s20 offen offset:3072 sc1 lds
    s_add_u32 s20, s20, 131072
    v_mfma_f32_16x16x32_bf16 v[168:171], v[24:27], v[64:67], v[168:171]
    v_mfma_f32_16x16x32_bf16 v[172:175], v[28:31], v[64:67], v[172:175]
    s_waitcnt vmcnt(10) lgkmcnt(0)
    s_barrier
    v_mfma_f32_16x16x32_bf16 v[188:191], v[28:31], v[68:71], v[188:191]
    ds_read_b128 v[32:35], v4 offset:34816
    ds_read_b128 v[36:39], v4 offset:35840
    v_mfma_f32_16x16x32_bf16 v[184:187], v[24:27], v[68:71], v[184:187]
    ds_read_b128 v[40:43], v4 offset:36864
    ds_read_b128 v[44:47], v4 offset:37888
    v_mfma_f32_16x16x32_bf16 v[180:183], v[20:23], v[68:71], v[180:183]
    ds_read_b64_tr_b16 v[48:49], v6 offset:34976
    ds_read_b64_tr_b16 v[50:51], v6 offset:36768
    v_mfma_f32_16x16x32_bf16 v[176:179], v[16:19], v[68:71], v[176:179]
    ds_read_b64_tr_b16 v[52:53], v6 offset:42144
    ds_read_b64_tr_b16 v[54:55], v6 offset:43936
    v_mfma_f32_16x16x32_bf16 v[192:195], v[16:19], v[72:75], v[192:195]
    ds_read_b64_tr_b16 v[56:57], v6 offset:35008
    v_mfma_f32_16x16x32_bf16 v[196:199], v[20:23], v[72:75], v[196:199]
    ds_read_b64_tr_b16 v[58:59], v6 offset:36800
    v_mfma_f32_16x16x32_bf16 v[200:203], v[24:27], v[72:75], v[200:203]
    v_mfma_f32_16x16x32_bf16 v[204:207], v[28:31], v[72:75], v[204:207]
    v_mfma_f32_16x16x32_bf16 v[220:223], v[28:31], v[76:79], v[220:223]
    ds_read_b64_tr_b16 v[60:61], v6 offset:42176
    v_mfma_f32_16x16x32_bf16 v[216:219], v[24:27], v[76:79], v[216:219]
    ds_read_b64_tr_b16 v[62:63], v6 offset:43968
    v_mfma_f32_16x16x32_bf16 v[212:215], v[20:23], v[76:79], v[212:215]
    v_mfma_f32_16x16x32_bf16 v[208:211], v[16:19], v[76:79], v[208:211]
    s_waitcnt lgkmcnt(6)
    v_mfma_f32_16x16x32_bf16 v[96:99], v[32:35], v[48:51], v[96:99]
    ds_read_b128 v[64:67], v88 offset:0
    v_mfma_f32_16x16x32_bf16 v[100:103], v[36:39], v[48:51], v[100:103]
    v_mfma_f32_16x16x32_bf16 v[104:107], v[40:43], v[48:51], v[104:107]
    v_mfma_f32_16x16x32_bf16 v[108:111], v[44:47], v[48:51], v[108:111]
    s_waitcnt lgkmcnt(5)
    v_mfma_f32_16x16x32_bf16 v[124:127], v[44:47], v[52:55], v[124:127]
    ds_read_b128 v[68:71], v88 offset:34816
    v_mfma_f32_16x16x32_bf16 v[120:123], v[40:43], v[52:55], v[120:123]
    s_add_u32 m0, s22, 0
    s_nop 0
    buffer_load_dwordx4 v2, s[8:11], s20 offen sc1 lds
    v_mfma_f32_16x16x32_bf16 v[116:119], v[36:39], v[52:55], v[116:119]
    v_mfma_f32_16x16x32_bf16 v[112:115], v[32:35], v[52:55], v[112:115]
    s_waitcnt lgkmcnt(4)
    v_mfma_f32_16x16x32_bf16 v[128:131], v[32:35], v[56:59], v[128:131]
    ds_read_b128 v[72:75], v88 offset:2048
    v_mfma_f32_16x16x32_bf16 v[132:135], v[36:39], v[56:59], v[132:135]
    buffer_load_dwordx4 v2, s[8:11], s20 offen offset:1024 sc1 lds
    v_mfma_f32_16x16x32_bf16 v[136:139], v[40:43], v[56:59], v[136:139]
    v_mfma_f32_16x16x32_bf16 v[140:143], v[44:47], v[56:59], v[140:143]
    s_waitcnt lgkmcnt(3)
    v_mfma_f32_16x16x32_bf16 v[156:159], v[44:47], v[60:63], v[156:159]
    ds_read_b128 v[76:79], v88 offset:36864
    v_mfma_f32_16x16x32_bf16 v[152:155], v[40:43], v[60:63], v[152:155]
    buffer_load_dwordx4 v2, s[8:11], s20 offen offset:2048 sc1 lds
    v_mfma_f32_16x16x32_bf16 v[148:151], v[36:39], v[60:63], v[148:151]
    v_mfma_f32_16x16x32_bf16 v[144:147], v[32:35], v[60:63], v[144:147]
    s_waitcnt lgkmcnt(3)
    v_mfma_f32_16x16x32_bf16 v[160:163], v[32:35], v[64:67], v[160:163]
    v_mfma_f32_16x16x32_bf16 v[164:167], v[36:39], v[64:67], v[164:167]
    buffer_load_dwordx4 v2, s[8:11], s20 offen offset:3072 sc1 lds
    s_add_u32 s20, s20, 131072
    v_mfma_f32_16x16x32_bf16 v[168:171], v[40:43], v[64:67], v[168:171]
    v_mfma_f32_16x16x32_bf16 v[172:175], v[44:47], v[64:67], v[172:175]
    s_waitcnt vmcnt(8) lgkmcnt(0)
    s_barrier
    v_mfma_f32_16x16x32_bf16 v[188:191], v[44:47], v[68:71], v[188:191]
    ds_read_b128 v[16:19], v5 offset:0
    ds_read_b128 v[20:23], v5 offset:1024
    v_mfma_f32_16x16x32_bf16 v[184:187], v[40:43], v[68:71], v[184:187]
    ds_read_b128 v[24:27], v5 offset:2048
    ds_read_b128 v[28:31], v5 offset:3072
    v_mfma_f32_16x16x32_bf16 v[180:183], v[36:39], v[68:71], v[180:183]
    ds_read_b64_tr_b16 v[48:49], v7 offset:160
    ds_read_b64_tr_b16 v[50:51], v7 offset:1952
    v_mfma_f32_16x16x32_bf16 v[176:179], v[32:35], v[68:71], v[176:179]
    ds_read_b64_tr_b16 v[52:53], v7 offset:7328
    ds_read_b64_tr_b16 v[54:55], v7 offset:9120
    v_mfma_f32_16x16x32_bf16 v[192:195], v[32:35], v[72:75], v[192:195]
    ds_read_b64_tr_b16 v[56:57], v7 offset:192
    v_mfma_f32_16x16x32_bf16 v[196:199], v[36:39], v[72:75], v[196:199]
    ds_read_b64_tr_b16 v[58:59], v7 offset:1984
    v_mfma_f32_16x16x32_bf16 v[200:203], v[40:43], v[72:75], v[200:203]
    v_mfma_f32_16x16x32_bf16 v[204:207], v[44:47], v[72:75], v[204:207]
    v_mfma_f32_16x16x32_bf16 v[220:223], v[44:47], v[76:79], v[220:223]
    ds_read_b64_tr_b16 v[60:61], v7 offset:7360
    v_mfma_f32_16x16x32_bf16 v[216:219], v[40:43], v[76:79], v[216:219]
    ds_read_b64_tr_b16 v[62:63], v7 offset:9152
    v_mfma_f32_16x16x32_bf16 v[212:215], v[36:39], v[76:79], v[212:215]
    s_add_u32 m0, s23, 30720
    s_nop 0
    buffer_load_dwordx4 v3, s[12:15], s21 offen lds
    v_mfma_f32_16x16x32_bf16 v[208:211], v[32:35], v[76:79], v[208:211]
L2_mid1:
    s_waitcnt lgkmcnt(6)
    v_mfma_f32_16x16x32_bf16 v[96:99], v[16:19], v[48:51], v[96:99]
    ds_read_b128 v[64:67], v9 offset:0
    v_mfma_f32_16x16x32_bf16 v[100:103], v[20:23], v[48:51], v[100:103]
    buffer_load_dwordx4 v90, s[12:15], s21 offen offset:1024 lds
    s_add_u32 s21, s21, 128
    v_mfma_f32_16x16x32_bf16 v[104:107], v[24:27], v[48:51], v[104:107]
    v_mfma_f32_16x16x32_bf16 v[108:111], v[28:31], v[48:51], v[108:111]
    s_waitcnt lgkmcnt(5)
    v_mfma_f32_16x16x32_bf16 v[124:127], v[28:31], v[52:55], v[124:127]
    ds_read_b128 v[68:71], v9 offset:34816
    v_mfma_f32_16x16x32_bf16 v[120:123], v[24:27], v[52:55], v[120:123]
    s_add_u32 m0, s22, 34816
    s_nop 0
    buffer_load_dwordx4 v2, s[8:11], s20 offen sc1 lds
    v_mfma_f32_16x16x32_bf16 v[116:119], v[20:23], v[52:55], v[116:119]
    v_mfma_f32_16x16x32_bf16 v[112:115], v[16:19], v[52:55], v[112:115]
    s_waitcnt lgkmcnt(4)
    v_mfma_f32_16x16x32_bf16 v[128:131], v[16:19], v[56:59], v[128:131]
    ds_read_b128 v[72:75], v9 offset:2048
    v_mfma_f32_16x16x32_bf16 v[132:135], v[20:23], v[56:59], v[132:135]
    buffer_load_dwordx4 v2, s[8:11], s20 offen offset:1024 sc1 lds
    v_mfma_f32_16x16x32_bf16 v[136:139], v[24:27], v[56:59], v[136:139]
    v_mfma_f32_16x16x32_bf16 v[140:143], v[28:31], v[56:59], v[140:143]
    s_waitcnt lgkmcnt(3)
    v_mfma_f32_16x16x32_bf16 v[156:159], v[28:31], v[60:63], v[156:159]
    ds_read_b128 v[76:79], v9 offset:36864
    v_mfma_f32_16x16x32_bf16 v[152:155], v[24:27], v[60:63], v[152:155]
    buffer_load_dwordx4 v2, s[8:11], s20 offen offset:2048 sc1 lds
    v_mfma_f32_16x16x32_bf16 v[148:151], v[20:23], v[60:63], v[148:151]
    v_mfma_f32_16x16x32_bf16 v[144:147], v[16:19], v[60:63], v[144:147]
    s_waitcnt lgkmcnt(3)
    v_mfma_f32_16x16x32_bf16 v[160:163], v[16:19], v[64:67], v[160:163]
    v_mfma_f32_16x16x32_bf16 v[164:167], v[20:23], v[64:67], v[164:167]
    buffer_load_dwordx4 v2, s[8:11], s20 offen offset:3072 sc1 lds
    s_add_u32 s20, s20, 131072
    v_mfma_f32_16x16x32_bf16 v[168:171], v[24:27], v[64:67], v[168:171]
    v_mfma_f32_16x16x32_bf16 v[172:175], v[28:31], v[64:67], v[172:175]
    s_waitcnt vmcnt(10) lgkmcnt(0)
    s_barrier
    v_mfma_f32_16x16x32_bf16 v[188:191], v[28:31], v[68:71], v[188:191]
    ds_read_b128 v[32:35], v5 offset:34816
    ds_read_b128 v[36:39], v5 offset:35840
    v_mfma_f32_16x16x32_bf16 v[184:187], v[24:27], v[68:71], v[184:187]
    ds_read_b128 v[40:43], v5 offset:36864
    ds_read_b128 v[44:47], v5 offset:37888
    v_mfma_f32_16x16x32_bf16 v[180:183], v[20:23], v[68:71], v[180:183]
    ds_read_b64_tr_b16 v[48:49], v7 offset:34976
    ds_read_b64_tr_b16 v[50:51], v7 offset:36768
    v_mfma_f32_16x16x32_bf16 v[176:179], v[16:19], v[68:71], v[176:179]
    ds_read_b64_tr_b16 v[52:53], v7 offset:42144
    ds_read_b64_tr_b16 v[54:55], v7 offset:43936
    v_mfma_f32_16x16x32_bf16 v[192:195], v[16:19], v[72:75], v[192:195]
    ds_read_b64_tr_b16 v[56:57], v7 offset:35008
    v_mfma_f32_16x16x32_bf16 v[196:199], v[20:23], v[72:75], v[196:199]
    ds_read_b64_tr_b16 v[58:59], v7 offset:36800
    v_mfma_f32_16x16x32_bf16 v[200:203], v[24:27], v[72:75], v[200:203]
    v_mfma_f32_16x16x32_bf16 v[204:207], v[28:31], v[72:75], v[204:207]
    v_mfma_f32_16x16x32_bf16 v[220:223], v[28:31], v[76:79], v[220:223]
    ds_read_b64_tr_b16 v[60:61], v7 offset:42176
    v_mfma_f32_16x16x32_bf16 v[216:219], v[24:27], v[76:79], v[216:219]
    ds_read_b64_tr_b16 v[62:63], v7 offset:43968
    v_mfma_f32_16x16x32_bf16 v[212:215], v[20:23], v[76:79], v[212:215]
    v_mfma_f32_16x16x32_bf16 v[208:211], v[16:19], v[76:79], v[208:211]
    s_waitcnt lgkmcnt(6)
    v_mfma_f32_16x16x32_bf16 v[96:99], v[32:35], v[48:51], v[96:99]
    ds_read_b128 v[64:67], v89 offset:0
    v_mfma_f32_16x16x32_bf16 v[100:103], v[36:39], v[48:51], v[100:103]
    v_mfma_f32_16x16x32_bf16 v[104:107], v[40:43], v[48:51], v[104:107]
    v_mfma_f32_16x16x32_bf16 v[108:111], v[44:47], v[48:51], v[108:111]
    s_waitcnt lgkmcnt(5)
    v_mfma_f32_16x16x32_bf16 v[124:127], v[44:47], v[52:55], v[124:127]
    ds_read_b128 v[68:71], v89 offset:34816
    v_mfma_f32_16x16x32_bf16 v[120:123], v[40:43], v[52:55], v[120:123]
    s_add_u32 m0, s22, 69632
    s_nop 0
    buffer_load_dwordx4 v2, s[8:11], s20 offen sc1 lds
    v_mfma_f32_16x16x32_bf16 v[116:119], v[36:39], v[52:55], v[116:119]
    v_mfma_f32_16x16x32_bf16 v[112:115], v[32:35], v[52:55], v[112:115]
    s_waitcnt lgkmcnt(4)
    v_mfma_f32_16x16x32_bf16 v[128:131], v[32:35], v[56:59], v[128:131]
    ds_read_b128 v[72:75], v89 offset:2048
    v_mfma_f32_16x16x32_bf16 v[132:135], v[36:39], v[56:59], v[132:135]
    buffer_load_dwordx4 v2, s[8:11], s20 offen offset:1024 sc1 lds
    v_mfma_f32_16x16x32_bf16 v[136:139], v[40:43], v[56:59], v[136:139]
    v_mfma_f32_16x16x32_bf16 v[140:143], v[44:47], v[56:59], v[140:143]
    s_waitcnt lgkmcnt(3)
    v_mfma_f32_16x16x32_bf16 v[156:159], v[44:47], v[60:63], v[156:159]
    ds_read_b128 v[76:79], v89 offset:36864
    v_mfma_f32_16x16x32_bf16 v[152:155], v[40:43], v[60:63], v[152:155]
    buffer_load_dwordx4 v2, s[8:11], s20 offen offset:2048 sc1 lds
    v_mfma_f32_16x16x32_bf16 v[148:151], v[36:39], v[60:63], v[148:151]
    v_mfma_f32_16x16x32_bf16 v[144:147], v[32:35], v[60:63], v[144:147]
    s_waitcnt lgkmcnt(3)
    v_mfma_f32_16x16x32_bf16 v[160:163], v[32:35], v[64:67], v[160:163]
    v_mfma_f32_16x16x32_bf16 v[164:167], v[36:39], v[64:67], v[164:167]
    buffer_load_dwordx4 v2, s[8:11], s20 offen offset:3072 sc1 lds
    s_add_u32 s20, s20, 131072
    v_mfma_f32_16x16x32_bf16 v[168:171], v[40:43], v[64:67], v[168:171]
    v_mfma_f32_16x16x32_bf16 v[172:175], v[44:47], v[64:67], v[172:175]
    s_waitcnt vmcnt(8) lgkmcnt(0)
    s_barrier
    v_mfma_f32_16x16x32_bf16 v[188:191], v[44:47], v[68:71], v[188:191]
    ds_read_b128 v[16:19], v4 offset:0
    ds_read_b128 v[20:23], v4 offset:1024
    v_mfma_f32_16x16x32_bf16 v[184:187], v[40:43], v[68:71], v[184:187]
    ds_read_b128 v[24:27], v4 offset:2048
    ds_read_b128 v[28:31], v4 offset:3072
    v_mfma_f32_16x16x32_bf16 v[180:183], v[36:39], v[68:71], v[180:183]
    ds_read_b64_tr_b16 v[48:49], v6 offset:160
    ds_read_b64_tr_b16 v[50:51], v6 offset:1952
    v_mfma_f32_16x16x32_bf16 v[176:179], v[32:35], v[68:71], v[176:179]
    ds_read_b64_tr_b16 v[52:53], v6 offset:7328
    ds_read_b64_tr_b16 v[54:55], v6 offset:9120
    v_mfma_f32_16x16x32_bf16 v[192:195], v[32:35], v[72:75], v[192:195]
    ds_read_b64_tr_b16 v[56:57], v6 offset:192
    v_mfma_f32_16x16x32_bf16 v[196:199], v[36:39], v[72:75], v[196:199]
    ds_read_b64_tr_b16 v[58:59], v6 offset:1984
    v_mfma_f32_16x16x32_bf16 v[200:203], v[40:43], v[72:75], v[200:203]
    v_mfma_f32_16x16x32_bf16 v[204:207], v[44:47], v[72:75], v[204:207]
    v_mfma_f32_16x16x32_bf16 v[220:223], v[44:47], v[76:79], v[220:223]
    ds_read_b64_tr_b16 v[60:61], v6 offset:7360
    v_mfma_f32_16x16x32_bf16 v[216:219], v[40:43], v[76:79], v[216:219]
    ds_read_b64_tr_b16 v[62:63], v6 offset:9152
    v_mfma_f32_16x16x32_bf16 v[212:215], v[36:39], v[76:79], v[212:215]
    s_add_u32 m0, s23, 100352
    s_nop 0
    buffer_load_dwordx4 v3, s[12:15], s21 offen lds
    v_mfma_f32_16x16x32_bf16 v[208:211], v[32:35], v[76:79], v[208:211]
    s_sub_u32 s24, s24, 1
    s_cmp_lg_u32 s24, 0
    s_cbranch_scc1 L2_loop1
    s_waitcnt lgkmcnt(6)
    v_mfma_f32_16x16x32_bf16 v[96:99], v[16:19], v[48:51], v[96:99]
    ds_read_b128 v[64:67], v8 offset:0
    v_and_b32 v12, 3, v1
    v_mfma_f32_16x16x32_bf16 v[100:103], v[20:23], v[48:51], v[100:103]
    v_bfe_u32 v13, v1, 3, 1
    buffer_load_dwordx4 v90, s[12:15], s21 offen offset:1024 lds
    s_add_u32 s21, s21, 128
    v_mfma_f32_16x16x32_bf16 v[104:107], v[24:27], v[48:51], v[104:107]
    v_lshl_or_b32 v12, v13, 2, v12
    v_mfma_f32_16x16x32_bf16 v[108:111], v[28:31], v[48:51], v[108:111]
    v_bfe_u32 v13, v1, 2, 1
    s_waitcnt lgkmcnt(5)
    v_mfma_f32_16x16x32_bf16 v[124:127], v[28:31], v[52:55], v[124:127]
    ds_read_b128 v[68:71], v8 offset:34816
    v_lshl_or_b32 v12, v13, 3, v12
    v_mfma_f32_16x16x32_bf16 v[120:123], v[24:27], v[52:55], v[120:123]
    v_and_b32 v13, 48, v1
    s_add_u32 m0, s22, 104448
    s_nop 0
    buffer_load_dwordx4 v2, s[8:11], s20 offen sc1 lds
    v_mfma_f32_16x16x32_bf16 v[116:119], v[20:23], v[52:55], v[116:119]
    v_or_b32 v12, v12, v13
    v_mfma_f32_16x16x32_bf16 v[112:115], v[16:19], v[52:55], v[112:115]
    v_lshlrev_b32 v10, 4, v12
    s_waitcnt lgkmcnt(4)
    v_mfma_f32_16x16x32_bf16 v[128:131], v[16:19], v[56:59], v[128:131]
    ds_read_b128 v[72:75], v8 offset:2048
    v_xor_b32 v11, 128, v10
    v_mfma_f32_16x16x32_bf16 v[132:135], v[20:23], v[56:59], v[132:135]
    v_add_u32 v11, 1024, v11
    buffer_load_dwordx4 v2, s[8:11], s20 offen offset:1024 sc1 lds
    v_mfma_f32_16x16x32_bf16 v[136:139], v[24:27], v[56:59], v[136:139]
    v_and_b32 v12, 15, v1
    v_mfma_f32_16x16x32_bf16 v[140:143], v[28:31], v[56:59], v[140:143]
    v_lshlrev_b32 v12, 4, v12
    s_waitcnt lgkmcnt(3)
    v_mfma_f32_16x16x32_bf16 v[156:159], v[28:31], v[60:63], v[156:159]
    ds_read_b128 v[76:79], v8 offset:36864
    v_add_u32 v13, 139264, v12
    v_mfma_f32_16x16x32_bf16 v[152:155], v[24:27], v[60:63], v[152:155]
    s_lshl_b32 s3, s26, 8
    buffer_load_dwordx4 v2, s[8:11], s20 offen offset:2048 sc1 lds
    v_mfma_f32_16x16x32_bf16 v[148:151], v[20:23], v[60:63], v[148:151]
    v_add_u32 v14, s3, v13
    v_mfma_f32_16x16x32_bf16 v[144:147], v[16:19], v[60:63], v[144:147]
    s_waitcnt lgkmcnt(3)
    v_mfma_f32_16x16x32_bf16 v[160:163], v[16:19], v[64:67], v[160:163]
    v_mfma_f32_16x16x32_bf16 v[164:167], v[20:23], v[64:67], v[164:167]
    buffer_load_dwordx4 v2, s[8:11], s20 offen offset:3072 sc1 lds
    s_add_u32 s20, s20, 131072
    v_mfma_f32_16x16x32_bf16 v[168:171], v[24:27], v[64:67], v[168:171]
    v_mfma_f32_16x16x32_bf16 v[172:175], v[28:31], v[64:67], v[172:175]
    s_waitcnt vmcnt(10) lgkmcnt(0)
    s_barrier
    v_mfma_f32_16x16x32_bf16 v[188:191], v[28:31], v[68:71], v[188:191]
    ds_read_b128 v[32:35], v4 offset:34816
    ds_read_b128 v[36:39], v4 offset:35840
    v_mfma_f32_16x16x32_bf16 v[184:187], v[24:27], v[68:71], v[184:187]
    ds_read_b128 v[40:43], v4 offset:36864
    ds_read_b128 v[44:47], v4 offset:37888
    v_mfma_f32_16x16x32_bf16 v[180:183], v[20:23], v[68:71], v[180:183]
    ds_read_b64_tr_b16 v[48:49], v6 offset:34976
    ds_read_b64_tr_b16 v[50:51], v6 offset:36768
    v_mfma_f32_16x16x32_bf16 v[176:179], v[16:19], v[68:71], v[176:179]
    ds_read_b64_tr_b16 v[52:53], v6 offset:42144
    ds_read_b64_tr_b16 v[54:55], v6 offset:43936
    v_mfma_f32_16x16x32_bf16 v[192:195], v[16:19], v[72:75], v[192:195]
    ds_read_b64_tr_b16 v[56:57], v6 offset:35008
    v_mfma_f32_16x16x32_bf16 v[196:199], v[20:23], v[72:75], v[196:199]
    ds_read_b64_tr_b16 v[58:59], v6 offset:36800
    v_mfma_f32_16x16x32_bf16 v[200:203], v[24:27], v[72:75], v[200:203]
    v_mfma_f32_16x16x32_bf16 v[204:207], v[28:31], v[72:75], v[204:207]
    v_mfma_f32_16x16x32_bf16 v[220:223], v[28:31], v[76:79], v[220:223]
    ds_read_b64_tr_b16 v[60:61], v6 offset:42176
    v_mfma_f32_16x16x32_bf16 v[216:219], v[24:27], v[76:79], v[216:219]
    ds_read_b64_tr_b16 v[62:63], v6 offset:43968
    v_mfma_f32_16x16x32_bf16 v[212:215], v[20:23], v[76:79], v[212:215]
    v_mfma_f32_16x16x32_bf16 v[208:211], v[16:19], v[76:79], v[208:211]
    s_waitcnt lgkmcnt(6)
    v_mfma_f32_16x16x32_bf16 v[96:99], v[32:35], v[48:51], v[96:99]
    ds_read_b128 v[64:67], v88 offset:0
    v_mfma_f32_16x16x32_bf16 v[100:103], v[36:39], v[48:51], v[100:103]
    v_mfma_f32_16x16x32_bf16 v[104:107], v[40:43], v[48:51], v[104:107]
    v_mfma_f32_16x16x32_bf16 v[108:111], v[44:47], v[48:51], v[108:111]
    s_waitcnt lgkmcnt(5)
    v_mfma_f32_16x16x32_bf16 v[124:127], v[44:47], v[52:55], v[124:127]
    ds_read_b128 v[68:71], v88 offset:34816
    v_mfma_f32_16x16x32_bf16 v[120:123], v[40:43], v[52:55], v[120:123]
    v_mfma_f32_16x16x32_bf16 v[116:119], v[36:39], v[52:55], v[116:119]
    v_mfma_f32_16x16x32_bf16 v[112:115], v[32:35], v[52:55], v[112:115]
    s_waitcnt lgkmcnt(4)
    v_mfma_f32_16x16x32_bf16 v[128:131], v[32:35], v[56:59], v[128:131]
    ds_read_b128 v[72:75], v88 offset:2048
    v_mfma_f32_16x16x32_bf16 v[132:135], v[36:39], v[56:59], v[132:135]
    v_mfma_f32_16x16x32_bf16 v[136:139], v[40:43], v[56:59], v[136:139]
    v_mfma_f32_16x16x32_bf16 v[140:143], v[44:47], v[56:59], v[140:143]
    s_waitcnt lgkmcnt(3)
    v_mfma_f32_16x16x32_bf16 v[156:159], v[44:47], v[60:63], v[156:159]
    ds_read_b128 v[76:79], v88 offset:36864
    v_mfma_f32_16x16x32_bf16 v[152:155], v[40:43], v[60:63], v[152:155]
    v_mfma_f32_16x16x32_bf16 v[148:151], v[36:39], v[60:63], v[148:151]
    v_mfma_f32_16x16x32_bf16 v[144:147], v[32:35], v[60:63], v[144:147]
    s_waitcnt lgkmcnt(3)
    v_mfma_f32_16x16x32_bf16 v[160:163], v[32:35], v[64:67], v[160:163]
    v_mfma_f32_16x16x32_bf16 v[164:167], v[36:39], v[64:67], v[164:167]
    v_mfma_f32_16x16x32_bf16 v[168:171], v[40:43], v[64:67], v[168:171]
    v_mfma_f32_16x16x32_bf16 v[172:175], v[44:47], v[64:67], v[172:175]
    s_waitcnt vmcnt(0) lgkmcnt(0)
    s_barrier
    s_setprio 2
    v_mfma_f32_16x16x32_bf16 v[188:191], v[44:47], v[68:71], v[188:191]
    ds_read_b128 v[16:19], v5 offset:0
    ds_read_b128 v[20:23], v5 offset:1024
    v_mfma_f32_16x16x32_bf16 v[184:187], v[40:43], v[68:71], v[184:187]
    ds_read_b128 v[24:27], v5 offset:2048
    ds_read_b128 v[28:31], v5 offset:3072
    v_mfma_f32_16x16x32_bf16 v[180:183], v[36:39], v[68:71], v[180:183]
    ds_read_b64_tr_b16 v[48:49], v7 offset:160
    ds_read_b64_tr_b16 v[50:51], v7 offset:1952
    v_mfma_f32_16x16x32_bf16 v[176:179], v[32:35], v[68:71], v[176:179]
    ds_read_b64_tr_b16 v[52:53], v7 offset:7328
    ds_read_b64_tr_b16 v[54:55], v7 offset:9120
    v_mfma_f32_16x16x32_bf16 v[192:195], v[32:35], v[72:75], v[192:195]
    ds_read_b64_tr_b16 v[56:57], v7 offset:192
    v_mfma_f32_16x16x32_bf16 v[196:199], v[36:39], v[72:75], v[196:199]
    ds_read_b64_tr_b16 v[58:59], v7 offset:1984
    v_mfma_f32_16x16x32_bf16 v[200:203], v[40:43], v[72:75], v[200:203]
    v_mfma_f32_16x16x32_bf16 v[204:207], v[44:47], v[72:75], v[204:207]
    v_mfma_f32_16x16x32_bf16 v[220:223], v[44:47], v[76:79], v[220:223]
    ds_read_b64_tr_b16 v[60:61], v7 offset:7360
    v_mfma_f32_16x16x32_bf16 v[216:219], v[40:43], v[76:79], v[216:219]
    ds_read_b64_tr_b16 v[62:63], v7 offset:9152
    v_mfma_f32_16x16x32_bf16 v[212:215], v[36:39], v[76:79], v[212:215]
    v_mfma_f32_16x16x32_bf16 v[208:211], v[32:35], v[76:79], v[208:211]
    v_and_b32 v86, 7, v1
    v_lshlrev_b32 v86, 5, v86
    buffer_load_dword v87, v86, s[96:99], 0 offen sc1
    s_waitcnt lgkmcnt(6)
    v_mfma_f32_16x16x32_bf16 v[96:99], v[16:19], v[48:51], v[96:99]
    ds_read_b128 v[64:67], v9 offset:0
    v_mfma_f32_16x16x32_bf16 v[100:103], v[20:23], v[48:51], v[100:103]
    v_mfma_f32_16x16x32_bf16 v[104:107], v[24:27], v[48:51], v[104:107]
    v_mfma_f32_16x16x32_bf16 v[108:111], v[28:31], v[48:51], v[108:111]
    s_waitcnt lgkmcnt(5)
    v_mfma_f32_16x16x32_bf16 v[124:127], v[28:31], v[52:55], v[124:127]
    ds_read_b128 v[68:71], v9 offset:34816
    v_mfma_f32_16x16x32_bf16 v[120:123], v[24:27], v[52:55], v[120:123]
    v_mfma_f32_16x16x32_bf16 v[116:119], v[20:23], v[52:55], v[116:119]
    v_mfma_f32_16x16x32_bf16 v[112:115], v[16:19], v[52:55], v[112:115]
    s_waitcnt lgkmcnt(4)
    v_mfma_f32_16x16x32_bf16 v[128:131], v[16:19], v[56:59], v[128:131]
    ds_read_b128 v[72:75], v9 offset:2048
    v_mfma_f32_16x16x32_bf16 v[132:135], v[20:23], v[56:59], v[132:135]
    v_mfma_f32_16x16x32_bf16 v[136:139], v[24:27], v[56:59], v[136:139]
    v_mfma_f32_16x16x32_bf16 v[140:143], v[28:31], v[56:59], v[140:143]
    s_waitcnt lgkmcnt(3)
    v_mfma_f32_16x16x32_bf16 v[156:159], v[28:31], v[60:63], v[156:159]
    ds_read_b128 v[76:79], v9 offset:36864
    v_mfma_f32_16x16x32_bf16 v[152:155], v[24:27], v[60:63], v[152:155]
    v_mfma_f32_16x16x32_bf16 v[148:151], v[20:23], v[60:63], v[148:151]
    v_mfma_f32_16x16x32_bf16 v[144:147], v[16:19], v[60:63], v[144:147]
    s_waitcnt lgkmcnt(3)
    v_mfma_f32_16x16x32_bf16 v[160:163], v[16:19], v[64:67], v[160:163]
    v_mfma_f32_16x16x32_bf16 v[164:167], v[20:23], v[64:67], v[164:167]
    v_mfma_f32_16x16x32_bf16 v[168:171], v[24:27], v[64:67], v[168:171]
    v_mfma_f32_16x16x32_bf16 v[172:175], v[28:31], v[64:67], v[172:175]
    s_waitcnt lgkmcnt(2)
    v_mfma_f32_16x16x32_bf16 v[188:191], v[28:31], v[68:71], v[188:191]
    ds_read_b128 v[32:35], v5 offset:34816
    ds_read_b128 v[36:39], v5 offset:35840
    v_mfma_f32_16x16x32_bf16 v[184:187], v[24:27], v[68:71], v[184:187]
    ds_read_b128 v[40:43], v5 offset:36864
    ds_read_b128 v[44:47], v5 offset:37888
    v_mfma_f32_16x16x32_bf16 v[180:183], v[20:23], v[68:71], v[180:183]
    ds_read_b64_tr_b16 v[48:49], v7 offset:34976
    ds_read_b64_tr_b16 v[50:51], v7 offset:36768
    v_mfma_f32_16x16x32_bf16 v[176:179], v[16:19], v[68:71], v[176:179]
    ds_read_b64_tr_b16 v[52:53], v7 offset:42144
    ds_read_b64_tr_b16 v[54:55], v7 offset:43936
    s_waitcnt lgkmcnt(9)
    v_mfma_f32_16x16x32_bf16 v[192:195], v[16:19], v[72:75], v[192:195]
    ds_read_b64_tr_b16 v[56:57], v7 offset:35008
    v_mfma_f32_16x16x32_bf16 v[196:199], v[20:23], v[72:75], v[196:199]
    ds_read_b64_tr_b16 v[58:59], v7 offset:36800
    v_mfma_f32_16x16x32_bf16 v[200:203], v[24:27], v[72:75], v[200:203]
    v_mfma_f32_16x16x32_bf16 v[204:207], v[28:31], v[72:75], v[204:207]
    s_waitcnt lgkmcnt(10)
    v_mfma_f32_16x16x32_bf16 v[220:223], v[28:31], v[76:79], v[220:223]
    ds_read_b64_tr_b16 v[60:61], v7 offset:42176
    v_mfma_f32_16x16x32_bf16 v[216:219], v[24:27], v[76:79], v[216:219]
    ds_read_b64_tr_b16 v[62:63], v7 offset:43968
    v_mfma_f32_16x16x32_bf16 v[212:215], v[20:23], v[76:79], v[212:215]
    v_mfma_f32_16x16x32_bf16 v[208:211], v[16:19], v[76:79], v[208:211]
    s_waitcnt lgkmcnt(6)
    v_mfma_f32_16x16x32_bf16 v[96:99], v[32:35], v[48:51], v[96:99]
    ds_read_b128 v[64:67], v89 offset:0
    v_mfma_f32_16x16x32_bf16 v[100:103], v[36:39], v[48:51], v[100:103]
    v_mfma_f32_16x16x32_bf16 v[104:107], v[40:43], v[48:51], v[104:107]
    v_mfma_f32_16x16x32_bf16 v[108:111], v[44:47], v[48:51], v[108:111]
    s_waitcnt lgkmcnt(5)
    v_mfma_f32_16x16x32_bf16 v[124:127], v[44:47], v[52:55], v[124:127]
    ds_read_b128 v[68:71], v89 offset:34816
    v_mfma_f32_16x16x32_bf16 v[120:123], v[40:43], v[52:55], v[120:123]
    v_mfma_f32_16x16x32_bf16 v[116:119], v[36:39], v[52:55], v[116:119]
    v_mfma_f32_16x16x32_bf16 v[112:115], v[32:35], v[52:55], v[112:115]
    s_waitcnt lgkmcnt(4)
    v_mfma_f32_16x16x32_bf16 v[128:131], v[32:35], v[56:59], v[128:131]
    ds_read_b128 v[72:75], v89 offset:2048
    v_mfma_f32_16x16x32_bf16 v[132:135], v[36:39], v[56:59], v[132:135]
    v_mfma_f32_16x16x32_bf16 v[136:139], v[40:43], v[56:59], v[136:139]
    v_mfma_f32_16x16x32_bf16 v[140:143], v[44:47], v[56:59], v[140:143]
    s_waitcnt lgkmcnt(3)
    v_mfma_f32_16x16x32_bf16 v[156:159], v[44:47], v[60:63], v[156:159]
    ds_read_b128 v[76:79], v89 offset:36864
    v_mfma_f32_16x16x32_bf16 v[152:155], v[40:43], v[60:63], v[152:155]
    v_mfma_f32_16x16x32_bf16 v[148:151], v[36:39], v[60:63], v[148:151]
    v_mfma_f32_16x16x32_bf16 v[144:147], v[32:35], v[60:63], v[144:147]
    s_waitcnt lgkmcnt(3)
    v_mfma_f32_16x16x32_bf16 v[160:163], v[32:35], v[64:67], v[160:163]
    v_mfma_f32_16x16x32_bf16 v[164:167], v[36:39], v[64:67], v[164:167]
    v_mfma_f32_16x16x32_bf16 v[168:171], v[40:43], v[64:67], v[168:171]
    v_mfma_f32_16x16x32_bf16 v[172:175], v[44:47], v[64:67], v[172:175]
    s_waitcnt lgkmcnt(2)
    v_mfma_f32_16x16x32_bf16 v[188:191], v[44:47], v[68:71], v[188:191]
    v_mfma_f32_16x16x32_bf16 v[184:187], v[40:43], v[68:71], v[184:187]
    v_mfma_f32_16x16x32_bf16 v[180:183], v[36:39], v[68:71], v[180:183]
    v_mfma_f32_16x16x32_bf16 v[176:179], v[32:35], v[68:71], v[176:179]
    s_waitcnt lgkmcnt(1)
    v_mfma_f32_16x16x32_bf16 v[192:195], v[32:35], v[72:75], v[192:195]
    v_mfma_f32_16x16x32_bf16 v[196:199], v[36:39], v[72:75], v[196:199]
    v_mfma_f32_16x16x32_bf16 v[200:203], v[40:43], v[72:75], v[200:203]
    v_mfma_f32_16x16x32_bf16 v[204:207], v[44:47], v[72:75], v[204:207]
    s_waitcnt lgkmcnt(0)
    v_mfma_f32_16x16x32_bf16 v[220:223], v[44:47], v[76:79], v[220:223]
    v_mfma_f32_16x16x32_bf16 v[216:219], v[40:43], v[76:79], v[216:219]
    v_mfma_f32_16x16x32_bf16 v[212:215], v[36:39], v[76:79], v[212:215]
    v_mfma_f32_16x16x32_bf16 v[208:211], v[32:35], v[76:79], v[208:211]
    v_mov_b32 v36, 0xbdd2d3e8
    v_mov_b32 v37, 0xbdd2d3e8
    v_mov_b32 v38, 0xc0135761
    v_mov_b32 v39, 0xc0135761
    v_fma_f32 v56, v225, v160, v162
    v_fma_f32 v57, v225, v161, v163
    v_fma_f32 v58, v225, v176, v178
    v_fma_f32 v59, v225, v177, v179
    v_fma_f32 v60, v241, v192, v194
    v_fma_f32 v61, v241, v193, v195
    v_fma_f32 v62, v241, v208, v210
    v_fma_f32 v63, v241, v209, v211
    v_fma_f32 v56, -v227, v176, v56
    v_fma_f32 v57, -v227, v177, v57
    v_fmac_f32 v58, v227, v160
    v_fmac_f32 v59, v227, v161
    v_fma_f32 v60, -v243, v208, v60
    v_fma_f32 v61, -v243, v209, v61
    v_fmac_f32 v62, v243, v192
    v_fmac_f32 v63, v243, v193
    v_fma_f32 v48, v225, v56, v164
    v_fma_f32 v49, v225, v57, v165
    v_fma_f32 v50, v225, v58, v180
    v_fma_f32 v51, v225, v59, v181
    v_fma_f32 v52, v241, v60, v196
    v_fma_f32 v53, v241, v61, v197
    v_fma_f32 v54, v241, v62, v212
    v_fma_f32 v55, v241, v63, v213
    v_fma_f32 v48, -v227, v58, v48
    v_fma_f32 v49, -v227, v59, v49
    v_fmac_f32 v50, v227, v56
    v_fmac_f32 v51, v227, v57
    v_fma_f32 v52, -v243, v62, v52
    v_fma_f32 v53, -v243, v63, v53
    v_fmac_f32 v54, v243, v60
    v_fmac_f32 v55, v243, v61
    v_fma_f32 v56, v225, v48, v166
    v_fma_f32 v57, v225, v49, v167
    v_fma_f32 v58, v225, v50, v182
    v_fma_f32 v59, v225, v51, v183
    v_fma_f32 v60, v241, v52, v198
    v_fma_f32 v61, v241, v53, v199
    v_fma_f32 v62, v241, v54, v214
    v_fma_f32 v63, v241, v55, v215
    v_fma_f32 v56, -v227, v50, v56
    v_fma_f32 v57, -v227, v51, v57
    v_fmac_f32 v58, v227, v48
    v_fmac_f32 v59, v227, v49
    v_fma_f32 v60, -v243, v54, v60
    v_fma_f32 v61, -v243, v55, v61
    v_fmac_f32 v62, v243, v52
    v_fmac_f32 v63, v243, v53
    v_fma_f32 v48, v225, v56, v168
    v_fma_f32 v49, v225, v57, v169
    v_fma_f32 v50, v225, v58, v184
    v_fma_f32 v51, v225, v59, v185
    v_fma_f32 v52, v241, v60, v200
    v_fma_f32 v53, v241, v61, v201
    v_fma_f32 v54, v241, v62, v216
    v_fma_f32 v55, v241, v63, v217
    v_fma_f32 v48, -v227, v58, v48
    v_fma_f32 v49, -v227, v59, v49
    v_fmac_f32 v50, v227, v56
    v_fmac_f32 v51, v227, v57
    v_fma_f32 v52, -v243, v62, v52
    v_fma_f32 v53, -v243, v63, v53
    v_fmac_f32 v54, v243, v60
    v_fmac_f32 v55, v243, v61
    v_fma_f32 v56, v225, v48, v170
    v_fma_f32 v57, v225, v49, v171
    v_fma_f32 v58, v225, v50, v186
    v_fma_f32 v59, v225, v51, v187
    v_fma_f32 v60, v241, v52, v202
    v_fma_f32 v61, v241, v53, v203
    v_fma_f32 v62, v241, v54, v218
    v_fma_f32 v63, v241, v55, v219
    v_fma_f32 v56, -v227, v50, v56
    v_fma_f32 v57, -v227, v51, v57
    v_fmac_f32 v58, v227, v48
    v_fmac_f32 v59, v227, v49
    v_fma_f32 v60, -v243, v54, v60
    v_fma_f32 v61, -v243, v55, v61
    v_fmac_f32 v62, v243, v52
    v_fmac_f32 v63, v243, v53
    v_fma_f32 v48, v225, v56, v172
    v_fma_f32 v49, v225, v57, v173
    v_fma_f32 v50, v225, v58, v188
    v_fma_f32 v51, v225, v59, v189
    v_fma_f32 v52, v241, v60, v204
    v_fma_f32 v53, v241, v61, v205
    v_fma_f32 v54, v241, v62, v220
    v_fma_f32 v55, v241, v63, v221
    v_fma_f32 v48, -v227, v58, v48
    v_fma_f32 v49, -v227, v59, v49
    v_fmac_f32 v50, v227, v56
    v_fmac_f32 v51, v227, v57
    v_fma_f32 v52, -v243, v62, v52
    v_fma_f32 v53, -v243, v63, v53
    v_fmac_f32 v54, v243, v60
    v_fmac_f32 v55, v243, v61
    v_fma_f32 v56, v225, v48, v174
    v_fma_f32 v57, v225, v49, v175
    v_fma_f32 v58, v225, v50, v190
    v_fma_f32 v59, v225, v51, v191
    v_fma_f32 v60, v241, v52, v206
    v_fma_f32 v61, v241, v53, v207
    v_fma_f32 v62, v241, v54, v222
    v_fma_f32 v63, v241, v55, v223
    v_fma_f32 v56, -v227, v50, v56
    v_fma_f32 v57, -v227, v51, v57
    v_fmac_f32 v58, v227, v48
    v_fmac_f32 v59, v227, v49
    v_fma_f32 v60, -v243, v54, v60
    v_fma_f32 v61, -v243, v55, v61
    v_fmac_f32 v62, v243, v52
    v_fmac_f32 v63, v243, v53
    v_fma_f32 v48, v224, v56, v57
    v_fma_f32 v49, v224, v58, v59
    v_fma_f32 v50, v240, v60, v61
    v_fma_f32 v51, v240, v62, v63
    v_fma_f32 v48, -v226, v58, v48
    v_fmac_f32 v49, v226, v56
    v_fma_f32 v50, -v242, v62, v50
    v_fmac_f32 v51, v242, v60
    v_mov_b32 v52, v48
    v_mov_b32 v53, v49
    v_mov_b32 v54, v50
    v_mov_b32 v55, v51
    v_permlane16_swap_b32 v48, v52
    v_permlane16_swap_b32 v49, v53
    v_permlane16_swap_b32 v50, v54
    v_permlane16_swap_b32 v51, v55
    v_fma_f32 v72, v228, v48, v52
    v_fma_f32 v73, v228, v49, v53
    v_fma_f32 v74, v244, v50, v54
    v_fma_f32 v75, v244, v51, v55
    v_fma_f32 v56, -v229, v49, v72
    v_fma_f32 v57, v229, v48, v73
    v_fma_f32 v58, -v245, v51, v74
    v_fma_f32 v59, v245, v50, v75
    v_mov_b32 v60, v56
    v_mov_b32 v61, v57
    v_mov_b32 v62, v58
    v_mov_b32 v63, v59
    v_permlane32_swap_b32 v56, v60
    v_permlane32_swap_b32 v57, v61
    v_permlane32_swap_b32 v58, v62
    v_permlane32_swap_b32 v59, v63
    v_fma_f32 v72, v230, v56, v60
    v_fma_f32 v73, v230, v57, v61
    v_fma_f32 v74, v246, v58, v62
    v_fma_f32 v75, v246, v59, v63
    v_fma_f32 v64, -v231, v57, v72
    v_fma_f32 v65, v231, v56, v73
    v_fma_f32 v66, -v247, v59, v74
    v_fma_f32 v67, v247, v58, v75
    v_min_u32 v64, -2, v64
    v_min_u32 v65, -2, v65
    v_min_u32 v66, -2, v66
    v_min_u32 v67, -2, v67
    s_mov_b64 exec, 0xffff
    ds_write_b128 v14, v[64:67]
    s_mov_b64 exec, -1
    v_and_b32 v15, 32, v1
    v_cmp_ne_u32 vcc, 0, v15
    v_mov_b32 v15, 0
    s_nop 0
    v_cndmask_b32 v68, v15, v56, vcc
    v_cndmask_b32 v69, v15, v57, vcc
    v_cndmask_b32 v70, v15, v58, vcc
    v_cndmask_b32 v71, v15, v59, vcc
    v_fma_f32 v72, v228, v68, v48
    v_fma_f32 v73, v228, v69, v49
    v_fma_f32 v74, v244, v70, v50
    v_fma_f32 v75, v244, v71, v51
    v_fma_f32 v60, -v229, v69, v72
    v_fma_f32 v61, v229, v68, v73
    v_fma_f32 v62, -v245, v71, v74
    v_fma_f32 v63, v245, v70, v75
    v_and_b32 v15, 16, v1
    v_cmp_ne_u32 vcc, 0, v15
    s_nop 1
    v_cndmask_b32 v68, v68, v60, vcc
    v_cndmask_b32 v69, v69, v61, vcc
    v_cndmask_b32 v70, v70, v62, vcc
    v_cndmask_b32 v71, v71, v63, vcc
    s_mov_b32 s5, 0
L2_cchk:
    s_waitcnt vmcnt(0)
    v_cmp_gt_u32 vcc, 32, v87
    s_nop 4
    s_cbranch_vccz L2_lspin
    buffer_load_dword v87, v86, s[96:99], 0 offen sc1
    s_add_u32 s5, s5, 1
    s_cmp_lt_u32 s5, 0x10000
    s_cbranch_scc1 L2_cchk
L2_lspin:
    ds_read_b128 v[48:51], v13 offset:0
    ds_read_b128 v[52:55], v13 offset:256
    ds_read_b128 v[56:59], v13 offset:512
    ds_read_b128 v[60:63], v13 offset:768
    s_waitcnt lgkmcnt(0)
    v_max_u32 v72, v48, v49
    v_max3_u32 v72, v72, v50, v51
    v_max3_u32 v72, v72, v52, v53
    v_max3_u32 v72, v72, v54, v55
    v_max3_u32 v72, v72, v56, v57
    v_max3_u32 v72, v72, v58, v59
    v_max3_u32 v72, v72, v60, v61
    v_max3_u32 v72, v72, v62, v63
    v_cmp_eq_u32 vcc, -1, v72
    s_nop 4
    s_cbranch_vccnz L2_lspin
    s_cmp_lg_u32 s26, 0
    s_cbranch_scc1 L2_nopub
    v_fma_f32 v72, v232, v48, v52
    v_fma_f32 v73, v232, v49, v53
    v_fma_f32 v74, v248, v50, v54
    v_fma_f32 v75, v248, v51, v55
    v_fma_f32 v64, -v233, v49, v72
    v_fma_f32 v65, v233, v48, v73
    v_fma_f32 v66, -v249, v51, v74
    v_fma_f32 v67, v249, v50, v75
    v_fma_f32 v72, v232, v64, v56
    v_fma_f32 v73, v232, v65, v57
    v_fma_f32 v74, v248, v66, v58
    v_fma_f32 v75, v248, v67, v59
    v_fma_f32 v76, -v233, v65, v72
    v_fma_f32 v77, v233, v64, v73
    v_fma_f32 v78, -v249, v67, v74
    v_fma_f32 v79, v249, v66, v75
    v_fma_f32 v72, v232, v76, v60
    v_fma_f32 v73, v232, v77, v61
    v_fma_f32 v74, v248, v78, v62
    v_fma_f32 v75, v248, v79, v63
    v_fma_f32 v64, -v233, v77, v72
    v_fma_f32 v65, v233, v76, v73
    v_fma_f32 v66, -v249, v79, v74
    v_fma_f32 v67, v249, v78, v75
    v_min_u32 v64, -2, v64
    v_min_u32 v65, -2, v65
    v_min_u32 v66, -2, v66
    v_min_u32 v67, -2, v67
    s_lshl_b32 s3, s28, 8
    s_add_u32 s3, s3, s67
    s_mov_b64 exec, 0xffff
    buffer_store_dwordx4 v[64:67], v12, s[8:11], s3 offen sc1
    s_mov_b64 exec, -1
L2_nopub:
    v_pk_mul_f32 v[72:73], v[236:237], v[160:161] op_sel_hi:[0,1]
    v_pk_mul_f32 v[74:75], v[236:237], v[160:161] op_sel:[1,0]
    v_pk_mul_f32 v[76:77], v[236:237], v[162:163] op_sel_hi:[0,1]
    v_pk_mul_f32 v[78:79], v[236:237], v[162:163] op_sel:[1,0]
    v_pk_fma_f32 v[160:161], v[236:237], v[176:177], v[72:73] op_sel:[1,0,0] neg_lo:[1,0,0] neg_hi:[1,0,0]
    v_pk_fma_f32 v[176:177], v[236:237], v[176:177], v[74:75] op_sel_hi:[0,1,1] neg_lo:[1,0,1] neg_hi:[1,0,1]
    v_pk_fma_f32 v[162:163], v[236:237], v[178:179], v[76:77] op_sel:[1,0,0] neg_lo:[1,0,0] neg_hi:[1,0,0]
    v_pk_fma_f32 v[178:179], v[236:237], v[178:179], v[78:79] op_sel_hi:[0,1,1] neg_lo:[1,0,1] neg_hi:[1,0,1]
    v_pk_mul_f32 v[72:73], v[236:237], v[164:165] op_sel_hi:[0,1]
    v_pk_mul_f32 v[74:75], v[236:237], v[164:165] op_sel:[1,0]
    v_pk_mul_f32 v[76:77], v[236:237], v[166:167] op_sel_hi:[0,1]
    v_pk_mul_f32 v[78:79], v[236:237], v[166:167] op_sel:[1,0]
    v_pk_fma_f32 v[164:165], v[236:237], v[180:181], v[72:73] op_sel:[1,0,0] neg_lo:[1,0,0] neg_hi:[1,0,0]
    v_pk_fma_f32 v[180:181], v[236:237], v[180:181], v[74:75] op_sel_hi:[0,1,1] neg_lo:[1,0,1] neg_hi:[1,0,1]
    v_pk_fma_f32 v[166:167], v[236:237], v[182:183], v[76:77] op_sel:[1,0,0] neg_lo:[1,0,0] neg_hi:[1,0,0]
    v_pk_fma_f32 v[182:183], v[236:237], v[182:183], v[78:79] op_sel_hi:[0,1,1] neg_lo:[1,0,1] neg_hi:[1,0,1]
    v_pk_mul_f32 v[72:73], v[236:237], v[168:169] op_sel_hi:[0,1]
    v_pk_mul_f32 v[74:75], v[236:237], v[168:169] op_sel:[1,0]
    v_pk_mul_f32 v[76:77], v[236:237], v[170:171] op_sel_hi:[0,1]
    v_pk_mul_f32 v[78:79], v[236:237], v[170:171] op_sel:[1,0]
    v_pk_fma_f32 v[168:169], v[236:237], v[184:185], v[72:73] op_sel:[1,0,0] neg_lo:[1,0,0] neg_hi:[1,0,0]
    v_pk_fma_f32 v[184:185], v[236:237], v[184:185], v[74:75] op_sel_hi:[0,1,1] neg_lo:[1,0,1] neg_hi:[1,0,1]
    v_pk_fma_f32 v[170:171], v[236:237], v[186:187], v[76:77] op_sel:[1,0,0] neg_lo:[1,0,0] neg_hi:[1,0,0]
    v_pk_fma_f32 v[186:187], v[236:237], v[186:187], v[78:79] op_sel_hi:[0,1,1] neg_lo:[1,0,1] neg_hi:[1,0,1]
    v_pk_mul_f32 v[72:73], v[236:237], v[172:173] op_sel_hi:[0,1]
    v_pk_mul_f32 v[74:75], v[236:237], v[172:173] op_sel:[1,0]
    v_pk_mul_f32 v[76:77], v[236:237], v[174:175] op_sel_hi:[0,1]
    v_pk_mul_f32 v[78:79], v[236:237], v[174:175] op_sel:[1,0]
    v_pk_fma_f32 v[172:173], v[236:237], v[188:189], v[72:73] op_sel:[1,0,0] neg_lo:[1,0,0] neg_hi:[1,0,0]
    v_pk_fma_f32 v[188:189], v[236:237], v[188:189], v[74:75] op_sel_hi:[0,1,1] neg_lo:[1,0,1] neg_hi:[1,0,1]
    v_pk_fma_f32 v[174:175], v[236:237], v[190:191], v[76:77] op_sel:[1,0,0] neg_lo:[1,0,0] neg_hi:[1,0,0]
    v_pk_fma_f32 v[190:191], v[236:237], v[190:191], v[78:79] op_sel_hi:[0,1,1] neg_lo:[1,0,1] neg_hi:[1,0,1]
    v_sub_f32 v72, 0, v226
    v_fmac_f32 v161, v224, v160
    v_fmac_f32 v177, v224, v176
    v_fmac_f32 v163, v224, v162
    v_fmac_f32 v179, v224, v178
    v_fmac_f32 v165, v224, v164
    v_fmac_f32 v181, v224, v180
    v_fmac_f32 v167, v224, v166
    v_fmac_f32 v183, v224, v182
    v_fmac_f32 v169, v224, v168
    v_fmac_f32 v185, v224, v184
    v_fmac_f32 v171, v224, v170
    v_fmac_f32 v187, v224, v186
    v_fmac_f32 v173, v224, v172
    v_fmac_f32 v189, v224, v188
    v_fmac_f32 v175, v224, v174
    v_fmac_f32 v191, v224, v190
    v_fmac_f32 v161, v226, v176
    v_fmac_f32 v177, v72, v160
    v_fmac_f32 v163, v226, v178
    v_fmac_f32 v179, v72, v162
    v_fmac_f32 v165, v226, v180
    v_fmac_f32 v181, v72, v164
    v_fmac_f32 v167, v226, v182
    v_fmac_f32 v183, v72, v166
    v_fmac_f32 v169, v226, v184
    v_fmac_f32 v185, v72, v168
    v_fmac_f32 v171, v226, v186
    v_fmac_f32 v187, v72, v170
    v_fmac_f32 v173, v226, v188
    v_fmac_f32 v189, v72, v172
    v_fmac_f32 v175, v226, v190
    v_fmac_f32 v191, v72, v174
    v_pk_mul_f32 v[72:73], v[252:253], v[192:193] op_sel_hi:[0,1]
    v_pk_mul_f32 v[74:75], v[252:253], v[192:193] op_sel:[1,0]
    v_pk_mul_f32 v[76:77], v[252:253], v[194:195] op_sel_hi:[0,1]
    v_pk_mul_f32 v[78:79], v[252:253], v[194:195] op_sel:[1,0]
    v_pk_fma_f32 v[192:193], v[252:253], v[208:209], v[72:73] op_sel:[1,0,0] neg_lo:[1,0,0] neg_hi:[1,0,0]
    v_pk_fma_f32 v[208:209], v[252:253], v[208:209], v[74:75] op_sel_hi:[0,1,1] neg_lo:[1,0,1] neg_hi:[1,0,1]
    v_pk_fma_f32 v[194:195], v[252:253], v[210:211], v[76:77] op_sel:[1,0,0] neg_lo:[1,0,0] neg_hi:[1,0,0]
    v_pk_fma_f32 v[210:211], v[252:253], v[210:211], v[78:79] op_sel_hi:[0,1,1] neg_lo:[1,0,1] neg_hi:[1,0,1]
    v_pk_mul_f32 v[72:73], v[252:253], v[196:197] op_sel_hi:[0,1]
    v_pk_mul_f32 v[74:75], v[252:253], v[196:197] op_sel:[1,0]
    v_pk_mul_f32 v[76:77], v[252:253], v[198:199] op_sel_hi:[0,1]
    v_pk_mul_f32 v[78:79], v[252:253], v[198:199] op_sel:[1,0]
    v_pk_fma_f32 v[196:197], v[252:253], v[212:213], v[72:73] op_sel:[1,0,0] neg_lo:[1,0,0] neg_hi:[1,0,0]
    v_pk_fma_f32 v[212:213], v[252:253], v[212:213], v[74:75] op_sel_hi:[0,1,1] neg_lo:[1,0,1] neg_hi:[1,0,1]
    v_pk_fma_f32 v[198:199], v[252:253], v[214:215], v[76:77] op_sel:[1,0,0] neg_lo:[1,0,0] neg_hi:[1,0,0]
    v_pk_fma_f32 v[214:215], v[252:253], v[214:215], v[78:79] op_sel_hi:[0,1,1] neg_lo:[1,0,1] neg_hi:[1,0,1]
    v_pk_mul_f32 v[72:73], v[252:253], v[200:201] op_sel_hi:[0,1]
    v_pk_mul_f32 v[74:75], v[252:253], v[200:201] op_sel:[1,0]
    v_pk_mul_f32 v[76:77], v[252:253], v[202:203] op_sel_hi:[0,1]
    v_pk_mul_f32 v[78:79], v[252:253], v[202:203] op_sel:[1,0]
    v_pk_fma_f32 v[200:201], v[252:253], v[216:217], v[72:73] op_sel:[1,0,0] neg_lo:[1,0,0] neg_hi:[1,0,0]
    v_pk_fma_f32 v[216:217], v[252:253], v[216:217], v[74:75] op_sel_hi:[0,1,1] neg_lo:[1,0,1] neg_hi:[1,0,1]
    v_pk_fma_f32 v[202:203], v[252:253], v[218:219], v[76:77] op_sel:[1,0,0] neg_lo:[1,0,0] neg_hi:[1,0,0]
    v_pk_fma_f32 v[218:219], v[252:253], v[218:219], v[78:79] op_sel_hi:[0,1,1] neg_lo:[1,0,1] neg_hi:[1,0,1]
    v_pk_mul_f32 v[72:73], v[252:253], v[204:205] op_sel_hi:[0,1]
    v_pk_mul_f32 v[74:75], v[252:253], v[204:205] op_sel:[1,0]
    v_pk_mul_f32 v[76:77], v[252:253], v[206:207] op_sel_hi:[0,1]
    v_pk_mul_f32 v[78:79], v[252:253], v[206:207] op_sel:[1,0]
    v_pk_fma_f32 v[204:205], v[252:253], v[220:221], v[72:73] op_sel:[1,0,0] neg_lo:[1,0,0] neg_hi:[1,0,0]
    v_pk_fma_f32 v[220:221], v[252:253], v[220:221], v[74:75] op_sel_hi:[0,1,1] neg_lo:[1,0,1] neg_hi:[1,0,1]
    v_pk_fma_f32 v[206:207], v[252:253], v[222:223], v[76:77] op_sel:[1,0,0] neg_lo:[1,0,0] neg_hi:[1,0,0]
    v_pk_fma_f32 v[222:223], v[252:253], v[222:223], v[78:79] op_sel_hi:[0,1,1] neg_lo:[1,0,1] neg_hi:[1,0,1]
    v_sub_f32 v72, 0, v242
    v_fmac_f32 v193, v240, v192
    v_fmac_f32 v209, v240, v208
    v_fmac_f32 v195, v240, v194
    v_fmac_f32 v211, v240, v210
    v_fmac_f32 v197, v240, v196
    v_fmac_f32 v213, v240, v212
    v_fmac_f32 v199, v240, v198
    v_fmac_f32 v215, v240, v214
    v_fmac_f32 v201, v240, v200
    v_fmac_f32 v217, v240, v216
    v_fmac_f32 v203, v240, v202
    v_fmac_f32 v219, v240, v218
    v_fmac_f32 v205, v240, v204
    v_fmac_f32 v221, v240, v220
    v_fmac_f32 v207, v240, v206
    v_fmac_f32 v223, v240, v222
    v_fmac_f32 v193, v242, v208
    v_fmac_f32 v209, v72, v192
    v_fmac_f32 v195, v242, v210
    v_fmac_f32 v211, v72, v194
    v_fmac_f32 v197, v242, v212
    v_fmac_f32 v213, v72, v196
    v_fmac_f32 v199, v242, v214
    v_fmac_f32 v215, v72, v198
    v_fmac_f32 v201, v242, v216
    v_fmac_f32 v217, v72, v200
    v_fmac_f32 v203, v242, v218
    v_fmac_f32 v219, v72, v202
    v_fmac_f32 v205, v242, v220
    v_fmac_f32 v221, v72, v204
    v_fmac_f32 v207, v242, v222
    v_fmac_f32 v223, v72, v206
    s_lshr_b32 s66, s64, 2
    s_lshl_b32 s66, s66, 18
    s_and_b32 s3, s64, 3
    s_lshl_b32 s3, s3, 12
    s_add_u32 s66, s66, s3
    s_add_u32 s66, s66, s65
    s_add_u32 s64, s64, 1
    v_pk_mul_f32 v[16:17], v[96:97], v[96:97]
    v_pk_mul_f32 v[18:19], v[98:99], v[98:99]
    v_pk_mul_f32 v[20:21], v[100:101], v[100:101]
    v_pk_mul_f32 v[22:23], v[102:103], v[102:103]
    v_pk_fma_f32 v[16:17], v[16:17], v[36:37], v[38:39]
    v_pk_fma_f32 v[18:19], v[18:19], v[36:37], v[38:39]
    v_pk_fma_f32 v[20:21], v[20:21], v[36:37], v[38:39]
    v_pk_fma_f32 v[22:23], v[22:23], v[36:37], v[38:39]
    v_pk_mul_f32 v[16:17], v[16:17], v[96:97]
    v_pk_mul_f32 v[18:19], v[18:19], v[98:99]
    v_pk_mul_f32 v[20:21], v[20:21], v[100:101]
    v_pk_mul_f32 v[22:23], v[22:23], v[102:103]
    v_exp_f32 v16, v16
    v_exp_f32 v17, v17
    v_pk_mul_f32 v[24:25], v[96:97], v[112:113]
    v_exp_f32 v18, v18
    v_exp_f32 v19, v19
    v_pk_mul_f32 v[26:27], v[98:99], v[114:115]
    v_exp_f32 v20, v20
    v_exp_f32 v21, v21
    v_pk_mul_f32 v[28:29], v[100:101], v[116:117]
    v_exp_f32 v22, v22
    v_exp_f32 v23, v23
    v_pk_mul_f32 v[30:31], v[102:103], v[118:119]
    v_pk_add_f32 v[16:17], v[16:17], 1.0 op_sel_hi:[1,0]
    v_pk_add_f32 v[18:19], v[18:19], 1.0 op_sel_hi:[1,0]
    v_pk_add_f32 v[20:21], v[20:21], 1.0 op_sel_hi:[1,0]
    v_pk_add_f32 v[22:23], v[22:23], 1.0 op_sel_hi:[1,0]
    v_rcp_f32 v16, v16
    v_rcp_f32 v17, v17
    v_rcp_f32 v18, v18
    v_rcp_f32 v19, v19
    v_rcp_f32 v20, v20
    v_rcp_f32 v21, v21
    v_rcp_f32 v22, v22
    v_rcp_f32 v23, v23
    v_pk_mul_f32 v[24:25], v[24:25], v[16:17]
    v_pk_mul_f32 v[26:27], v[26:27], v[18:19]
    v_pk_mul_f32 v[28:29], v[28:29], v[20:21]
    v_pk_mul_f32 v[30:31], v[30:31], v[22:23]
    v_cvt_pk_bf16_f32 v96, v24, v25
    v_cvt_pk_bf16_f32 v97, v26, v27
    v_cvt_pk_bf16_f32 v98, v28, v29
    v_cvt_pk_bf16_f32 v99, v30, v31
    buffer_store_dwordx4 v[96:99], v10, s[8:11], s66 offen sc1
    v_pk_mul_f32 v[16:17], v[104:105], v[104:105]
    v_pk_mul_f32 v[18:19], v[106:107], v[106:107]
    v_pk_mul_f32 v[20:21], v[108:109], v[108:109]
    v_pk_mul_f32 v[22:23], v[110:111], v[110:111]
    v_pk_fma_f32 v[16:17], v[16:17], v[36:37], v[38:39]
    v_pk_fma_f32 v[18:19], v[18:19], v[36:37], v[38:39]
    v_pk_fma_f32 v[20:21], v[20:21], v[36:37], v[38:39]
    v_pk_fma_f32 v[22:23], v[22:23], v[36:37], v[38:39]
    v_pk_mul_f32 v[16:17], v[16:17], v[104:105]
    v_pk_mul_f32 v[18:19], v[18:19], v[106:107]
    v_pk_mul_f32 v[20:21], v[20:21], v[108:109]
    v_pk_mul_f32 v[22:23], v[22:23], v[110:111]
    v_exp_f32 v16, v16
    v_exp_f32 v17, v17
    v_pk_mul_f32 v[24:25], v[104:105], v[120:121]
    v_exp_f32 v18, v18
    v_exp_f32 v19, v19
    v_pk_mul_f32 v[26:27], v[106:107], v[122:123]
    v_exp_f32 v20, v20
    v_exp_f32 v21, v21
    v_pk_mul_f32 v[28:29], v[108:109], v[124:125]
    v_exp_f32 v22, v22
    v_exp_f32 v23, v23
    v_pk_mul_f32 v[30:31], v[110:111], v[126:127]
    v_pk_add_f32 v[16:17], v[16:17], 1.0 op_sel_hi:[1,0]
    v_pk_add_f32 v[18:19], v[18:19], 1.0 op_sel_hi:[1,0]
    v_pk_add_f32 v[20:21], v[20:21], 1.0 op_sel_hi:[1,0]
    v_pk_add_f32 v[22:23], v[22:23], 1.0 op_sel_hi:[1,0]
    v_rcp_f32 v16, v16
    v_rcp_f32 v17, v17
    v_rcp_f32 v18, v18
    v_rcp_f32 v19, v19
    v_rcp_f32 v20, v20
    v_rcp_f32 v21, v21
    v_rcp_f32 v22, v22
    v_rcp_f32 v23, v23
    v_pk_mul_f32 v[24:25], v[24:25], v[16:17]
    v_pk_mul_f32 v[26:27], v[26:27], v[18:19]
    v_pk_mul_f32 v[28:29], v[28:29], v[20:21]
    v_pk_mul_f32 v[30:31], v[30:31], v[22:23]
    v_cvt_pk_bf16_f32 v104, v24, v25
    v_cvt_pk_bf16_f32 v105, v26, v27
    v_cvt_pk_bf16_f32 v106, v28, v29
    v_cvt_pk_bf16_f32 v107, v30, v31
    buffer_store_dwordx4 v[104:107], v11, s[8:11], s66 offen sc1
    s_lshr_b32 s66, s64, 2
    s_lshl_b32 s66, s66, 18
    s_and_b32 s3, s64, 3
    s_lshl_b32 s3, s3, 12
    s_add_u32 s66, s66, s3
    s_add_u32 s66, s66, s65
    s_add_u32 s64, s64, 1
    v_pk_mul_f32 v[16:17], v[128:129], v[128:129]
    v_pk_mul_f32 v[18:19], v[130:131], v[130:131]
    v_pk_mul_f32 v[20:21], v[132:133], v[132:133]
    v_pk_mul_f32 v[22:23], v[134:135], v[134:135]
    v_pk_fma_f32 v[16:17], v[16:17], v[36:37], v[38:39]
    v_pk_fma_f32 v[18:19], v[18:19], v[36:37], v[38:39]
    v_pk_fma_f32 v[20:21], v[20:21], v[36:37], v[38:39]
    v_pk_fma_f32 v[22:23], v[22:23], v[36:37], v[38:39]
    v_pk_mul_f32 v[16:17], v[16:17], v[128:129]
    v_pk_mul_f32 v[18:19], v[18:19], v[130:131]
    v_pk_mul_f32 v[20:21], v[20:21], v[132:133]
    v_pk_mul_f32 v[22:23], v[22:23], v[134:135]
    v_exp_f32 v16, v16
    v_exp_f32 v17, v17
    v_pk_mul_f32 v[24:25], v[128:129], v[144:145]
    v_exp_f32 v18, v18
    v_exp_f32 v19, v19
    v_pk_mul_f32 v[26:27], v[130:131], v[146:147]
    v_exp_f32 v20, v20
    v_exp_f32 v21, v21
    v_pk_mul_f32 v[28:29], v[132:133], v[148:149]
    v_exp_f32 v22, v22
    v_exp_f32 v23, v23
    v_pk_mul_f32 v[30:31], v[134:135], v[150:151]
    v_pk_add_f32 v[16:17], v[16:17], 1.0 op_sel_hi:[1,0]
    v_pk_add_f32 v[18:19], v[18:19], 1.0 op_sel_hi:[1,0]
    v_pk_add_f32 v[20:21], v[20:21], 1.0 op_sel_hi:[1,0]
    v_pk_add_f32 v[22:23], v[22:23], 1.0 op_sel_hi:[1,0]
    v_rcp_f32 v16, v16
    v_rcp_f32 v17, v17
    v_rcp_f32 v18, v18
    v_rcp_f32 v19, v19
    v_rcp_f32 v20, v20
    v_rcp_f32 v21, v21
    v_rcp_f32 v22, v22
    v_rcp_f32 v23, v23
    v_pk_mul_f32 v[24:25], v[24:25], v[16:17]
    v_pk_mul_f32 v[26:27], v[26:27], v[18:19]
    v_pk_mul_f32 v[28:29], v[28:29], v[20:21]
    v_pk_mul_f32 v[30:31], v[30:31], v[22:23]
    v_cvt_pk_bf16_f32 v128, v24, v25
    v_cvt_pk_bf16_f32 v129, v26, v27
    v_cvt_pk_bf16_f32 v130, v28, v29
    v_cvt_pk_bf16_f32 v131, v30, v31
    buffer_store_dwordx4 v[128:131], v10, s[8:11], s66 offen sc1
    v_pk_mul_f32 v[16:17], v[136:137], v[136:137]
    v_pk_mul_f32 v[18:19], v[138:139], v[138:139]
    v_pk_mul_f32 v[20:21], v[140:141], v[140:141]
    v_pk_mul_f32 v[22:23], v[142:143], v[142:143]
    v_pk_fma_f32 v[16:17], v[16:17], v[36:37], v[38:39]
    v_pk_fma_f32 v[18:19], v[18:19], v[36:37], v[38:39]
    v_pk_fma_f32 v[20:21], v[20:21], v[36:37], v[38:39]
    v_pk_fma_f32 v[22:23], v[22:23], v[36:37], v[38:39]
    v_pk_mul_f32 v[16:17], v[16:17], v[136:137]
    v_pk_mul_f32 v[18:19], v[18:19], v[138:139]
    v_pk_mul_f32 v[20:21], v[20:21], v[140:141]
    v_pk_mul_f32 v[22:23], v[22:23], v[142:143]
    v_exp_f32 v16, v16
    v_exp_f32 v17, v17
    v_pk_mul_f32 v[24:25], v[136:137], v[152:153]
    v_exp_f32 v18, v18
    v_exp_f32 v19, v19
    v_pk_mul_f32 v[26:27], v[138:139], v[154:155]
    v_exp_f32 v20, v20
    v_exp_f32 v21, v21
    v_pk_mul_f32 v[28:29], v[140:141], v[156:157]
    v_exp_f32 v22, v22
    v_exp_f32 v23, v23
    v_pk_mul_f32 v[30:31], v[142:143], v[158:159]
    v_pk_add_f32 v[16:17], v[16:17], 1.0 op_sel_hi:[1,0]
    v_pk_add_f32 v[18:19], v[18:19], 1.0 op_sel_hi:[1,0]
    v_pk_add_f32 v[20:21], v[20:21], 1.0 op_sel_hi:[1,0]
    v_pk_add_f32 v[22:23], v[22:23], 1.0 op_sel_hi:[1,0]
    v_rcp_f32 v16, v16
    v_rcp_f32 v17, v17
    v_rcp_f32 v18, v18
    v_rcp_f32 v19, v19
    v_rcp_f32 v20, v20
    v_rcp_f32 v21, v21
    v_rcp_f32 v22, v22
    v_rcp_f32 v23, v23
    v_pk_mul_f32 v[24:25], v[24:25], v[16:17]
    v_pk_mul_f32 v[26:27], v[26:27], v[18:19]
    v_pk_mul_f32 v[28:29], v[28:29], v[20:21]
    v_pk_mul_f32 v[30:31], v[30:31], v[22:23]
    v_cvt_pk_bf16_f32 v136, v24, v25
    v_cvt_pk_bf16_f32 v137, v26, v27
    v_cvt_pk_bf16_f32 v138, v28, v29
    v_cvt_pk_bf16_f32 v139, v30, v31
    buffer_store_dwordx4 v[136:139], v11, s[8:11], s66 offen sc1
    v_mov_b32 v64, 0
    v_mov_b32 v65, 0
    v_mov_b32 v66, 0
    v_mov_b32 v67, 0
    s_cmp_eq_u32 s28, 0
    s_cbranch_scc1 L2_nocarry
    s_sub_u32 s4, s28, 1
    s_mov_b32 s5, 0
L2_poll:
    s_min_u32 s3, s4, 0
    s_lshl_b32 s3, s3, 8
    s_add_u32 s3, s3, s67
    buffer_load_dwordx4 v[16:19], v12, s[8:11], s3 offen sc1
    s_min_u32 s3, s4, 1
    s_lshl_b32 s3, s3, 8
    s_add_u32 s3, s3, s67
    buffer_load_dwordx4 v[20:23], v12, s[8:11], s3 offen sc1
    s_min_u32 s3, s4, 2
    s_lshl_b32 s3, s3, 8
    s_add_u32 s3, s3, s67
    buffer_load_dwordx4 v[24:27], v12, s[8:11], s3 offen sc1
    s_min_u32 s3, s4, 3
    s_lshl_b32 s3, s3, 8
    s_add_u32 s3, s3, s67
    buffer_load_dwordx4 v[28:31], v12, s[8:11], s3 offen sc1
    s_min_u32 s3, s4, 4
    s_lshl_b32 s3, s3, 8
    s_add_u32 s3, s3, s67
    buffer_load_dwordx4 v[32:35], v12, s[8:11], s3 offen sc1
    s_min_u32 s3, s4, 5
    s_lshl_b32 s3, s3, 8
    s_add_u32 s3, s3, s67
    buffer_load_dwordx4 v[36:39], v12, s[8:11], s3 offen sc1
    s_min_u32 s3, s4, 6
    s_lshl_b32 s3, s3, 8
    s_add_u32 s3, s3, s67
    buffer_load_dwordx4 v[40:43], v12, s[8:11], s3 offen sc1
    s_waitcnt vmcnt(0)
    v_max_u32 v72, v16, v17
    v_max3_u32 v72, v72, v18, v19
    v_max3_u32 v72, v72, v20, v21
    v_max3_u32 v72, v72, v22, v23
    v_max3_u32 v72, v72, v24, v25
    v_max3_u32 v72, v72, v26, v27
    v_max3_u32 v72, v72, v28, v29
    v_max3_u32 v72, v72, v30, v31
    v_max3_u32 v72, v72, v32, v33
    v_max3_u32 v72, v72, v34, v35
    v_max3_u32 v72, v72, v36, v37
    v_max3_u32 v72, v72, v38, v39
    v_max3_u32 v72, v72, v40, v41
    v_max3_u32 v72, v72, v42, v43
    v_cmp_eq_u32 vcc, -1, v72
    s_nop 4
    s_cbranch_vccz L2_got
    s_sleep 1
    s_add_u32 s5, s5, 1
    s_cmp_lt_u32 s5, 0x10000
    s_cbranch_scc1 L2_poll
L2_got:
    v_mov_b32 v64, v16
    v_mov_b32 v65, v17
    v_mov_b32 v66, v18
    v_mov_b32 v67, v19
    s_cmp_le_u32 s28, 1
    s_cbranch_scc1 L2_nocarry
    v_pk_fma_f32 v[72:73], v[234:235], v[64:65], v[20:21] op_sel_hi:[0,1,1]
    v_pk_fma_f32 v[74:75], v[250:251], v[66:67], v[22:23] op_sel_hi:[0,1,1]
    v_pk_fma_f32 v[64:65], v[234:235], v[64:65], v[72:73] op_sel:[1,1,0] op_sel_hi:[1,0,1] neg_lo:[1,0,0]
    v_pk_fma_f32 v[66:67], v[250:251], v[66:67], v[74:75] op_sel:[1,1,0] op_sel_hi:[1,0,1] neg_lo:[1,0,0]
    s_cmp_le_u32 s28, 2
    s_cbranch_scc1 L2_nocarry
    v_pk_fma_f32 v[72:73], v[234:235], v[64:65], v[24:25] op_sel_hi:[0,1,1]
    v_pk_fma_f32 v[74:75], v[250:251], v[66:67], v[26:27] op_sel_hi:[0,1,1]
    v_pk_fma_f32 v[64:65], v[234:235], v[64:65], v[72:73] op_sel:[1,1,0] op_sel_hi:[1,0,1] neg_lo:[1,0,0]
    v_pk_fma_f32 v[66:67], v[250:251], v[66:67], v[74:75] op_sel:[1,1,0] op_sel_hi:[1,0,1] neg_lo:[1,0,0]
    s_cmp_le_u32 s28, 3
    s_cbranch_scc1 L2_nocarry
    v_pk_fma_f32 v[72:73], v[234:235], v[64:65], v[28:29] op_sel_hi:[0,1,1]
    v_pk_fma_f32 v[74:75], v[250:251], v[66:67], v[30:31] op_sel_hi:[0,1,1]
    v_pk_fma_f32 v[64:65], v[234:235], v[64:65], v[72:73] op_sel:[1,1,0] op_sel_hi:[1,0,1] neg_lo:[1,0,0]
    v_pk_fma_f32 v[66:67], v[250:251], v[66:67], v[74:75] op_sel:[1,1,0] op_sel_hi:[1,0,1] neg_lo:[1,0,0]
    s_cmp_le_u32 s28, 4
    s_cbranch_scc1 L2_nocarry
    v_pk_fma_f32 v[72:73], v[234:235], v[64:65], v[32:33] op_sel_hi:[0,1,1]
    v_pk_fma_f32 v[74:75], v[250:251], v[66:67], v[34:35] op_sel_hi:[0,1,1]
    v_pk_fma_f32 v[64:65], v[234:235], v[64:65], v[72:73] op_sel:[1,1,0] op_sel_hi:[1,0,1] neg_lo:[1,0,0]
    v_pk_fma_f32 v[66:67], v[250:251], v[66:67], v[74:75] op_sel:[1,1,0] op_sel_hi:[1,0,1] neg_lo:[1,0,0]
    s_cmp_le_u32 s28, 5
    s_cbranch_scc1 L2_nocarry
    v_pk_fma_f32 v[72:73], v[234:235], v[64:65], v[36:37] op_sel_hi:[0,1,1]
    v_pk_fma_f32 v[74:75], v[250:251], v[66:67], v[38:39] op_sel_hi:[0,1,1]
    v_pk_fma_f32 v[64:65], v[234:235], v[64:65], v[72:73] op_sel:[1,1,0] op_sel_hi:[1,0,1] neg_lo:[1,0,0]
    v_pk_fma_f32 v[66:67], v[250:251], v[66:67], v[74:75] op_sel:[1,1,0] op_sel_hi:[1,0,1] neg_lo:[1,0,0]
    s_cmp_le_u32 s28, 6
    s_cbranch_scc1 L2_nocarry
    v_pk_fma_f32 v[72:73], v[234:235], v[64:65], v[40:41] op_sel_hi:[0,1,1]
    v_pk_fma_f32 v[74:75], v[250:251], v[66:67], v[42:43] op_sel_hi:[0,1,1]
    v_pk_fma_f32 v[64:65], v[234:235], v[64:65], v[72:73] op_sel:[1,1,0] op_sel_hi:[1,0,1] neg_lo:[1,0,0]
    v_pk_fma_f32 v[66:67], v[250:251], v[66:67], v[74:75] op_sel:[1,1,0] op_sel_hi:[1,0,1] neg_lo:[1,0,0]
L2_nocarry:
    s_cmp_le_u32 s26, 0
    s_cbranch_scc1 L2_hw
    v_pk_fma_f32 v[72:73], v[232:233], v[64:65], v[48:49] op_sel_hi:[0,1,1]
    v_pk_fma_f32 v[74:75], v[248:249], v[66:67], v[50:51] op_sel_hi:[0,1,1]
    v_pk_fma_f32 v[64:65], v[232:233], v[64:65], v[72:73] op_sel:[1,1,0] op_sel_hi:[1,0,1] neg_lo:[1,0,0]
    v_pk_fma_f32 v[66:67], v[248:249], v[66:67], v[74:75] op_sel:[1,1,0] op_sel_hi:[1,0,1] neg_lo:[1,0,0]
    s_cmp_le_u32 s26, 1
    s_cbranch_scc1 L2_hw
    v_pk_fma_f32 v[72:73], v[232:233], v[64:65], v[52:53] op_sel_hi:[0,1,1]
    v_pk_fma_f32 v[74:75], v[248:249], v[66:67], v[54:55] op_sel_hi:[0,1,1]
    v_pk_fma_f32 v[64:65], v[232:233], v[64:65], v[72:73] op_sel:[1,1,0] op_sel_hi:[1,0,1] neg_lo:[1,0,0]
    v_pk_fma_f32 v[66:67], v[248:249], v[66:67], v[74:75] op_sel:[1,1,0] op_sel_hi:[1,0,1] neg_lo:[1,0,0]
    s_cmp_le_u32 s26, 2
    s_cbranch_scc1 L2_hw
    v_pk_fma_f32 v[72:73], v[232:233], v[64:65], v[56:57] op_sel_hi:[0,1,1]
    v_pk_fma_f32 v[74:75], v[248:249], v[66:67], v[58:59] op_sel_hi:[0,1,1]
    v_pk_fma_f32 v[64:65], v[232:233], v[64:65], v[72:73] op_sel:[1,1,0] op_sel_hi:[1,0,1] neg_lo:[1,0,0]
    v_pk_fma_f32 v[66:67], v[248:249], v[66:67], v[74:75] op_sel:[1,1,0] op_sel_hi:[1,0,1] neg_lo:[1,0,0]
L2_hw:
    v_pk_fma_f32 v[72:73], v[238:239], v[64:65], v[68:69] op_sel_hi:[0,1,1]
    v_pk_fma_f32 v[74:75], v[254:255], v[66:67], v[70:71] op_sel_hi:[0,1,1]
    v_pk_fma_f32 v[64:65], v[238:239], v[64:65], v[72:73] op_sel:[1,1,0] op_sel_hi:[1,0,1] neg_lo:[1,0,0]
    v_pk_fma_f32 v[66:67], v[254:255], v[66:67], v[74:75] op_sel:[1,1,0] op_sel_hi:[1,0,1] neg_lo:[1,0,0]
    v_mul_f32 v72, v236, v64
    v_mul_f32 v73, v237, v64
    v_mul_f32 v74, v252, v66
    v_mul_f32 v75, v253, v66
    v_fma_f32 v49, -v237, v65, v72
    v_fma_f32 v51, -v236, v65, -v73
    v_fma_f32 v53, -v253, v67, v74
    v_fma_f32 v55, -v252, v67, -v75
    s_lshr_b32 s66, s27, 1
    s_lshl_b32 s66, s66, 18
    s_and_b32 s3, s27, 1
    s_lshl_b32 s3, s3, 13
    s_add_u32 s66, s66, s3
    s_add_u32 s66, s66, s65
    v_pk_fma_f32 v[160:161], v[224:225], v[48:49], v[160:161] op_sel:[0,1,0]
    v_pk_fma_f32 v[176:177], v[224:225], v[50:51], v[176:177] op_sel:[0,1,0]
    v_pk_fma_f32 v[192:193], v[240:241], v[52:53], v[192:193] op_sel:[0,1,0]
    v_pk_fma_f32 v[208:209], v[240:241], v[54:55], v[208:209] op_sel:[0,1,0]
    v_pk_fma_f32 v[160:161], v[226:227], v[50:51], v[160:161] op_sel:[0,1,0]
    v_pk_fma_f32 v[176:177], v[226:227], v[48:49], v[176:177] op_sel:[0,1,0] neg_lo:[1,0,0] neg_hi:[1,0,0]
    v_pk_fma_f32 v[192:193], v[242:243], v[54:55], v[192:193] op_sel:[0,1,0]
    v_pk_fma_f32 v[208:209], v[242:243], v[52:53], v[208:209] op_sel:[0,1,0] neg_lo:[1,0,0] neg_hi:[1,0,0]
    v_pk_fma_f32 v[162:163], v[224:225], v[160:161], v[162:163] op_sel:[0,1,0]
    v_pk_fma_f32 v[178:179], v[224:225], v[176:177], v[178:179] op_sel:[0,1,0]
    v_pk_fma_f32 v[194:195], v[240:241], v[192:193], v[194:195] op_sel:[0,1,0]
    v_pk_fma_f32 v[210:211], v[240:241], v[208:209], v[210:211] op_sel:[0,1,0]
    v_pk_fma_f32 v[162:163], v[226:227], v[176:177], v[162:163] op_sel:[0,1,0]
    v_pk_fma_f32 v[178:179], v[226:227], v[160:161], v[178:179] op_sel:[0,1,0] neg_lo:[1,0,0] neg_hi:[1,0,0]
    v_pk_fma_f32 v[194:195], v[242:243], v[208:209], v[194:195] op_sel:[0,1,0]
    v_pk_fma_f32 v[210:211], v[242:243], v[192:193], v[210:211] op_sel:[0,1,0] neg_lo:[1,0,0] neg_hi:[1,0,0]
    v_pk_fma_f32 v[164:165], v[224:225], v[162:163], v[164:165] op_sel:[0,1,0]
    v_pk_fma_f32 v[180:181], v[224:225], v[178:179], v[180:181] op_sel:[0,1,0]
    v_pk_fma_f32 v[196:197], v[240:241], v[194:195], v[196:197] op_sel:[0,1,0]
    v_pk_fma_f32 v[212:213], v[240:241], v[210:211], v[212:213] op_sel:[0,1,0]
    v_pk_fma_f32 v[164:165], v[226:227], v[178:179], v[164:165] op_sel:[0,1,0]
    v_pk_fma_f32 v[180:181], v[226:227], v[162:163], v[180:181] op_sel:[0,1,0] neg_lo:[1,0,0] neg_hi:[1,0,0]
    v_pk_fma_f32 v[196:197], v[242:243], v[210:211], v[196:197] op_sel:[0,1,0]
    v_pk_fma_f32 v[212:213], v[242:243], v[194:195], v[212:213] op_sel:[0,1,0] neg_lo:[1,0,0] neg_hi:[1,0,0]
    v_pk_fma_f32 v[166:167], v[224:225], v[164:165], v[166:167] op_sel:[0,1,0]
    v_pk_fma_f32 v[182:183], v[224:225], v[180:181], v[182:183] op_sel:[0,1,0]
    v_pk_fma_f32 v[198:199], v[240:241], v[196:197], v[198:199] op_sel:[0,1,0]
    v_pk_fma_f32 v[214:215], v[240:241], v[212:213], v[214:215] op_sel:[0,1,0]
    v_pk_fma_f32 v[166:167], v[226:227], v[180:181], v[166:167] op_sel:[0,1,0]
    v_pk_fma_f32 v[182:183], v[226:227], v[164:165], v[182:183] op_sel:[0,1,0] neg_lo:[1,0,0] neg_hi:[1,0,0]
    v_pk_fma_f32 v[198:199], v[242:243], v[212:213], v[198:199] op_sel:[0,1,0]
    v_pk_fma_f32 v[214:215], v[242:243], v[196:197], v[214:215] op_sel:[0,1,0] neg_lo:[1,0,0] neg_hi:[1,0,0]
    s_add_u32 s3, s66, 0
    v_cvt_pk_bf16_f32 v16, v160, v161
    v_cvt_pk_bf16_f32 v17, v162, v163
    v_cvt_pk_bf16_f32 v18, v164, v165
    v_cvt_pk_bf16_f32 v19, v166, v167
    buffer_store_dwordx4 v[16:19], v10, s[8:11], s3 offen sc1
    s_add_u32 s3, s66, 4194304
    v_cvt_pk_bf16_f32 v20, v176, v177
    v_cvt_pk_bf16_f32 v21, v178, v179
    v_cvt_pk_bf16_f32 v22, v180, v181
    v_cvt_pk_bf16_f32 v23, v182, v183
    buffer_store_dwordx4 v[20:23], v10, s[8:11], s3 offen sc1
    s_add_u32 s3, s66, 4096
    v_cvt_pk_bf16_f32 v24, v192, v193
    v_cvt_pk_bf16_f32 v25, v194, v195
    v_cvt_pk_bf16_f32 v26, v196, v197
    v_cvt_pk_bf16_f32 v27, v198, v199
    buffer_store_dwordx4 v[24:27], v10, s[8:11], s3 offen sc1
    s_add_u32 s3, s66, 4198400
    v_cvt_pk_bf16_f32 v28, v208, v209
    v_cvt_pk_bf16_f32 v29, v210, v211
    v_cvt_pk_bf16_f32 v30, v212, v213
    v_cvt_pk_bf16_f32 v31, v214, v215
    buffer_store_dwordx4 v[28:31], v10, s[8:11], s3 offen sc1
    v_pk_fma_f32 v[168:169], v[224:225], v[166:167], v[168:169] op_sel:[0,1,0]
    v_pk_fma_f32 v[184:185], v[224:225], v[182:183], v[184:185] op_sel:[0,1,0]
    v_pk_fma_f32 v[200:201], v[240:241], v[198:199], v[200:201] op_sel:[0,1,0]
    v_pk_fma_f32 v[216:217], v[240:241], v[214:215], v[216:217] op_sel:[0,1,0]
    v_pk_fma_f32 v[168:169], v[226:227], v[182:183], v[168:169] op_sel:[0,1,0]
    v_pk_fma_f32 v[184:185], v[226:227], v[166:167], v[184:185] op_sel:[0,1,0] neg_lo:[1,0,0] neg_hi:[1,0,0]
    v_pk_fma_f32 v[200:201], v[242:243], v[214:215], v[200:201] op_sel:[0,1,0]
    v_pk_fma_f32 v[216:217], v[242:243], v[198:199], v[216:217] op_sel:[0,1,0] neg_lo:[1,0,0] neg_hi:[1,0,0]
    v_pk_fma_f32 v[170:171], v[224:225], v[168:169], v[170:171] op_sel:[0,1,0]
    v_pk_fma_f32 v[186:187], v[224:225], v[184:185], v[186:187] op_sel:[0,1,0]
    v_pk_fma_f32 v[202:203], v[240:241], v[200:201], v[202:203] op_sel:[0,1,0]
    v_pk_fma_f32 v[218:219], v[240:241], v[216:217], v[218:219] op_sel:[0,1,0]
    v_pk_fma_f32 v[170:171], v[226:227], v[184:185], v[170:171] op_sel:[0,1,0]
    v_pk_fma_f32 v[186:187], v[226:227], v[168:169], v[186:187] op_sel:[0,1,0] neg_lo:[1,0,0] neg_hi:[1,0,0]
    v_pk_fma_f32 v[202:203], v[242:243], v[216:217], v[202:203] op_sel:[0,1,0]
    v_pk_fma_f32 v[218:219], v[242:243], v[200:201], v[218:219] op_sel:[0,1,0] neg_lo:[1,0,0] neg_hi:[1,0,0]
    v_pk_fma_f32 v[172:173], v[224:225], v[170:171], v[172:173] op_sel:[0,1,0]
    v_pk_fma_f32 v[188:189], v[224:225], v[186:187], v[188:189] op_sel:[0,1,0]
    v_pk_fma_f32 v[204:205], v[240:241], v[202:203], v[204:205] op_sel:[0,1,0]
    v_pk_fma_f32 v[220:221], v[240:241], v[218:219], v[220:221] op_sel:[0,1,0]
    v_pk_fma_f32 v[172:173], v[226:227], v[186:187], v[172:173] op_sel:[0,1,0]
    v_pk_fma_f32 v[188:189], v[226:227], v[170:171], v[188:189] op_sel:[0,1,0] neg_lo:[1,0,0] neg_hi:[1,0,0]
    v_pk_fma_f32 v[204:205], v[242:243], v[218:219], v[204:205] op_sel:[0,1,0]
    v_pk_fma_f32 v[220:221], v[242:243], v[202:203], v[220:221] op_sel:[0,1,0] neg_lo:[1,0,0] neg_hi:[1,0,0]
    v_pk_fma_f32 v[174:175], v[224:225], v[172:173], v[174:175] op_sel:[0,1,0]
    v_pk_fma_f32 v[190:191], v[224:225], v[188:189], v[190:191] op_sel:[0,1,0]
    v_pk_fma_f32 v[206:207], v[240:241], v[204:205], v[206:207] op_sel:[0,1,0]
    v_pk_fma_f32 v[222:223], v[240:241], v[220:221], v[222:223] op_sel:[0,1,0]
    v_pk_fma_f32 v[174:175], v[226:227], v[188:189], v[174:175] op_sel:[0,1,0]
    v_pk_fma_f32 v[190:191], v[226:227], v[172:173], v[190:191] op_sel:[0,1,0] neg_lo:[1,0,0] neg_hi:[1,0,0]
    v_pk_fma_f32 v[206:207], v[242:243], v[220:221], v[206:207] op_sel:[0,1,0]
    v_pk_fma_f32 v[222:223], v[242:243], v[204:205], v[222:223] op_sel:[0,1,0] neg_lo:[1,0,0] neg_hi:[1,0,0]
    s_add_u32 s3, s66, 0
    v_cvt_pk_bf16_f32 v32, v168, v169
    v_cvt_pk_bf16_f32 v33, v170, v171
    v_cvt_pk_bf16_f32 v34, v172, v173
    v_cvt_pk_bf16_f32 v35, v174, v175
    buffer_store_dwordx4 v[32:35], v11, s[8:11], s3 offen sc1
    s_add_u32 s3, s66, 4194304
    v_cvt_pk_bf16_f32 v36, v184, v185
    v_cvt_pk_bf16_f32 v37, v186, v187
    v_cvt_pk_bf16_f32 v38, v188, v189
    v_cvt_pk_bf16_f32 v39, v190, v191
    buffer_store_dwordx4 v[36:39], v11, s[8:11], s3 offen sc1
    s_add_u32 s3, s66, 4096
    v_cvt_pk_bf16_f32 v40, v200, v201
    v_cvt_pk_bf16_f32 v41, v202, v203
    v_cvt_pk_bf16_f32 v42, v204, v205
    v_cvt_pk_bf16_f32 v43, v206, v207
    buffer_store_dwordx4 v[40:43], v11, s[8:11], s3 offen sc1
    s_add_u32 s3, s66, 4198400
    v_cvt_pk_bf16_f32 v44, v216, v217
    v_cvt_pk_bf16_f32 v45, v218, v219
    v_cvt_pk_bf16_f32 v46, v220, v221
    v_cvt_pk_bf16_f32 v47, v222, v223
    buffer_store_dwordx4 v[44:47], v11, s[8:11], s3 offen sc1
L2_end:
    s_setprio 0
    s_waitcnt vmcnt(0) lgkmcnt(0)
    s_barrier
    s_cmp_lg_u32 s25, 0
    s_cbranch_scc1 L2_ns2
    s_lshl_b32 s3, s28, 12
    s_add_u32 s3, s3, 4456448
    v_mov_b32 v10, 1
    v_lshlrev_b32 v11, 7, v1
    s_mov_b32 exec_lo, 0xff
    s_mov_b32 exec_hi, 0
    buffer_atomic_add v10, v11, s[8:11], s3 offen sc1
    s_mov_b64 exec, -1
L2_ns2:
    v_and_b32 v2, 63, v0
    s_mov_b32 s26, s25
    s_cmp_ge_u32 s26, 4
    s_cbranch_scc1 L3_loader
    s_waitcnt lgkmcnt(0)
    s_mov_b32 s8, s62
    s_and_b32 s9, s63, 0xffff
    s_mov_b32 s10, 67108864
    s_mov_b32 s11, 0x20000
    s_and_b32 s27, s6, 1
    s_bfe_u32 s28, s6, 0x20001
    s_lshr_b32 s29, s6, 3
    s_and_b32 s30, s28, 1
    s_lshl_b32 s30, s30, 3
    s_and_b32 s31, s29, 7
    s_add_u32 s30, s30, s31
    s_lshr_b32 s31, s28, 1
    s_lshl_b32 s31, s31, 2
    s_lshr_b32 s3, s29, 3
    s_add_u32 s31, s31, s3
    s_and_b32 s64, s26, 1
    s_lshr_b32 s65, s26, 1
    v_lshrrev_b32 v6, 4, v2
    v_bfe_u32 v7, v2, 2, 2
    v_and_b32 v8, 3, v2
    v_and_b32 v5, 15, v2
    s_lshl_b32 s3, s30, 7
    s_lshl_b32 s4, s64, 6
    s_add_u32 s3, s3, s4
    v_add_u32 v5, s3, v5
    s_lshl_b32 s3, s31, 7
    s_lshl_b32 s4, s65, 6
    s_add_u32 s3, s3, s4
    v_lshl_add_u32 v9, v6, 2, s3
    v_lshlrev_b32 v27, 12, v5
    v_lshl_add_u32 v27, v9, 2, v27
    v_lshlrev_b32 v26, 3, v5
    v_lshlrev_b32 v63, 1, v9
    v_lshrrev_b32 v9, 1, v6
    v_lshlrev_b32 v9, 12, v9
    s_lshl_b32 s3, s64, 11
    v_add_u32 v9, s3, v9
    v_lshrrev_b32 v3, 1, v8
    v_lshl_add_u32 v9, v3, 10, v9
    v_and_b32 v4, 1, v6
    v_lshl_or_b32 v4, v4, 2, v7
    v_lshl_or_b32 v5, v3, 3, v4
    v_lshl_add_u32 v9, v5, 4, v9
    v_and_b32 v5, 1, v8
    v_lshl_add_u32 v10, v5, 3, v9
    v_xor_b32 v11, 128, v10
    v_lshl_add_u32 v9, v6, 3, v7
    v_lshlrev_b32 v9, 8, v9
    v_lshl_add_u32 v9, v8, 3, v9
    v_add_u32 v9, 16384, v9
    s_lshl_b32 s3, s65, 2
    s_add_u32 s3, s3, 0
    v_xor_b32 v5, s3, v4
    v_lshl_add_u32 v12, v5, 5, v9
    s_lshl_b32 s3, s65, 2
    s_add_u32 s3, s3, 1
    v_xor_b32 v5, s3, v4
    v_lshl_add_u32 v13, v5, 5, v9
    s_lshl_b32 s3, s65, 2
    s_add_u32 s3, s3, 2
    v_xor_b32 v5, s3, v4
    v_lshl_add_u32 v14, v5, 5, v9
    s_lshl_b32 s3, s65, 2
    s_add_u32 s3, s3, 3
    v_xor_b32 v5, s3, v4
    v_lshl_add_u32 v15, v5, 5, v9
    v_and_b32 v5, 15, v2
    v_and_b32 v9, 7, v2
    v_xor_b32 v9, v9, v6
    v_lshlrev_b32 v9, 4, v9
    v_lshl_add_u32 v9, v5, 7, v9
    s_lshl_b32 s3, s65, 13
    s_add_u32 s3, s3, 16384
    v_add_u32 v16, s3, v9
    v_xor_b32 v17, 64, v16
    v_add_u32 v18, 0x10000, v10
    v_add_u32 v19, 0x10000, v11
    v_add_u32 v20, 0x10000, v12
    v_add_u32 v21, 0x10000, v13
    v_add_u32 v22, 0x10000, v14
    v_add_u32 v23, 0x10000, v15
    v_add_u32 v24, 0x10000, v16
    v_add_u32 v25, 0x10000, v17
    v_and_b32 v3, 15, v2
    v_lshrrev_b32 v4, 1, v6
    s_lshl_b32 s3, s65, 3
    v_or_b32 v4, s3, v4
    v_xor_b32 v4, v4, v3
    v_lshlrev_b32 v4, 4, v4
    v_lshl_add_u32 v4, v3, 8, v4
    v_and_b32 v3, 1, v6
    v_lshl_add_u32 v4, v3, 3, v4
    s_lshl_b32 s3, s64, 14
    s_add_u32 s3, s3, 131072
    v_add_u32 v4, s3, v4
    v_xor_b32 v28, 0, v4
    v_xor_b32 v29, 32, v4
    v_xor_b32 v30, 64, v4
    v_xor_b32 v31, 96, v4
    s_lshl_b32 s4, s30, 3
    s_add_u32 s4, s4, s31
    s_lshl_b32 s70, s4, 16
    s_lshl_b32 s3, s26, 14
    s_add_u32 s70, s70, s3
    s_add_u32 s70, s70, 33554432
    s_lshl_b32 s71, s4, 6
    s_lshl_b32 s3, s26, 4
    s_add_u32 s71, s71, s3
    s_add_u32 s71, s71, 4390912
    s_lshl_b32 s72, s26, 13
    s_add_u32 s72, s72, 0
    v_pk_mov_b32 v[96:97], 0, 0
    v_pk_mov_b32 v[98:99], 0, 0
    v_pk_mov_b32 v[100:101], 0, 0
    v_pk_mov_b32 v[102:103], 0, 0
    v_pk_mov_b32 v[104:105], 0, 0
    v_pk_mov_b32 v[106:107], 0, 0
    v_pk_mov_b32 v[108:109], 0, 0
    v_pk_mov_b32 v[110:111], 0, 0
    v_pk_mov_b32 v[112:113], 0, 0
    v_pk_mov_b32 v[114:115], 0, 0
    v_pk_mov_b32 v[116:117], 0, 0
    v_pk_mov_b32 v[118:119], 0, 0
    v_pk_mov_b32 v[120:121], 0, 0
    v_pk_mov_b32 v[122:123], 0, 0
    v_pk_mov_b32 v[124:125], 0, 0
    v_pk_mov_b32 v[126:127], 0, 0
    v_pk_mov_b32 v[128:129], 0, 0
    v_pk_mov_b32 v[130:131], 0, 0
    v_pk_mov_b32 v[132:133], 0, 0
    v_pk_mov_b32 v[134:135], 0, 0
    v_pk_mov_b32 v[136:137], 0, 0
    v_pk_mov_b32 v[138:139], 0, 0
    v_pk_mov_b32 v[140:141], 0, 0
    v_pk_mov_b32 v[142:143], 0, 0
    v_pk_mov_b32 v[144:145], 0, 0
    v_pk_mov_b32 v[146:147], 0, 0
    v_pk_mov_b32 v[148:149], 0, 0
    v_pk_mov_b32 v[150:151], 0, 0
    v_pk_mov_b32 v[152:153], 0, 0
    v_pk_mov_b32 v[154:155], 0, 0
    v_pk_mov_b32 v[156:157], 0, 0
    v_pk_mov_b32 v[158:159], 0, 0
    s_cmp_lg_u32 s27, 0
    s_cbranch_scc1 L3_nost
    s_mov_b32 s16, s48
    s_and_b32 s17, s49, 0xffff
    s_mov_b32 s18, 2048
    s_mov_b32 s19, 0x20000
    s_mov_b32 s3, 4194304
    buffer_load_dwordx2 v[224:225], v26, s[8:11], s3 offen offset:0 sc1
    buffer_load_dwordx2 v[226:227], v26, s[8:11], s3 offen offset:128 sc1
    buffer_load_dwordx2 v[228:229], v26, s[8:11], s3 offen offset:256 sc1
    buffer_load_dwordx2 v[230:231], v26, s[8:11], s3 offen offset:384 sc1
    buffer_load_dwordx2 v[232:233], v63, s[16:19], 0 offen offset:0
    buffer_load_dwordx2 v[234:235], v63, s[16:19], 0 offen offset:32
    buffer_load_dwordx2 v[236:237], v63, s[16:19], 0 offen offset:64
    buffer_load_dwordx2 v[238:239], v63, s[16:19], 0 offen offset:96
L3_nost:
    s_cmp_lg_u32 s27, 0
    s_cbranch_scc1 L3_typeB
    s_waitcnt vmcnt(0)
    s_barrier
    ds_read_b64 v[64:65], v28 offset:0
    ds_read_b64 v[66:67], v28 offset:4096
    ds_read_b64 v[68:69], v28 offset:8192
    ds_read_b64 v[70:71], v28 offset:12288
    ds_read_b64 v[72:73], v29 offset:0
    ds_read_b64 v[74:75], v29 offset:4096
    ds_read_b64 v[76:77], v29 offset:8192
    ds_read_b64 v[78:79], v29 offset:12288
    ds_read_b64 v[80:81], v30 offset:0
    ds_read_b64 v[82:83], v30 offset:4096
    ds_read_b64 v[84:85], v30 offset:8192
    ds_read_b64 v[86:87], v30 offset:12288
    s_waitcnt lgkmcnt(8)
    ds_read_b64 v[88:89], v31 offset:0
    ds_read_b64 v[90:91], v31 offset:4096
    ds_read_b64 v[92:93], v31 offset:8192
    ds_read_b64 v[94:95], v31 offset:12288
    v_mul_f32 v32, v224, v225
    v_mul_f32 v33, v224, v225
    v_mul_f32 v34, v226, v227
    v_mul_f32 v35, v226, v227
    v_mul_f32 v36, v228, v229
    v_mul_f32 v37, v228, v229
    v_mul_f32 v38, v230, v231
    v_mul_f32 v39, v230, v231
    v_lshlrev_b32 v240, 16, v232
    v_and_b32 v241, 0xffff0000, v232
    v_lshlrev_b32 v242, 16, v233
    v_and_b32 v243, 0xffff0000, v233
    s_waitcnt lgkmcnt(12)
    v_lshlrev_b32 v244, 16, v64
    v_and_b32 v245, 0xffff0000, v64
    v_lshlrev_b32 v246, 16, v65
    v_and_b32 v247, 0xffff0000, v65
    v_pk_fma_f32 v[244:245], v[244:245], v[224:225], v[32:33] op_sel:[0,1,0] neg_lo:[0,0,1] neg_hi:[0,0,1]
    v_pk_fma_f32 v[246:247], v[246:247], v[224:225], v[32:33] op_sel:[0,1,0] neg_lo:[0,0,1] neg_hi:[0,0,1]
    v_pk_mul_f32 v[160:161], v[244:245], v[240:241]
    v_pk_mul_f32 v[162:163], v[246:247], v[242:243]
    v_lshlrev_b32 v248, 16, v66
    v_and_b32 v249, 0xffff0000, v66
    v_lshlrev_b32 v250, 16, v67
    v_and_b32 v251, 0xffff0000, v67
    v_pk_fma_f32 v[248:249], v[248:249], v[226:227], v[34:35] op_sel:[0,1,0] neg_lo:[0,0,1] neg_hi:[0,0,1]
    v_pk_fma_f32 v[250:251], v[250:251], v[226:227], v[34:35] op_sel:[0,1,0] neg_lo:[0,0,1] neg_hi:[0,0,1]
    v_pk_mul_f32 v[164:165], v[248:249], v[240:241]
    v_pk_mul_f32 v[166:167], v[250:251], v[242:243]
    v_lshlrev_b32 v244, 16, v68
    v_and_b32 v245, 0xffff0000, v68
    v_lshlrev_b32 v246, 16, v69
    v_and_b32 v247, 0xffff0000, v69
    v_pk_fma_f32 v[244:245], v[244:245], v[228:229], v[36:37] op_sel:[0,1,0] neg_lo:[0,0,1] neg_hi:[0,0,1]
    v_pk_fma_f32 v[246:247], v[246:247], v[228:229], v[36:37] op_sel:[0,1,0] neg_lo:[0,0,1] neg_hi:[0,0,1]
    v_pk_mul_f32 v[168:169], v[244:245], v[240:241]
    v_pk_mul_f32 v[170:171], v[246:247], v[242:243]
    v_lshlrev_b32 v248, 16, v70
    v_and_b32 v249, 0xffff0000, v70
    v_lshlrev_b32 v250, 16, v71
    v_and_b32 v251, 0xffff0000, v71
    v_pk_fma_f32 v[248:249], v[248:249], v[230:231], v[38:39] op_sel:[0,1,0] neg_lo:[0,0,1] neg_hi:[0,0,1]
    v_pk_fma_f32 v[250:251], v[250:251], v[230:231], v[38:39] op_sel:[0,1,0] neg_lo:[0,0,1] neg_hi:[0,0,1]
    v_pk_mul_f32 v[172:173], v[248:249], v[240:241]
    v_pk_mul_f32 v[174:175], v[250:251], v[242:243]
    v_lshlrev_b32 v240, 16, v234
    v_and_b32 v241, 0xffff0000, v234
    v_lshlrev_b32 v242, 16, v235
    v_and_b32 v243, 0xffff0000, v235
    s_waitcnt lgkmcnt(8)
    v_lshlrev_b32 v244, 16, v72
    v_and_b32 v245, 0xffff0000, v72
    v_lshlrev_b32 v246, 16, v73
    v_and_b32 v247, 0xffff0000, v73
    v_pk_fma_f32 v[244:245], v[244:245], v[224:225], v[32:33] op_sel:[0,1,0] neg_lo:[0,0,1] neg_hi:[0,0,1]
    v_pk_fma_f32 v[246:247], v[246:247], v[224:225], v[32:33] op_sel:[0,1,0] neg_lo:[0,0,1] neg_hi:[0,0,1]
    v_pk_mul_f32 v[176:177], v[244:245], v[240:241]
    v_pk_mul_f32 v[178:179], v[246:247], v[242:243]
    v_lshlrev_b32 v248, 16, v74
    v_and_b32 v249, 0xffff0000, v74
    v_lshlrev_b32 v250, 16, v75
    v_and_b32 v251, 0xffff0000, v75
    v_pk_fma_f32 v[248:249], v[248:249], v[226:227], v[34:35] op_sel:[0,1,0] neg_lo:[0,0,1] neg_hi:[0,0,1]
    v_pk_fma_f32 v[250:251], v[250:251], v[226:227], v[34:35] op_sel:[0,1,0] neg_lo:[0,0,1] neg_hi:[0,0,1]
    v_pk_mul_f32 v[180:181], v[248:249], v[240:241]
    v_pk_mul_f32 v[182:183], v[250:251], v[242:243]
    v_lshlrev_b32 v244, 16, v76
    v_and_b32 v245, 0xffff0000, v76
    v_lshlrev_b32 v246, 16, v77
    v_and_b32 v247, 0xffff0000, v77
    v_pk_fma_f32 v[244:245], v[244:245], v[228:229], v[36:37] op_sel:[0,1,0] neg_lo:[0,0,1] neg_hi:[0,0,1]
    v_pk_fma_f32 v[246:247], v[246:247], v[228:229], v[36:37] op_sel:[0,1,0] neg_lo:[0,0,1] neg_hi:[0,0,1]
    v_pk_mul_f32 v[184:185], v[244:245], v[240:241]
    v_pk_mul_f32 v[186:187], v[246:247], v[242:243]
    v_lshlrev_b32 v248, 16, v78
    v_and_b32 v249, 0xffff0000, v78
    v_lshlrev_b32 v250, 16, v79
    v_and_b32 v251, 0xffff0000, v79
    v_pk_fma_f32 v[248:249], v[248:249], v[230:231], v[38:39] op_sel:[0,1,0] neg_lo:[0,0,1] neg_hi:[0,0,1]
    v_pk_fma_f32 v[250:251], v[250:251], v[230:231], v[38:39] op_sel:[0,1,0] neg_lo:[0,0,1] neg_hi:[0,0,1]
    v_pk_mul_f32 v[188:189], v[248:249], v[240:241]
    v_pk_mul_f32 v[190:191], v[250:251], v[242:243]
    v_lshlrev_b32 v240, 16, v236
    v_and_b32 v241, 0xffff0000, v236
    v_lshlrev_b32 v242, 16, v237
    v_and_b32 v243, 0xffff0000, v237
    s_waitcnt lgkmcnt(4)
    v_lshlrev_b32 v244, 16, v80
    v_and_b32 v245, 0xffff0000, v80
    v_lshlrev_b32 v246, 16, v81
    v_and_b32 v247, 0xffff0000, v81
    v_pk_fma_f32 v[244:245], v[244:245], v[224:225], v[32:33] op_sel:[0,1,0] neg_lo:[0,0,1] neg_hi:[0,0,1]
    v_pk_fma_f32 v[246:247], v[246:247], v[224:225], v[32:33] op_sel:[0,1,0] neg_lo:[0,0,1] neg_hi:[0,0,1]
    v_pk_mul_f32 v[192:193], v[244:245], v[240:241]
    v_pk_mul_f32 v[194:195], v[246:247], v[242:243]
    v_lshlrev_b32 v248, 16, v82
    v_and_b32 v249, 0xffff0000, v82
    v_lshlrev_b32 v250, 16, v83
    v_and_b32 v251, 0xffff0000, v83
    v_pk_fma_f32 v[248:249], v[248:249], v[226:227], v[34:35] op_sel:[0,1,0] neg_lo:[0,0,1] neg_hi:[0,0,1]
    v_pk_fma_f32 v[250:251], v[250:251], v[226:227], v[34:35] op_sel:[0,1,0] neg_lo:[0,0,1] neg_hi:[0,0,1]
    v_pk_mul_f32 v[196:197], v[248:249], v[240:241]
    v_pk_mul_f32 v[198:199], v[250:251], v[242:243]
    v_lshlrev_b32 v244, 16, v84
    v_and_b32 v245, 0xffff0000, v84
    v_lshlrev_b32 v246, 16, v85
    v_and_b32 v247, 0xffff0000, v85
    v_pk_fma_f32 v[244:245], v[244:245], v[228:229], v[36:37] op_sel:[0,1,0] neg_lo:[0,0,1] neg_hi:[0,0,1]
    v_pk_fma_f32 v[246:247], v[246:247], v[228:229], v[36:37] op_sel:[0,1,0] neg_lo:[0,0,1] neg_hi:[0,0,1]
    v_pk_mul_f32 v[200:201], v[244:245], v[240:241]
    v_pk_mul_f32 v[202:203], v[246:247], v[242:243]
    v_lshlrev_b32 v248, 16, v86
    v_and_b32 v249, 0xffff0000, v86
    v_lshlrev_b32 v250, 16, v87
    v_and_b32 v251, 0xffff0000, v87
    v_pk_fma_f32 v[248:249], v[248:249], v[230:231], v[38:39] op_sel:[0,1,0] neg_lo:[0,0,1] neg_hi:[0,0,1]
    v_pk_fma_f32 v[250:251], v[250:251], v[230:231], v[38:39] op_sel:[0,1,0] neg_lo:[0,0,1] neg_hi:[0,0,1]
    v_pk_mul_f32 v[204:205], v[248:249], v[240:241]
    v_pk_mul_f32 v[206:207], v[250:251], v[242:243]
    v_lshlrev_b32 v240, 16, v238
    v_and_b32 v241, 0xffff0000, v238
    v_lshlrev_b32 v242, 16, v239
    v_and_b32 v243, 0xffff0000, v239
    s_waitcnt lgkmcnt(0)
    v_lshlrev_b32 v244, 16, v88
    v_and_b32 v245, 0xffff0000, v88
    v_lshlrev_b32 v246, 16, v89
    v_and_b32 v247, 0xffff0000, v89
    v_pk_fma_f32 v[244:245], v[244:245], v[224:225], v[32:33] op_sel:[0,1,0] neg_lo:[0,0,1] neg_hi:[0,0,1]
    v_pk_fma_f32 v[246:247], v[246:247], v[224:225], v[32:33] op_sel:[0,1,0] neg_lo:[0,0,1] neg_hi:[0,0,1]
    v_pk_mul_f32 v[208:209], v[244:245], v[240:241]
    v_pk_mul_f32 v[210:211], v[246:247], v[242:243]
    v_lshlrev_b32 v248, 16, v90
    v_and_b32 v249, 0xffff0000, v90
    v_lshlrev_b32 v250, 16, v91
    v_and_b32 v251, 0xffff0000, v91
    v_pk_fma_f32 v[248:249], v[248:249], v[226:227], v[34:35] op_sel:[0,1,0] neg_lo:[0,0,1] neg_hi:[0,0,1]
    v_pk_fma_f32 v[250:251], v[250:251], v[226:227], v[34:35] op_sel:[0,1,0] neg_lo:[0,0,1] neg_hi:[0,0,1]
    v_pk_mul_f32 v[212:213], v[248:249], v[240:241]
    v_pk_mul_f32 v[214:215], v[250:251], v[242:243]
    v_lshlrev_b32 v244, 16, v92
    v_and_b32 v245, 0xffff0000, v92
    v_lshlrev_b32 v246, 16, v93
    v_and_b32 v247, 0xffff0000, v93
    v_pk_fma_f32 v[244:245], v[244:245], v[228:229], v[36:37] op_sel:[0,1,0] neg_lo:[0,0,1] neg_hi:[0,0,1]
    v_pk_fma_f32 v[246:247], v[246:247], v[228:229], v[36:37] op_sel:[0,1,0] neg_lo:[0,0,1] neg_hi:[0,0,1]
    v_pk_mul_f32 v[216:217], v[244:245], v[240:241]
    v_pk_mul_f32 v[218:219], v[246:247], v[242:243]
    v_lshlrev_b32 v248, 16, v94
    v_and_b32 v249, 0xffff0000, v94
    v_lshlrev_b32 v250, 16, v95
    v_and_b32 v251, 0xffff0000, v95
    v_pk_fma_f32 v[248:249], v[248:249], v[230:231], v[38:39] op_sel:[0,1,0] neg_lo:[0,0,1] neg_hi:[0,0,1]
    v_pk_fma_f32 v[250:251], v[250:251], v[230:231], v[38:39] op_sel:[0,1,0] neg_lo:[0,0,1] neg_hi:[0,0,1]
    v_pk_mul_f32 v[220:221], v[248:249], v[240:241]
    v_pk_mul_f32 v[222:223], v[250:251], v[242:243]
    s_barrier
    s_barrier
    ds_read_b128 v[64:67], v16 offset:0
    ds_read_b128 v[68:71], v17 offset:0
    ds_read_b64_tr_b16 v[32:33], v10 offset:0
    ds_read_b64_tr_b16 v[34:35], v11 offset:0
    ds_read_b64_tr_b16 v[36:37], v10 offset:8192
    ds_read_b64_tr_b16 v[38:39], v11 offset:8192
    ds_read_b64_tr_b16 v[40:41], v10 offset:256
    ds_read_b64_tr_b16 v[42:43], v11 offset:256
    ds_read_b64_tr_b16 v[44:45], v10 offset:8448
    ds_read_b64_tr_b16 v[46:47], v11 offset:8448
    ds_read_b64_tr_b16 v[48:49], v10 offset:512
    ds_read_b64_tr_b16 v[50:51], v11 offset:512
    s_waitcnt lgkmcnt(4)
    ds_read_b64_tr_b16 v[52:53], v10 offset:8704
    ds_read_b64_tr_b16 v[54:55], v11 offset:8704
    ds_read_b64_tr_b16 v[56:57], v10 offset:768
    ds_read_b64_tr_b16 v[58:59], v11 offset:768
    ds_read_b64_tr_b16 v[60:61], v10 offset:8960
    ds_read_b64_tr_b16 v[62:63], v11 offset:8960
    ds_read_b128 v[72:75], v16 offset:2048
    ds_read_b128 v[76:79], v17 offset:2048
    s_waitcnt lgkmcnt(4)
    ds_read_b128 v[80:83], v16 offset:4096
    ds_read_b128 v[84:87], v17 offset:4096
    s_mov_b32 s24, 7
.p2align 4
L3_yloop:
    s_waitcnt lgkmcnt(4)
    v_mfma_f32_16x16x32_bf16 v[160:163], v[64:67], v[32:35], v[160:163]
    ds_read_b128 v[88:91], v16 offset:6144
    v_mfma_f32_16x16x32_bf16 v[160:163], v[68:71], v[36:39], v[160:163]
    ds_read_b128 v[92:95], v17 offset:6144
    v_mfma_f32_16x16x32_bf16 v[164:167], v[68:71], v[44:47], v[164:167]
    v_mfma_f32_16x16x32_bf16 v[164:167], v[64:67], v[40:43], v[164:167]
    v_mfma_f32_16x16x32_bf16 v[168:171], v[64:67], v[48:51], v[168:171]
    v_mfma_f32_16x16x32_bf16 v[168:171], v[68:71], v[52:55], v[168:171]
    v_mfma_f32_16x16x32_bf16 v[172:175], v[68:71], v[60:63], v[172:175]
    v_mfma_f32_16x16x32_bf16 v[172:175], v[64:67], v[56:59], v[172:175]
    s_waitcnt lgkmcnt(0)
    s_barrier
    v_mfma_f32_16x16x32_bf16 v[188:191], v[72:75], v[56:59], v[188:191]
    ds_read_b128 v[64:67], v16 offset:32768
    v_mfma_f32_16x16x32_bf16 v[188:191], v[76:79], v[60:63], v[188:191]
    ds_read_b128 v[68:71], v17 offset:32768
    v_mfma_f32_16x16x32_bf16 v[184:187], v[76:79], v[52:55], v[184:187]
    ds_read_b64_tr_b16 v[224:225], v10 offset:32768
    v_mfma_f32_16x16x32_bf16 v[184:187], v[72:75], v[48:51], v[184:187]
    ds_read_b64_tr_b16 v[226:227], v11 offset:32768
    v_mfma_f32_16x16x32_bf16 v[180:183], v[72:75], v[40:43], v[180:183]
    ds_read_b64_tr_b16 v[228:229], v10 offset:40960
    v_mfma_f32_16x16x32_bf16 v[180:183], v[76:79], v[44:47], v[180:183]
    ds_read_b64_tr_b16 v[230:231], v11 offset:40960
    v_mfma_f32_16x16x32_bf16 v[176:179], v[76:79], v[36:39], v[176:179]
    ds_read_b64_tr_b16 v[232:233], v10 offset:33024
    v_mfma_f32_16x16x32_bf16 v[176:179], v[72:75], v[32:35], v[176:179]
    ds_read_b64_tr_b16 v[234:235], v11 offset:33024
    v_mfma_f32_16x16x32_bf16 v[192:195], v[80:83], v[32:35], v[192:195]
    ds_read_b64_tr_b16 v[236:237], v10 offset:41216
    v_mfma_f32_16x16x32_bf16 v[192:195], v[84:87], v[36:39], v[192:195]
    ds_read_b64_tr_b16 v[238:239], v11 offset:41216
    v_mfma_f32_16x16x32_bf16 v[196:199], v[84:87], v[44:47], v[196:199]
    ds_read_b64_tr_b16 v[240:241], v10 offset:33280
    v_mfma_f32_16x16x32_bf16 v[196:199], v[80:83], v[40:43], v[196:199]
    ds_read_b64_tr_b16 v[242:243], v11 offset:33280
    v_mfma_f32_16x16x32_bf16 v[200:203], v[80:83], v[48:51], v[200:203]
    ds_read_b64_tr_b16 v[244:245], v10 offset:41472
    v_mfma_f32_16x16x32_bf16 v[200:203], v[84:87], v[52:55], v[200:203]
    ds_read_b64_tr_b16 v[246:247], v11 offset:41472
    v_mfma_f32_16x16x32_bf16 v[204:207], v[84:87], v[60:63], v[204:207]
    ds_read_b64_tr_b16 v[248:249], v10 offset:33536
    v_mfma_f32_16x16x32_bf16 v[204:207], v[80:83], v[56:59], v[204:207]
    ds_read_b64_tr_b16 v[250:251], v11 offset:33536
    v_mfma_f32_16x16x32_bf16 v[220:223], v[88:91], v[56:59], v[220:223]
    ds_read_b64_tr_b16 v[252:253], v10 offset:41728
    v_mfma_f32_16x16x32_bf16 v[220:223], v[92:95], v[60:63], v[220:223]
    ds_read_b64_tr_b16 v[254:255], v11 offset:41728
    v_mfma_f32_16x16x32_bf16 v[216:219], v[92:95], v[52:55], v[216:219]
    ds_read_b128 v[72:75], v16 offset:34816
    v_mfma_f32_16x16x32_bf16 v[216:219], v[88:91], v[48:51], v[216:219]
    ds_read_b128 v[76:79], v17 offset:34816
    v_mfma_f32_16x16x32_bf16 v[212:215], v[88:91], v[40:43], v[212:215]
    ds_read_b128 v[80:83], v16 offset:36864
    v_mfma_f32_16x16x32_bf16 v[212:215], v[92:95], v[44:47], v[212:215]
    ds_read_b128 v[84:87], v17 offset:36864
    v_mfma_f32_16x16x32_bf16 v[208:211], v[92:95], v[36:39], v[208:211]
    v_mfma_f32_16x16x32_bf16 v[208:211], v[88:91], v[32:35], v[208:211]
    s_waitcnt lgkmcnt(4)
    v_mfma_f32_16x16x32_bf16 v[160:163], v[64:67], v[224:227], v[160:163]
    ds_read_b128 v[88:91], v16 offset:38912
    v_mfma_f32_16x16x32_bf16 v[160:163], v[68:71], v[228:231], v[160:163]
    ds_read_b128 v[92:95], v17 offset:38912
    v_mfma_f32_16x16x32_bf16 v[164:167], v[68:71], v[236:239], v[164:167]
    v_mfma_f32_16x16x32_bf16 v[164:167], v[64:67], v[232:235], v[164:167]
    v_mfma_f32_16x16x32_bf16 v[168:171], v[64:67], v[240:243], v[168:171]
    v_mfma_f32_16x16x32_bf16 v[168:171], v[68:71], v[244:247], v[168:171]
    v_mfma_f32_16x16x32_bf16 v[172:175], v[68:71], v[252:255], v[172:175]
    v_mfma_f32_16x16x32_bf16 v[172:175], v[64:67], v[248:251], v[172:175]
    s_waitcnt lgkmcnt(0)
    s_barrier
    v_mfma_f32_16x16x32_bf16 v[188:191], v[72:75], v[248:251], v[188:191]
    ds_read_b128 v[64:67], v24 offset:0
    v_mfma_f32_16x16x32_bf16 v[188:191], v[76:79], v[252:255], v[188:191]
    ds_read_b128 v[68:71], v25 offset:0
    v_mfma_f32_16x16x32_bf16 v[184:187], v[76:79], v[244:247], v[184:187]
    ds_read_b64_tr_b16 v[32:33], v18 offset:0
    v_mfma_f32_16x16x32_bf16 v[184:187], v[72:75], v[240:243], v[184:187]
    ds_read_b64_tr_b16 v[34:35], v19 offset:0
    v_mfma_f32_16x16x32_bf16 v[180:183], v[72:75], v[232:235], v[180:183]
    ds_read_b64_tr_b16 v[36:37], v18 offset:8192
    v_mfma_f32_16x16x32_bf16 v[180:183], v[76:79], v[236:239], v[180:183]
    ds_read_b64_tr_b16 v[38:39], v19 offset:8192
    v_mfma_f32_16x16x32_bf16 v[176:179], v[76:79], v[228:231], v[176:179]
    ds_read_b64_tr_b16 v[40:41], v18 offset:256
    v_mfma_f32_16x16x32_bf16 v[176:179], v[72:75], v[224:227], v[176:179]
    ds_read_b64_tr_b16 v[42:43], v19 offset:256
    v_mfma_f32_16x16x32_bf16 v[192:195], v[80:83], v[224:227], v[192:195]
    ds_read_b64_tr_b16 v[44:45], v18 offset:8448
    v_mfma_f32_16x16x32_bf16 v[192:195], v[84:87], v[228:231], v[192:195]
    ds_read_b64_tr_b16 v[46:47], v19 offset:8448
    v_mfma_f32_16x16x32_bf16 v[196:199], v[84:87], v[236:239], v[196:199]
    ds_read_b64_tr_b16 v[48:49], v18 offset:512
    v_mfma_f32_16x16x32_bf16 v[196:199], v[80:83], v[232:235], v[196:199]
    ds_read_b64_tr_b16 v[50:51], v19 offset:512
    v_mfma_f32_16x16x32_bf16 v[200:203], v[80:83], v[240:243], v[200:203]
    ds_read_b64_tr_b16 v[52:53], v18 offset:8704
    v_mfma_f32_16x16x32_bf16 v[200:203], v[84:87], v[244:247], v[200:203]
    ds_read_b64_tr_b16 v[54:55], v19 offset:8704
    v_mfma_f32_16x16x32_bf16 v[204:207], v[84:87], v[252:255], v[204:207]
    ds_read_b64_tr_b16 v[56:57], v18 offset:768
    v_mfma_f32_16x16x32_bf16 v[204:207], v[80:83], v[248:251], v[204:207]
    ds_read_b64_tr_b16 v[58:59], v19 offset:768
    v_mfma_f32_16x16x32_bf16 v[220:223], v[88:91], v[248:251], v[220:223]
    ds_read_b64_tr_b16 v[60:61], v18 offset:8960
    v_mfma_f32_16x16x32_bf16 v[220:223], v[92:95], v[252:255], v[220:223]
    ds_read_b64_tr_b16 v[62:63], v19 offset:8960
    v_mfma_f32_16x16x32_bf16 v[216:219], v[92:95], v[244:247], v[216:219]
    ds_read_b128 v[72:75], v24 offset:2048
    v_mfma_f32_16x16x32_bf16 v[216:219], v[88:91], v[240:243], v[216:219]
    ds_read_b128 v[76:79], v25 offset:2048
    v_mfma_f32_16x16x32_bf16 v[212:215], v[88:91], v[232:235], v[212:215]
    ds_read_b128 v[80:83], v24 offset:4096
    v_mfma_f32_16x16x32_bf16 v[212:215], v[92:95], v[236:239], v[212:215]
    ds_read_b128 v[84:87], v25 offset:4096
    v_mfma_f32_16x16x32_bf16 v[208:211], v[92:95], v[228:231], v[208:211]
    v_mfma_f32_16x16x32_bf16 v[208:211], v[88:91], v[224:227], v[208:211]
    s_waitcnt lgkmcnt(4)
    v_mfma_f32_16x16x32_bf16 v[160:163], v[64:67], v[32:35], v[160:163]
    ds_read_b128 v[88:91], v24 offset:6144
    v_mfma_f32_16x16x32_bf16 v[160:163], v[68:71], v[36:39], v[160:163]
    ds_read_b128 v[92:95], v25 offset:6144
    v_mfma_f32_16x16x32_bf16 v[164:167], v[68:71], v[44:47], v[164:167]
    v_mfma_f32_16x16x32_bf16 v[164:167], v[64:67], v[40:43], v[164:167]
    v_mfma_f32_16x16x32_bf16 v[168:171], v[64:67], v[48:51], v[168:171]
    v_mfma_f32_16x16x32_bf16 v[168:171], v[68:71], v[52:55], v[168:171]
    v_mfma_f32_16x16x32_bf16 v[172:175], v[68:71], v[60:63], v[172:175]
    v_mfma_f32_16x16x32_bf16 v[172:175], v[64:67], v[56:59], v[172:175]
    s_waitcnt lgkmcnt(0)
    s_barrier
    v_mfma_f32_16x16x32_bf16 v[188:191], v[72:75], v[56:59], v[188:191]
    ds_read_b128 v[64:67], v24 offset:32768
    v_mfma_f32_16x16x32_bf16 v[188:191], v[76:79], v[60:63], v[188:191]
    ds_read_b128 v[68:71], v25 offset:32768
    v_mfma_f32_16x16x32_bf16 v[184:187], v[76:79], v[52:55], v[184:187]
    ds_read_b64_tr_b16 v[224:225], v18 offset:32768
    v_mfma_f32_16x16x32_bf16 v[184:187], v[72:75], v[48:51], v[184:187]
    ds_read_b64_tr_b16 v[226:227], v19 offset:32768
    v_mfma_f32_16x16x32_bf16 v[180:183], v[72:75], v[40:43], v[180:183]
    ds_read_b64_tr_b16 v[228:229], v18 offset:40960
    v_mfma_f32_16x16x32_bf16 v[180:183], v[76:79], v[44:47], v[180:183]
    ds_read_b64_tr_b16 v[230:231], v19 offset:40960
    v_mfma_f32_16x16x32_bf16 v[176:179], v[76:79], v[36:39], v[176:179]
    ds_read_b64_tr_b16 v[232:233], v18 offset:33024
    v_mfma_f32_16x16x32_bf16 v[176:179], v[72:75], v[32:35], v[176:179]
    ds_read_b64_tr_b16 v[234:235], v19 offset:33024
    v_mfma_f32_16x16x32_bf16 v[192:195], v[80:83], v[32:35], v[192:195]
    ds_read_b64_tr_b16 v[236:237], v18 offset:41216
    v_mfma_f32_16x16x32_bf16 v[192:195], v[84:87], v[36:39], v[192:195]
    ds_read_b64_tr_b16 v[238:239], v19 offset:41216
    v_mfma_f32_16x16x32_bf16 v[196:199], v[84:87], v[44:47], v[196:199]
    ds_read_b64_tr_b16 v[240:241], v18 offset:33280
    v_mfma_f32_16x16x32_bf16 v[196:199], v[80:83], v[40:43], v[196:199]
    ds_read_b64_tr_b16 v[242:243], v19 offset:33280
    v_mfma_f32_16x16x32_bf16 v[200:203], v[80:83], v[48:51], v[200:203]
    ds_read_b64_tr_b16 v[244:245], v18 offset:41472
    v_mfma_f32_16x16x32_bf16 v[200:203], v[84:87], v[52:55], v[200:203]
    ds_read_b64_tr_b16 v[246:247], v19 offset:41472
    v_mfma_f32_16x16x32_bf16 v[204:207], v[84:87], v[60:63], v[204:207]
    ds_read_b64_tr_b16 v[248:249], v18 offset:33536
    v_mfma_f32_16x16x32_bf16 v[204:207], v[80:83], v[56:59], v[204:207]
    ds_read_b64_tr_b16 v[250:251], v19 offset:33536
    v_mfma_f32_16x16x32_bf16 v[220:223], v[88:91], v[56:59], v[220:223]
    ds_read_b64_tr_b16 v[252:253], v18 offset:41728
    v_mfma_f32_16x16x32_bf16 v[220:223], v[92:95], v[60:63], v[220:223]
    ds_read_b64_tr_b16 v[254:255], v19 offset:41728
    v_mfma_f32_16x16x32_bf16 v[216:219], v[92:95], v[52:55], v[216:219]
    ds_read_b128 v[72:75], v24 offset:34816
    v_mfma_f32_16x16x32_bf16 v[216:219], v[88:91], v[48:51], v[216:219]
    ds_read_b128 v[76:79], v25 offset:34816
    v_mfma_f32_16x16x32_bf16 v[212:215], v[88:91], v[40:43], v[212:215]
    ds_read_b128 v[80:83], v24 offset:36864
    v_mfma_f32_16x16x32_bf16 v[212:215], v[92:95], v[44:47], v[212:215]
    ds_read_b128 v[84:87], v25 offset:36864
    v_mfma_f32_16x16x32_bf16 v[208:211], v[92:95], v[36:39], v[208:211]
    v_mfma_f32_16x16x32_bf16 v[208:211], v[88:91], v[32:35], v[208:211]
    s_waitcnt lgkmcnt(4)
    v_mfma_f32_16x16x32_bf16 v[160:163], v[64:67], v[224:227], v[160:163]
    ds_read_b128 v[88:91], v24 offset:38912
    v_mfma_f32_16x16x32_bf16 v[160:163], v[68:71], v[228:231], v[160:163]
    ds_read_b128 v[92:95], v25 offset:38912
    v_mfma_f32_16x16x32_bf16 v[164:167], v[68:71], v[236:239], v[164:167]
    v_mfma_f32_16x16x32_bf16 v[164:167], v[64:67], v[232:235], v[164:167]
    v_mfma_f32_16x16x32_bf16 v[168:171], v[64:67], v[240:243], v[168:171]
    v_mfma_f32_16x16x32_bf16 v[168:171], v[68:71], v[244:247], v[168:171]
    v_mfma_f32_16x16x32_bf16 v[172:175], v[68:71], v[252:255], v[172:175]
    v_mfma_f32_16x16x32_bf16 v[172:175], v[64:67], v[248:251], v[172:175]
    s_waitcnt lgkmcnt(0)
    s_barrier
    v_mfma_f32_16x16x32_bf16 v[188:191], v[72:75], v[248:251], v[188:191]
    ds_read_b128 v[64:67], v16 offset:0
    v_mfma_f32_16x16x32_bf16 v[188:191], v[76:79], v[252:255], v[188:191]
    ds_read_b128 v[68:71], v17 offset:0
    v_mfma_f32_16x16x32_bf16 v[184:187], v[76:79], v[244:247], v[184:187]
    ds_read_b64_tr_b16 v[32:33], v10 offset:0
    v_mfma_f32_16x16x32_bf16 v[184:187], v[72:75], v[240:243], v[184:187]
    ds_read_b64_tr_b16 v[34:35], v11 offset:0
    v_mfma_f32_16x16x32_bf16 v[180:183], v[72:75], v[232:235], v[180:183]
    ds_read_b64_tr_b16 v[36:37], v10 offset:8192
    v_mfma_f32_16x16x32_bf16 v[180:183], v[76:79], v[236:239], v[180:183]
    ds_read_b64_tr_b16 v[38:39], v11 offset:8192
    v_mfma_f32_16x16x32_bf16 v[176:179], v[76:79], v[228:231], v[176:179]
    ds_read_b64_tr_b16 v[40:41], v10 offset:256
    v_mfma_f32_16x16x32_bf16 v[176:179], v[72:75], v[224:227], v[176:179]
    ds_read_b64_tr_b16 v[42:43], v11 offset:256
    v_mfma_f32_16x16x32_bf16 v[192:195], v[80:83], v[224:227], v[192:195]
    ds_read_b64_tr_b16 v[44:45], v10 offset:8448
    v_mfma_f32_16x16x32_bf16 v[192:195], v[84:87], v[228:231], v[192:195]
    ds_read_b64_tr_b16 v[46:47], v11 offset:8448
    v_mfma_f32_16x16x32_bf16 v[196:199], v[84:87], v[236:239], v[196:199]
    ds_read_b64_tr_b16 v[48:49], v10 offset:512
    v_mfma_f32_16x16x32_bf16 v[196:199], v[80:83], v[232:235], v[196:199]
    ds_read_b64_tr_b16 v[50:51], v11 offset:512
    v_mfma_f32_16x16x32_bf16 v[200:203], v[80:83], v[240:243], v[200:203]
    ds_read_b64_tr_b16 v[52:53], v10 offset:8704
    v_mfma_f32_16x16x32_bf16 v[200:203], v[84:87], v[244:247], v[200:203]
    ds_read_b64_tr_b16 v[54:55], v11 offset:8704
    v_mfma_f32_16x16x32_bf16 v[204:207], v[84:87], v[252:255], v[204:207]
    ds_read_b64_tr_b16 v[56:57], v10 offset:768
    v_mfma_f32_16x16x32_bf16 v[204:207], v[80:83], v[248:251], v[204:207]
    ds_read_b64_tr_b16 v[58:59], v11 offset:768
    v_mfma_f32_16x16x32_bf16 v[220:223], v[88:91], v[248:251], v[220:223]
    ds_read_b64_tr_b16 v[60:61], v10 offset:8960
    v_mfma_f32_16x16x32_bf16 v[220:223], v[92:95], v[252:255], v[220:223]
    ds_read_b64_tr_b16 v[62:63], v11 offset:8960
    v_mfma_f32_16x16x32_bf16 v[216:219], v[92:95], v[244:247], v[216:219]
    ds_read_b128 v[72:75], v16 offset:2048
    v_mfma_f32_16x16x32_bf16 v[216:219], v[88:91], v[240:243], v[216:219]
    ds_read_b128 v[76:79], v17 offset:2048
    v_mfma_f32_16x16x32_bf16 v[212:215], v[88:91], v[232:235], v[212:215]
    ds_read_b128 v[80:83], v16 offset:4096
    v_mfma_f32_16x16x32_bf16 v[212:215], v[92:95], v[236:239], v[212:215]
    ds_read_b128 v[84:87], v17 offset:4096
    v_mfma_f32_16x16x32_bf16 v[208:211], v[92:95], v[228:231], v[208:211]
    v_mfma_f32_16x16x32_bf16 v[208:211], v[88:91], v[224:227], v[208:211]
    s_sub_u32 s24, s24, 1
    s_cmp_lg_u32 s24, 0
    s_cbranch_scc1 L3_yloop
    s_waitcnt lgkmcnt(4)
    v_mfma_f32_16x16x32_bf16 v[160:163], v[64:67], v[32:35], v[160:163]
    ds_read_b128 v[88:91], v16 offset:6144
    v_mfma_f32_16x16x32_bf16 v[160:163], v[68:71], v[36:39], v[160:163]
    ds_read_b128 v[92:95], v17 offset:6144
    v_mfma_f32_16x16x32_bf16 v[164:167], v[68:71], v[44:47], v[164:167]
    v_mfma_f32_16x16x32_bf16 v[164:167], v[64:67], v[40:43], v[164:167]
    v_mfma_f32_16x16x32_bf16 v[168:171], v[64:67], v[48:51], v[168:171]
    v_mfma_f32_16x16x32_bf16 v[168:171], v[68:71], v[52:55], v[168:171]
    v_mfma_f32_16x16x32_bf16 v[172:175], v[68:71], v[60:63], v[172:175]
    v_mfma_f32_16x16x32_bf16 v[172:175], v[64:67], v[56:59], v[172:175]
    s_waitcnt lgkmcnt(0)
    s_barrier
    v_mfma_f32_16x16x32_bf16 v[188:191], v[72:75], v[56:59], v[188:191]
    ds_read_b128 v[64:67], v16 offset:32768
    v_mfma_f32_16x16x32_bf16 v[188:191], v[76:79], v[60:63], v[188:191]
    ds_read_b128 v[68:71], v17 offset:32768
    v_mfma_f32_16x16x32_bf16 v[184:187], v[76:79], v[52:55], v[184:187]
    ds_read_b64_tr_b16 v[224:225], v10 offset:32768
    v_mfma_f32_16x16x32_bf16 v[184:187], v[72:75], v[48:51], v[184:187]
    ds_read_b64_tr_b16 v[226:227], v11 offset:32768
    v_mfma_f32_16x16x32_bf16 v[180:183], v[72:75], v[40:43], v[180:183]
    ds_read_b64_tr_b16 v[228:229], v10 offset:40960
    v_mfma_f32_16x16x32_bf16 v[180:183], v[76:79], v[44:47], v[180:183]
    ds_read_b64_tr_b16 v[230:231], v11 offset:40960
    v_mfma_f32_16x16x32_bf16 v[176:179], v[76:79], v[36:39], v[176:179]
    ds_read_b64_tr_b16 v[232:233], v10 offset:33024
    v_mfma_f32_16x16x32_bf16 v[176:179], v[72:75], v[32:35], v[176:179]
    ds_read_b64_tr_b16 v[234:235], v11 offset:33024
    v_mfma_f32_16x16x32_bf16 v[192:195], v[80:83], v[32:35], v[192:195]
    ds_read_b64_tr_b16 v[236:237], v10 offset:41216
    v_mfma_f32_16x16x32_bf16 v[192:195], v[84:87], v[36:39], v[192:195]
    ds_read_b64_tr_b16 v[238:239], v11 offset:41216
    v_mfma_f32_16x16x32_bf16 v[196:199], v[84:87], v[44:47], v[196:199]
    ds_read_b64_tr_b16 v[240:241], v10 offset:33280
    v_mfma_f32_16x16x32_bf16 v[196:199], v[80:83], v[40:43], v[196:199]
    ds_read_b64_tr_b16 v[242:243], v11 offset:33280
    v_mfma_f32_16x16x32_bf16 v[200:203], v[80:83], v[48:51], v[200:203]
    ds_read_b64_tr_b16 v[244:245], v10 offset:41472
    v_mfma_f32_16x16x32_bf16 v[200:203], v[84:87], v[52:55], v[200:203]
    ds_read_b64_tr_b16 v[246:247], v11 offset:41472
    v_mfma_f32_16x16x32_bf16 v[204:207], v[84:87], v[60:63], v[204:207]
    ds_read_b64_tr_b16 v[248:249], v10 offset:33536
    v_mfma_f32_16x16x32_bf16 v[204:207], v[80:83], v[56:59], v[204:207]
    ds_read_b64_tr_b16 v[250:251], v11 offset:33536
    v_mfma_f32_16x16x32_bf16 v[220:223], v[88:91], v[56:59], v[220:223]
    ds_read_b64_tr_b16 v[252:253], v10 offset:41728
    v_mfma_f32_16x16x32_bf16 v[220:223], v[92:95], v[60:63], v[220:223]
    ds_read_b64_tr_b16 v[254:255], v11 offset:41728
    v_mfma_f32_16x16x32_bf16 v[216:219], v[92:95], v[52:55], v[216:219]
    ds_read_b128 v[72:75], v16 offset:34816
    v_mfma_f32_16x16x32_bf16 v[216:219], v[88:91], v[48:51], v[216:219]
    ds_read_b128 v[76:79], v17 offset:34816
    v_mfma_f32_16x16x32_bf16 v[212:215], v[88:91], v[40:43], v[212:215]
    ds_read_b128 v[80:83], v16 offset:36864
    v_mfma_f32_16x16x32_bf16 v[212:215], v[92:95], v[44:47], v[212:215]
    ds_read_b128 v[84:87], v17 offset:36864
    v_mfma_f32_16x16x32_bf16 v[208:211], v[92:95], v[36:39], v[208:211]
    v_mfma_f32_16x16x32_bf16 v[208:211], v[88:91], v[32:35], v[208:211]
    s_waitcnt lgkmcnt(4)
    v_mfma_f32_16x16x32_bf16 v[160:163], v[64:67], v[224:227], v[160:163]
    ds_read_b128 v[88:91], v16 offset:38912
    v_mfma_f32_16x16x32_bf16 v[160:163], v[68:71], v[228:231], v[160:163]
    ds_read_b128 v[92:95], v17 offset:38912
    v_mfma_f32_16x16x32_bf16 v[164:167], v[68:71], v[236:239], v[164:167]
    v_mfma_f32_16x16x32_bf16 v[164:167], v[64:67], v[232:235], v[164:167]
    v_mfma_f32_16x16x32_bf16 v[168:171], v[64:67], v[240:243], v[168:171]
    v_mfma_f32_16x16x32_bf16 v[168:171], v[68:71], v[244:247], v[168:171]
    v_mfma_f32_16x16x32_bf16 v[172:175], v[68:71], v[252:255], v[172:175]
    v_mfma_f32_16x16x32_bf16 v[172:175], v[64:67], v[248:251], v[172:175]
    s_waitcnt lgkmcnt(0)
    s_barrier
    v_mfma_f32_16x16x32_bf16 v[188:191], v[72:75], v[248:251], v[188:191]
    ds_read_b128 v[64:67], v24 offset:0
    v_mfma_f32_16x16x32_bf16 v[188:191], v[76:79], v[252:255], v[188:191]
    ds_read_b128 v[68:71], v25 offset:0
    v_mfma_f32_16x16x32_bf16 v[184:187], v[76:79], v[244:247], v[184:187]
    ds_read_b64_tr_b16 v[32:33], v18 offset:0
    v_mfma_f32_16x16x32_bf16 v[184:187], v[72:75], v[240:243], v[184:187]
    ds_read_b64_tr_b16 v[34:35], v19 offset:0
    v_mfma_f32_16x16x32_bf16 v[180:183], v[72:75], v[232:235], v[180:183]
    ds_read_b64_tr_b16 v[36:37], v18 offset:8192
    v_mfma_f32_16x16x32_bf16 v[180:183], v[76:79], v[236:239], v[180:183]
    ds_read_b64_tr_b16 v[38:39], v19 offset:8192
    v_mfma_f32_16x16x32_bf16 v[176:179], v[76:79], v[228:231], v[176:179]
    ds_read_b64_tr_b16 v[40:41], v18 offset:256
    v_mfma_f32_16x16x32_bf16 v[176:179], v[72:75], v[224:227], v[176:179]
    ds_read_b64_tr_b16 v[42:43], v19 offset:256
    v_mfma_f32_16x16x32_bf16 v[192:195], v[80:83], v[224:227], v[192:195]
    ds_read_b64_tr_b16 v[44:45], v18 offset:8448
    v_mfma_f32_16x16x32_bf16 v[192:195], v[84:87], v[228:231], v[192:195]
    ds_read_b64_tr_b16 v[46:47], v19 offset:8448
    v_mfma_f32_16x16x32_bf16 v[196:199], v[84:87], v[236:239], v[196:199]
    ds_read_b64_tr_b16 v[48:49], v18 offset:512
    v_mfma_f32_16x16x32_bf16 v[196:199], v[80:83], v[232:235], v[196:199]
    ds_read_b64_tr_b16 v[50:51], v19 offset:512
    v_mfma_f32_16x16x32_bf16 v[200:203], v[80:83], v[240:243], v[200:203]
    ds_read_b64_tr_b16 v[52:53], v18 offset:8704
    v_mfma_f32_16x16x32_bf16 v[200:203], v[84:87], v[244:247], v[200:203]
    ds_read_b64_tr_b16 v[54:55], v19 offset:8704
    v_mfma_f32_16x16x32_bf16 v[204:207], v[84:87], v[252:255], v[204:207]
    ds_read_b64_tr_b16 v[56:57], v18 offset:768
    v_mfma_f32_16x16x32_bf16 v[204:207], v[80:83], v[248:251], v[204:207]
    ds_read_b64_tr_b16 v[58:59], v19 offset:768
    v_mfma_f32_16x16x32_bf16 v[220:223], v[88:91], v[248:251], v[220:223]
    ds_read_b64_tr_b16 v[60:61], v18 offset:8960
    v_mfma_f32_16x16x32_bf16 v[220:223], v[92:95], v[252:255], v[220:223]
    ds_read_b64_tr_b16 v[62:63], v19 offset:8960
    v_mfma_f32_16x16x32_bf16 v[216:219], v[92:95], v[244:247], v[216:219]
    ds_read_b128 v[72:75], v24 offset:2048
    v_mfma_f32_16x16x32_bf16 v[216:219], v[88:91], v[240:243], v[216:219]
    ds_read_b128 v[76:79], v25 offset:2048
    v_mfma_f32_16x16x32_bf16 v[212:215], v[88:91], v[232:235], v[212:215]
    ds_read_b128 v[80:83], v24 offset:4096
    v_mfma_f32_16x16x32_bf16 v[212:215], v[92:95], v[236:239], v[212:215]
    ds_read_b128 v[84:87], v25 offset:4096
    v_mfma_f32_16x16x32_bf16 v[208:211], v[92:95], v[228:231], v[208:211]
    v_mfma_f32_16x16x32_bf16 v[208:211], v[88:91], v[224:227], v[208:211]
    s_waitcnt lgkmcnt(4)
    v_mfma_f32_16x16x32_bf16 v[160:163], v[64:67], v[32:35], v[160:163]
    ds_read_b128 v[88:91], v24 offset:6144
    v_mfma_f32_16x16x32_bf16 v[160:163], v[68:71], v[36:39], v[160:163]
    ds_read_b128 v[92:95], v25 offset:6144
    v_mfma_f32_16x16x32_bf16 v[164:167], v[68:71], v[44:47], v[164:167]
    v_mfma_f32_16x16x32_bf16 v[164:167], v[64:67], v[40:43], v[164:167]
    v_mfma_f32_16x16x32_bf16 v[168:171], v[64:67], v[48:51], v[168:171]
    v_mfma_f32_16x16x32_bf16 v[168:171], v[68:71], v[52:55], v[168:171]
    v_mfma_f32_16x16x32_bf16 v[172:175], v[68:71], v[60:63], v[172:175]
    v_mfma_f32_16x16x32_bf16 v[172:175], v[64:67], v[56:59], v[172:175]
    s_waitcnt lgkmcnt(0)
    s_barrier
    v_mfma_f32_16x16x32_bf16 v[188:191], v[72:75], v[56:59], v[188:191]
    ds_read_b128 v[64:67], v24 offset:32768
    v_mfma_f32_16x16x32_bf16 v[188:191], v[76:79], v[60:63], v[188:191]
    ds_read_b128 v[68:71], v25 offset:32768
    v_mfma_f32_16x16x32_bf16 v[184:187], v[76:79], v[52:55], v[184:187]
    ds_read_b64_tr_b16 v[224:225], v18 offset:32768
    v_mfma_f32_16x16x32_bf16 v[184:187], v[72:75], v[48:51], v[184:187]
    ds_read_b64_tr_b16 v[226:227], v19 offset:32768
    v_mfma_f32_16x16x32_bf16 v[180:183], v[72:75], v[40:43], v[180:183]
    ds_read_b64_tr_b16 v[228:229], v18 offset:40960
    v_mfma_f32_16x16x32_bf16 v[180:183], v[76:79], v[44:47], v[180:183]
    ds_read_b64_tr_b16 v[230:231], v19 offset:40960
    v_mfma_f32_16x16x32_bf16 v[176:179], v[76:79], v[36:39], v[176:179]
    ds_read_b64_tr_b16 v[232:233], v18 offset:33024
    v_mfma_f32_16x16x32_bf16 v[176:179], v[72:75], v[32:35], v[176:179]
    ds_read_b64_tr_b16 v[234:235], v19 offset:33024
    v_mfma_f32_16x16x32_bf16 v[192:195], v[80:83], v[32:35], v[192:195]
    ds_read_b64_tr_b16 v[236:237], v18 offset:41216
    v_mfma_f32_16x16x32_bf16 v[192:195], v[84:87], v[36:39], v[192:195]
    ds_read_b64_tr_b16 v[238:239], v19 offset:41216
    v_mfma_f32_16x16x32_bf16 v[196:199], v[84:87], v[44:47], v[196:199]
    ds_read_b64_tr_b16 v[240:241], v18 offset:33280
    v_mfma_f32_16x16x32_bf16 v[196:199], v[80:83], v[40:43], v[196:199]
    ds_read_b64_tr_b16 v[242:243], v19 offset:33280
    v_mfma_f32_16x16x32_bf16 v[200:203], v[80:83], v[48:51], v[200:203]
    ds_read_b64_tr_b16 v[244:245], v18 offset:41472
    v_mfma_f32_16x16x32_bf16 v[200:203], v[84:87], v[52:55], v[200:203]
    ds_read_b64_tr_b16 v[246:247], v19 offset:41472
    v_mfma_f32_16x16x32_bf16 v[204:207], v[84:87], v[60:63], v[204:207]
    ds_read_b64_tr_b16 v[248:249], v18 offset:33536
    v_mfma_f32_16x16x32_bf16 v[204:207], v[80:83], v[56:59], v[204:207]
    ds_read_b64_tr_b16 v[250:251], v19 offset:33536
    v_mfma_f32_16x16x32_bf16 v[220:223], v[88:91], v[56:59], v[220:223]
    ds_read_b64_tr_b16 v[252:253], v18 offset:41728
    v_mfma_f32_16x16x32_bf16 v[220:223], v[92:95], v[60:63], v[220:223]
    ds_read_b64_tr_b16 v[254:255], v19 offset:41728
    v_mfma_f32_16x16x32_bf16 v[216:219], v[92:95], v[52:55], v[216:219]
    ds_read_b128 v[72:75], v24 offset:34816
    v_mfma_f32_16x16x32_bf16 v[216:219], v[88:91], v[48:51], v[216:219]
    ds_read_b128 v[76:79], v25 offset:34816
    v_mfma_f32_16x16x32_bf16 v[212:215], v[88:91], v[40:43], v[212:215]
    ds_read_b128 v[80:83], v24 offset:36864
    v_mfma_f32_16x16x32_bf16 v[212:215], v[92:95], v[44:47], v[212:215]
    ds_read_b128 v[84:87], v25 offset:36864
    v_mfma_f32_16x16x32_bf16 v[208:211], v[92:95], v[36:39], v[208:211]
    v_mfma_f32_16x16x32_bf16 v[208:211], v[88:91], v[32:35], v[208:211]
    s_waitcnt lgkmcnt(4)
    v_mfma_f32_16x16x32_bf16 v[160:163], v[64:67], v[224:227], v[160:163]
    ds_read_b128 v[88:91], v24 offset:38912
    v_mfma_f32_16x16x32_bf16 v[160:163], v[68:71], v[228:231], v[160:163]
    ds_read_b128 v[92:95], v25 offset:38912
    v_mfma_f32_16x16x32_bf16 v[164:167], v[68:71], v[236:239], v[164:167]
    v_mfma_f32_16x16x32_bf16 v[164:167], v[64:67], v[232:235], v[164:167]
    v_mfma_f32_16x16x32_bf16 v[168:171], v[64:67], v[240:243], v[168:171]
    v_mfma_f32_16x16x32_bf16 v[168:171], v[68:71], v[244:247], v[168:171]
    v_mfma_f32_16x16x32_bf16 v[172:175], v[68:71], v[252:255], v[172:175]
    v_mfma_f32_16x16x32_bf16 v[172:175], v[64:67], v[248:251], v[172:175]
    s_waitcnt lgkmcnt(0)
    s_barrier
    v_mfma_f32_16x16x32_bf16 v[188:191], v[72:75], v[248:251], v[188:191]
    ds_read_b64_tr_b16 v[64:65], v12 offset:0
    ds_read_b64_tr_b16 v[66:67], v12 offset:1024
    v_mfma_f32_16x16x32_bf16 v[188:191], v[76:79], v[252:255], v[188:191]
    ds_read_b64_tr_b16 v[68:69], v12 offset:8192
    ds_read_b64_tr_b16 v[70:71], v12 offset:9216
    v_mfma_f32_16x16x32_bf16 v[184:187], v[76:79], v[244:247], v[184:187]
    ds_read_b64_tr_b16 v[32:33], v10 offset:0
    ds_read_b64_tr_b16 v[34:35], v11 offset:0
    v_mfma_f32_16x16x32_bf16 v[184:187], v[72:75], v[240:243], v[184:187]
    ds_read_b64_tr_b16 v[36:37], v10 offset:8192
    ds_read_b64_tr_b16 v[38:39], v11 offset:8192
    v_mfma_f32_16x16x32_bf16 v[180:183], v[72:75], v[232:235], v[180:183]
    ds_read_b64_tr_b16 v[40:41], v10 offset:256
    ds_read_b64_tr_b16 v[42:43], v11 offset:256
    v_mfma_f32_16x16x32_bf16 v[180:183], v[76:79], v[236:239], v[180:183]
    ds_read_b64_tr_b16 v[44:45], v10 offset:8448
    v_mfma_f32_16x16x32_bf16 v[176:179], v[76:79], v[228:231], v[176:179]
    ds_read_b64_tr_b16 v[46:47], v11 offset:8448
    v_mfma_f32_16x16x32_bf16 v[176:179], v[72:75], v[224:227], v[176:179]
    ds_read_b64_tr_b16 v[48:49], v10 offset:512
    v_mfma_f32_16x16x32_bf16 v[192:195], v[80:83], v[224:227], v[192:195]
    ds_read_b64_tr_b16 v[50:51], v11 offset:512
    v_mfma_f32_16x16x32_bf16 v[192:195], v[84:87], v[228:231], v[192:195]
    ds_read_b64_tr_b16 v[52:53], v10 offset:8704
    v_mfma_f32_16x16x32_bf16 v[196:199], v[84:87], v[236:239], v[196:199]
    ds_read_b64_tr_b16 v[54:55], v11 offset:8704
    v_mfma_f32_16x16x32_bf16 v[196:199], v[80:83], v[232:235], v[196:199]
    ds_read_b64_tr_b16 v[56:57], v10 offset:768
    v_mfma_f32_16x16x32_bf16 v[200:203], v[80:83], v[240:243], v[200:203]
    ds_read_b64_tr_b16 v[58:59], v11 offset:768
    v_mfma_f32_16x16x32_bf16 v[200:203], v[84:87], v[244:247], v[200:203]
    ds_read_b64_tr_b16 v[60:61], v10 offset:8960
    v_mfma_f32_16x16x32_bf16 v[204:207], v[84:87], v[252:255], v[204:207]
    ds_read_b64_tr_b16 v[62:63], v11 offset:8960
    v_mfma_f32_16x16x32_bf16 v[204:207], v[80:83], v[248:251], v[204:207]
    ds_read_b64_tr_b16 v[72:73], v13 offset:0
    v_mfma_f32_16x16x32_bf16 v[220:223], v[88:91], v[248:251], v[220:223]
    ds_read_b64_tr_b16 v[74:75], v13 offset:1024
    v_mfma_f32_16x16x32_bf16 v[220:223], v[92:95], v[252:255], v[220:223]
    ds_read_b64_tr_b16 v[76:77], v13 offset:8192
    v_mfma_f32_16x16x32_bf16 v[216:219], v[92:95], v[244:247], v[216:219]
    ds_read_b64_tr_b16 v[78:79], v13 offset:9216
    v_mfma_f32_16x16x32_bf16 v[216:219], v[88:91], v[240:243], v[216:219]
    ds_read_b64_tr_b16 v[80:81], v14 offset:0
    v_mfma_f32_16x16x32_bf16 v[212:215], v[88:91], v[232:235], v[212:215]
    ds_read_b64_tr_b16 v[82:83], v14 offset:1024
    v_mfma_f32_16x16x32_bf16 v[212:215], v[92:95], v[236:239], v[212:215]
    ds_read_b64_tr_b16 v[84:85], v14 offset:8192
    v_mfma_f32_16x16x32_bf16 v[208:211], v[92:95], v[228:231], v[208:211]
    ds_read_b64_tr_b16 v[86:87], v14 offset:9216
    v_mfma_f32_16x16x32_bf16 v[208:211], v[88:91], v[224:227], v[208:211]
    s_mov_b32 s24, 16
    s_branch L3_oloop
L3_typeB:
    s_barrier
    s_barrier
    ds_read_b64_tr_b16 v[64:65], v12 offset:0
    ds_read_b64_tr_b16 v[66:67], v12 offset:1024
    ds_read_b64_tr_b16 v[68:69], v12 offset:8192
    ds_read_b64_tr_b16 v[70:71], v12 offset:9216
    ds_read_b64_tr_b16 v[32:33], v10 offset:0
    ds_read_b64_tr_b16 v[34:35], v11 offset:0
    ds_read_b64_tr_b16 v[36:37], v10 offset:8192
    ds_read_b64_tr_b16 v[38:39], v11 offset:8192
    ds_read_b64_tr_b16 v[40:41], v10 offset:256
    ds_read_b64_tr_b16 v[42:43], v11 offset:256
    ds_read_b64_tr_b16 v[44:45], v10 offset:8448
    ds_read_b64_tr_b16 v[46:47], v11 offset:8448
    s_waitcnt lgkmcnt(4)
    ds_read_b64_tr_b16 v[48:49], v10 offset:512
    ds_read_b64_tr_b16 v[50:51], v11 offset:512
    ds_read_b64_tr_b16 v[52:53], v10 offset:8704
    ds_read_b64_tr_b16 v[54:55], v11 offset:8704
    ds_read_b64_tr_b16 v[56:57], v10 offset:768
    ds_read_b64_tr_b16 v[58:59], v11 offset:768
    ds_read_b64_tr_b16 v[60:61], v10 offset:8960
    ds_read_b64_tr_b16 v[62:63], v11 offset:8960
    s_waitcnt lgkmcnt(4)
    ds_read_b64_tr_b16 v[72:73], v13 offset:0
    ds_read_b64_tr_b16 v[74:75], v13 offset:1024
    ds_read_b64_tr_b16 v[76:77], v13 offset:8192
    ds_read_b64_tr_b16 v[78:79], v13 offset:9216
    ds_read_b64_tr_b16 v[80:81], v14 offset:0
    ds_read_b64_tr_b16 v[82:83], v14 offset:1024
    ds_read_b64_tr_b16 v[84:85], v14 offset:8192
    ds_read_b64_tr_b16 v[86:87], v14 offset:9216
    s_mov_b32 s24, 40
.p2align 4
L3_oloop:
    s_waitcnt lgkmcnt(8)
    v_mfma_f32_16x16x32_bf16 v[96:99], v[64:67], v[32:35], v[96:99]
    ds_read_b64_tr_b16 v[88:89], v15 offset:0
    v_mfma_f32_16x16x32_bf16 v[96:99], v[68:71], v[36:39], v[96:99]
    ds_read_b64_tr_b16 v[90:91], v15 offset:1024
    v_mfma_f32_16x16x32_bf16 v[100:103], v[68:71], v[44:47], v[100:103]
    ds_read_b64_tr_b16 v[92:93], v15 offset:8192
    v_mfma_f32_16x16x32_bf16 v[100:103], v[64:67], v[40:43], v[100:103]
    ds_read_b64_tr_b16 v[94:95], v15 offset:9216
    v_mfma_f32_16x16x32_bf16 v[104:107], v[64:67], v[48:51], v[104:107]
    v_mfma_f32_16x16x32_bf16 v[104:107], v[68:71], v[52:55], v[104:107]
    v_mfma_f32_16x16x32_bf16 v[108:111], v[68:71], v[60:63], v[108:111]
    v_mfma_f32_16x16x32_bf16 v[108:111], v[64:67], v[56:59], v[108:111]
    s_waitcnt lgkmcnt(0)
    s_sub_u32 s24, s24, 1
    s_cmp_eq_u32 s24, 0
    s_cbranch_scc1 L3_otail0
    s_barrier
    v_mfma_f32_16x16x32_bf16 v[124:127], v[72:75], v[56:59], v[124:127]
    ds_read_b64_tr_b16 v[64:65], v12 offset:32768
    ds_read_b64_tr_b16 v[66:67], v12 offset:33792
    v_mfma_f32_16x16x32_bf16 v[124:127], v[76:79], v[60:63], v[124:127]
    ds_read_b64_tr_b16 v[68:69], v12 offset:40960
    ds_read_b64_tr_b16 v[70:71], v12 offset:41984
    v_mfma_f32_16x16x32_bf16 v[120:123], v[76:79], v[52:55], v[120:123]
    ds_read_b64_tr_b16 v[224:225], v10 offset:32768
    ds_read_b64_tr_b16 v[226:227], v11 offset:32768
    v_mfma_f32_16x16x32_bf16 v[120:123], v[72:75], v[48:51], v[120:123]
    ds_read_b64_tr_b16 v[228:229], v10 offset:40960
    ds_read_b64_tr_b16 v[230:231], v11 offset:40960
    v_mfma_f32_16x16x32_bf16 v[116:119], v[72:75], v[40:43], v[116:119]
    ds_read_b64_tr_b16 v[232:233], v10 offset:33024
    ds_read_b64_tr_b16 v[234:235], v11 offset:33024
    v_mfma_f32_16x16x32_bf16 v[116:119], v[76:79], v[44:47], v[116:119]
    ds_read_b64_tr_b16 v[236:237], v10 offset:41216
    v_mfma_f32_16x16x32_bf16 v[112:115], v[76:79], v[36:39], v[112:115]
    ds_read_b64_tr_b16 v[238:239], v11 offset:41216
    v_mfma_f32_16x16x32_bf16 v[112:115], v[72:75], v[32:35], v[112:115]
    ds_read_b64_tr_b16 v[240:241], v10 offset:33280
    v_mfma_f32_16x16x32_bf16 v[128:131], v[80:83], v[32:35], v[128:131]
    ds_read_b64_tr_b16 v[242:243], v11 offset:33280
    v_mfma_f32_16x16x32_bf16 v[128:131], v[84:87], v[36:39], v[128:131]
    ds_read_b64_tr_b16 v[244:245], v10 offset:41472
    v_mfma_f32_16x16x32_bf16 v[132:135], v[84:87], v[44:47], v[132:135]
    ds_read_b64_tr_b16 v[246:247], v11 offset:41472
    v_mfma_f32_16x16x32_bf16 v[132:135], v[80:83], v[40:43], v[132:135]
    ds_read_b64_tr_b16 v[248:249], v10 offset:33536
    v_mfma_f32_16x16x32_bf16 v[136:139], v[80:83], v[48:51], v[136:139]
    ds_read_b64_tr_b16 v[250:251], v11 offset:33536
    v_mfma_f32_16x16x32_bf16 v[136:139], v[84:87], v[52:55], v[136:139]
    ds_read_b64_tr_b16 v[252:253], v10 offset:41728
    v_mfma_f32_16x16x32_bf16 v[140:143], v[84:87], v[60:63], v[140:143]
    ds_read_b64_tr_b16 v[254:255], v11 offset:41728
    v_mfma_f32_16x16x32_bf16 v[140:143], v[80:83], v[56:59], v[140:143]
    ds_read_b64_tr_b16 v[72:73], v13 offset:32768
    v_mfma_f32_16x16x32_bf16 v[156:159], v[88:91], v[56:59], v[156:159]
    ds_read_b64_tr_b16 v[74:75], v13 offset:33792
    v_mfma_f32_16x16x32_bf16 v[156:159], v[92:95], v[60:63], v[156:159]
    ds_read_b64_tr_b16 v[76:77], v13 offset:40960
    v_mfma_f32_16x16x32_bf16 v[152:155], v[92:95], v[52:55], v[152:155]
    ds_read_b64_tr_b16 v[78:79], v13 offset:41984
    v_mfma_f32_16x16x32_bf16 v[152:155], v[88:91], v[48:51], v[152:155]
    ds_read_b64_tr_b16 v[80:81], v14 offset:32768
    v_mfma_f32_16x16x32_bf16 v[148:151], v[88:91], v[40:43], v[148:151]
    ds_read_b64_tr_b16 v[82:83], v14 offset:33792
    v_mfma_f32_16x16x32_bf16 v[148:151], v[92:95], v[44:47], v[148:151]
    ds_read_b64_tr_b16 v[84:85], v14 offset:40960
    v_mfma_f32_16x16x32_bf16 v[144:147], v[92:95], v[36:39], v[144:147]
    ds_read_b64_tr_b16 v[86:87], v14 offset:41984
    v_mfma_f32_16x16x32_bf16 v[144:147], v[88:91], v[32:35], v[144:147]
    s_waitcnt lgkmcnt(8)
    v_mfma_f32_16x16x32_bf16 v[96:99], v[64:67], v[224:227], v[96:99]
    ds_read_b64_tr_b16 v[88:89], v15 offset:32768
    v_mfma_f32_16x16x32_bf16 v[96:99], v[68:71], v[228:231], v[96:99]
    ds_read_b64_tr_b16 v[90:91], v15 offset:33792
    v_mfma_f32_16x16x32_bf16 v[100:103], v[68:71], v[236:239], v[100:103]
    ds_read_b64_tr_b16 v[92:93], v15 offset:40960
    v_mfma_f32_16x16x32_bf16 v[100:103], v[64:67], v[232:235], v[100:103]
    ds_read_b64_tr_b16 v[94:95], v15 offset:41984
    v_mfma_f32_16x16x32_bf16 v[104:107], v[64:67], v[240:243], v[104:107]
    v_mfma_f32_16x16x32_bf16 v[104:107], v[68:71], v[244:247], v[104:107]
    v_mfma_f32_16x16x32_bf16 v[108:111], v[68:71], v[252:255], v[108:111]
    v_mfma_f32_16x16x32_bf16 v[108:111], v[64:67], v[248:251], v[108:111]
    s_waitcnt lgkmcnt(0)
    s_sub_u32 s24, s24, 1
    s_cmp_eq_u32 s24, 0
    s_cbranch_scc1 L3_otail1
    s_barrier
    v_mfma_f32_16x16x32_bf16 v[124:127], v[72:75], v[248:251], v[124:127]
    ds_read_b64_tr_b16 v[64:65], v20 offset:0
    ds_read_b64_tr_b16 v[66:67], v20 offset:1024
    v_mfma_f32_16x16x32_bf16 v[124:127], v[76:79], v[252:255], v[124:127]
    ds_read_b64_tr_b16 v[68:69], v20 offset:8192
    ds_read_b64_tr_b16 v[70:71], v20 offset:9216
    v_mfma_f32_16x16x32_bf16 v[120:123], v[76:79], v[244:247], v[120:123]
    ds_read_b64_tr_b16 v[32:33], v18 offset:0
    ds_read_b64_tr_b16 v[34:35], v19 offset:0
    v_mfma_f32_16x16x32_bf16 v[120:123], v[72:75], v[240:243], v[120:123]
    ds_read_b64_tr_b16 v[36:37], v18 offset:8192
    ds_read_b64_tr_b16 v[38:39], v19 offset:8192
    v_mfma_f32_16x16x32_bf16 v[116:119], v[72:75], v[232:235], v[116:119]
    ds_read_b64_tr_b16 v[40:41], v18 offset:256
    ds_read_b64_tr_b16 v[42:43], v19 offset:256
    v_mfma_f32_16x16x32_bf16 v[116:119], v[76:79], v[236:239], v[116:119]
    ds_read_b64_tr_b16 v[44:45], v18 offset:8448
    v_mfma_f32_16x16x32_bf16 v[112:115], v[76:79], v[228:231], v[112:115]
    ds_read_b64_tr_b16 v[46:47], v19 offset:8448
    v_mfma_f32_16x16x32_bf16 v[112:115], v[72:75], v[224:227], v[112:115]
    ds_read_b64_tr_b16 v[48:49], v18 offset:512
    v_mfma_f32_16x16x32_bf16 v[128:131], v[80:83], v[224:227], v[128:131]
    ds_read_b64_tr_b16 v[50:51], v19 offset:512
    v_mfma_f32_16x16x32_bf16 v[128:131], v[84:87], v[228:231], v[128:131]
    ds_read_b64_tr_b16 v[52:53], v18 offset:8704
    v_mfma_f32_16x16x32_bf16 v[132:135], v[84:87], v[236:239], v[132:135]
    ds_read_b64_tr_b16 v[54:55], v19 offset:8704
    v_mfma_f32_16x16x32_bf16 v[132:135], v[80:83], v[232:235], v[132:135]
    ds_read_b64_tr_b16 v[56:57], v18 offset:768
    v_mfma_f32_16x16x32_bf16 v[136:139], v[80:83], v[240:243], v[136:139]
    ds_read_b64_tr_b16 v[58:59], v19 offset:768
    v_mfma_f32_16x16x32_bf16 v[136:139], v[84:87], v[244:247], v[136:139]
    ds_read_b64_tr_b16 v[60:61], v18 offset:8960
    v_mfma_f32_16x16x32_bf16 v[140:143], v[84:87], v[252:255], v[140:143]
    ds_read_b64_tr_b16 v[62:63], v19 offset:8960
    v_mfma_f32_16x16x32_bf16 v[140:143], v[80:83], v[248:251], v[140:143]
    ds_read_b64_tr_b16 v[72:73], v21 offset:0
    v_mfma_f32_16x16x32_bf16 v[156:159], v[88:91], v[248:251], v[156:159]
    ds_read_b64_tr_b16 v[74:75], v21 offset:1024
    v_mfma_f32_16x16x32_bf16 v[156:159], v[92:95], v[252:255], v[156:159]
    ds_read_b64_tr_b16 v[76:77], v21 offset:8192
    v_mfma_f32_16x16x32_bf16 v[152:155], v[92:95], v[244:247], v[152:155]
    ds_read_b64_tr_b16 v[78:79], v21 offset:9216
    v_mfma_f32_16x16x32_bf16 v[152:155], v[88:91], v[240:243], v[152:155]
    ds_read_b64_tr_b16 v[80:81], v22 offset:0
    v_mfma_f32_16x16x32_bf16 v[148:151], v[88:91], v[232:235], v[148:151]
    ds_read_b64_tr_b16 v[82:83], v22 offset:1024
    v_mfma_f32_16x16x32_bf16 v[148:151], v[92:95], v[236:239], v[148:151]
    ds_read_b64_tr_b16 v[84:85], v22 offset:8192
    v_mfma_f32_16x16x32_bf16 v[144:147], v[92:95], v[228:231], v[144:147]
    ds_read_b64_tr_b16 v[86:87], v22 offset:9216
    v_mfma_f32_16x16x32_bf16 v[144:147], v[88:91], v[224:227], v[144:147]
    s_waitcnt lgkmcnt(8)
    v_mfma_f32_16x16x32_bf16 v[96:99], v[64:67], v[32:35], v[96:99]
    ds_read_b64_tr_b16 v[88:89], v23 offset:0
    v_mfma_f32_16x16x32_bf16 v[96:99], v[68:71], v[36:39], v[96:99]
    ds_read_b64_tr_b16 v[90:91], v23 offset:1024
    v_mfma_f32_16x16x32_bf16 v[100:103], v[68:71], v[44:47], v[100:103]
    ds_read_b64_tr_b16 v[92:93], v23 offset:8192
    v_mfma_f32_16x16x32_bf16 v[100:103], v[64:67], v[40:43], v[100:103]
    ds_read_b64_tr_b16 v[94:95], v23 offset:9216
    v_mfma_f32_16x16x32_bf16 v[104:107], v[64:67], v[48:51], v[104:107]
    v_mfma_f32_16x16x32_bf16 v[104:107], v[68:71], v[52:55], v[104:107]
    v_mfma_f32_16x16x32_bf16 v[108:111], v[68:71], v[60:63], v[108:111]
    v_mfma_f32_16x16x32_bf16 v[108:111], v[64:67], v[56:59], v[108:111]
    s_waitcnt lgkmcnt(0)
    s_sub_u32 s24, s24, 1
    s_cmp_eq_u32 s24, 0
    s_cbranch_scc1 L3_otail0
    s_barrier
    v_mfma_f32_16x16x32_bf16 v[124:127], v[72:75], v[56:59], v[124:127]
    ds_read_b64_tr_b16 v[64:65], v20 offset:32768
    ds_read_b64_tr_b16 v[66:67], v20 offset:33792
    v_mfma_f32_16x16x32_bf16 v[124:127], v[76:79], v[60:63], v[124:127]
    ds_read_b64_tr_b16 v[68:69], v20 offset:40960
    ds_read_b64_tr_b16 v[70:71], v20 offset:41984
    v_mfma_f32_16x16x32_bf16 v[120:123], v[76:79], v[52:55], v[120:123]
    ds_read_b64_tr_b16 v[224:225], v18 offset:32768
    ds_read_b64_tr_b16 v[226:227], v19 offset:32768
    v_mfma_f32_16x16x32_bf16 v[120:123], v[72:75], v[48:51], v[120:123]
    ds_read_b64_tr_b16 v[228:229], v18 offset:40960
    ds_read_b64_tr_b16 v[230:231], v19 offset:40960
    v_mfma_f32_16x16x32_bf16 v[116:119], v[72:75], v[40:43], v[116:119]
    ds_read_b64_tr_b16 v[232:233], v18 offset:33024
    ds_read_b64_tr_b16 v[234:235], v19 offset:33024
    v_mfma_f32_16x16x32_bf16 v[116:119], v[76:79], v[44:47], v[116:119]
    ds_read_b64_tr_b16 v[236:237], v18 offset:41216
    v_mfma_f32_16x16x32_bf16 v[112:115], v[76:79], v[36:39], v[112:115]
    ds_read_b64_tr_b16 v[238:239], v19 offset:41216
    v_mfma_f32_16x16x32_bf16 v[112:115], v[72:75], v[32:35], v[112:115]
    ds_read_b64_tr_b16 v[240:241], v18 offset:33280
    v_mfma_f32_16x16x32_bf16 v[128:131], v[80:83], v[32:35], v[128:131]
    ds_read_b64_tr_b16 v[242:243], v19 offset:33280
    v_mfma_f32_16x16x32_bf16 v[128:131], v[84:87], v[36:39], v[128:131]
    ds_read_b64_tr_b16 v[244:245], v18 offset:41472
    v_mfma_f32_16x16x32_bf16 v[132:135], v[84:87], v[44:47], v[132:135]
    ds_read_b64_tr_b16 v[246:247], v19 offset:41472
    v_mfma_f32_16x16x32_bf16 v[132:135], v[80:83], v[40:43], v[132:135]
    ds_read_b64_tr_b16 v[248:249], v18 offset:33536
    v_mfma_f32_16x16x32_bf16 v[136:139], v[80:83], v[48:51], v[136:139]
    ds_read_b64_tr_b16 v[250:251], v19 offset:33536
    v_mfma_f32_16x16x32_bf16 v[136:139], v[84:87], v[52:55], v[136:139]
    ds_read_b64_tr_b16 v[252:253], v18 offset:41728
    v_mfma_f32_16x16x32_bf16 v[140:143], v[84:87], v[60:63], v[140:143]
    ds_read_b64_tr_b16 v[254:255], v19 offset:41728
    v_mfma_f32_16x16x32_bf16 v[140:143], v[80:83], v[56:59], v[140:143]
    ds_read_b64_tr_b16 v[72:73], v21 offset:32768
    v_mfma_f32_16x16x32_bf16 v[156:159], v[88:91], v[56:59], v[156:159]
    ds_read_b64_tr_b16 v[74:75], v21 offset:33792
    v_mfma_f32_16x16x32_bf16 v[156:159], v[92:95], v[60:63], v[156:159]
    ds_read_b64_tr_b16 v[76:77], v21 offset:40960
    v_mfma_f32_16x16x32_bf16 v[152:155], v[92:95], v[52:55], v[152:155]
    ds_read_b64_tr_b16 v[78:79], v21 offset:41984
    v_mfma_f32_16x16x32_bf16 v[152:155], v[88:91], v[48:51], v[152:155]
    ds_read_b64_tr_b16 v[80:81], v22 offset:32768
    v_mfma_f32_16x16x32_bf16 v[148:151], v[88:91], v[40:43], v[148:151]
    ds_read_b64_tr_b16 v[82:83], v22 offset:33792
    v_mfma_f32_16x16x32_bf16 v[148:151], v[92:95], v[44:47], v[148:151]
    ds_read_b64_tr_b16 v[84:85], v22 offset:40960
    v_mfma_f32_16x16x32_bf16 v[144:147], v[92:95], v[36:39], v[144:147]
    ds_read_b64_tr_b16 v[86:87], v22 offset:41984
    v_mfma_f32_16x16x32_bf16 v[144:147], v[88:91], v[32:35], v[144:147]
    s_waitcnt lgkmcnt(8)
    v_mfma_f32_16x16x32_bf16 v[96:99], v[64:67], v[224:227], v[96:99]
    ds_read_b64_tr_b16 v[88:89], v23 offset:32768
    v_mfma_f32_16x16x32_bf16 v[96:99], v[68:71], v[228:231], v[96:99]
    ds_read_b64_tr_b16 v[90:91], v23 offset:33792
    v_mfma_f32_16x16x32_bf16 v[100:103], v[68:71], v[236:239], v[100:103]
    ds_read_b64_tr_b16 v[92:93], v23 offset:40960
    v_mfma_f32_16x16x32_bf16 v[100:103], v[64:67], v[232:235], v[100:103]
    ds_read_b64_tr_b16 v[94:95], v23 offset:41984
    v_mfma_f32_16x16x32_bf16 v[104:107], v[64:67], v[240:243], v[104:107]
    v_mfma_f32_16x16x32_bf16 v[104:107], v[68:71], v[244:247], v[104:107]
    v_mfma_f32_16x16x32_bf16 v[108:111], v[68:71], v[252:255], v[108:111]
    v_mfma_f32_16x16x32_bf16 v[108:111], v[64:67], v[248:251], v[108:111]
    s_waitcnt lgkmcnt(0)
    s_sub_u32 s24, s24, 1
    s_cmp_eq_u32 s24, 0
    s_cbranch_scc1 L3_otail1
    s_barrier
    v_mfma_f32_16x16x32_bf16 v[124:127], v[72:75], v[248:251], v[124:127]
    ds_read_b64_tr_b16 v[64:65], v12 offset:0
    ds_read_b64_tr_b16 v[66:67], v12 offset:1024
    v_mfma_f32_16x16x32_bf16 v[124:127], v[76:79], v[252:255], v[124:127]
    ds_read_b64_tr_b16 v[68:69], v12 offset:8192
    ds_read_b64_tr_b16 v[70:71], v12 offset:9216
    v_mfma_f32_16x16x32_bf16 v[120:123], v[76:79], v[244:247], v[120:123]
    ds_read_b64_tr_b16 v[32:33], v10 offset:0
    ds_read_b64_tr_b16 v[34:35], v11 offset:0
    v_mfma_f32_16x16x32_bf16 v[120:123], v[72:75], v[240:243], v[120:123]
    ds_read_b64_tr_b16 v[36:37], v10 offset:8192
    ds_read_b64_tr_b16 v[38:39], v11 offset:8192
    v_mfma_f32_16x16x32_bf16 v[116:119], v[72:75], v[232:235], v[116:119]
    ds_read_b64_tr_b16 v[40:41], v10 offset:256
    ds_read_b64_tr_b16 v[42:43], v11 offset:256
    v_mfma_f32_16x16x32_bf16 v[116:119], v[76:79], v[236:239], v[116:119]
    ds_read_b64_tr_b16 v[44:45], v10 offset:8448
    v_mfma_f32_16x16x32_bf16 v[112:115], v[76:79], v[228:231], v[112:115]
    ds_read_b64_tr_b16 v[46:47], v11 offset:8448
    v_mfma_f32_16x16x32_bf16 v[112:115], v[72:75], v[224:227], v[112:115]
    ds_read_b64_tr_b16 v[48:49], v10 offset:512
    v_mfma_f32_16x16x32_bf16 v[128:131], v[80:83], v[224:227], v[128:131]
    ds_read_b64_tr_b16 v[50:51], v11 offset:512
    v_mfma_f32_16x16x32_bf16 v[128:131], v[84:87], v[228:231], v[128:131]
    ds_read_b64_tr_b16 v[52:53], v10 offset:8704
    v_mfma_f32_16x16x32_bf16 v[132:135], v[84:87], v[236:239], v[132:135]
    ds_read_b64_tr_b16 v[54:55], v11 offset:8704
    v_mfma_f32_16x16x32_bf16 v[132:135], v[80:83], v[232:235], v[132:135]
    ds_read_b64_tr_b16 v[56:57], v10 offset:768
    v_mfma_f32_16x16x32_bf16 v[136:139], v[80:83], v[240:243], v[136:139]
    ds_read_b64_tr_b16 v[58:59], v11 offset:768
    v_mfma_f32_16x16x32_bf16 v[136:139], v[84:87], v[244:247], v[136:139]
    ds_read_b64_tr_b16 v[60:61], v10 offset:8960
    v_mfma_f32_16x16x32_bf16 v[140:143], v[84:87], v[252:255], v[140:143]
    ds_read_b64_tr_b16 v[62:63], v11 offset:8960
    v_mfma_f32_16x16x32_bf16 v[140:143], v[80:83], v[248:251], v[140:143]
    ds_read_b64_tr_b16 v[72:73], v13 offset:0
    v_mfma_f32_16x16x32_bf16 v[156:159], v[88:91], v[248:251], v[156:159]
    ds_read_b64_tr_b16 v[74:75], v13 offset:1024
    v_mfma_f32_16x16x32_bf16 v[156:159], v[92:95], v[252:255], v[156:159]
    ds_read_b64_tr_b16 v[76:77], v13 offset:8192
    v_mfma_f32_16x16x32_bf16 v[152:155], v[92:95], v[244:247], v[152:155]
    ds_read_b64_tr_b16 v[78:79], v13 offset:9216
    v_mfma_f32_16x16x32_bf16 v[152:155], v[88:91], v[240:243], v[152:155]
    ds_read_b64_tr_b16 v[80:81], v14 offset:0
    v_mfma_f32_16x16x32_bf16 v[148:151], v[88:91], v[232:235], v[148:151]
    ds_read_b64_tr_b16 v[82:83], v14 offset:1024
    v_mfma_f32_16x16x32_bf16 v[148:151], v[92:95], v[236:239], v[148:151]
    ds_read_b64_tr_b16 v[84:85], v14 offset:8192
    v_mfma_f32_16x16x32_bf16 v[144:147], v[92:95], v[228:231], v[144:147]
    ds_read_b64_tr_b16 v[86:87], v14 offset:9216
    v_mfma_f32_16x16x32_bf16 v[144:147], v[88:91], v[224:227], v[144:147]
    s_branch L3_oloop
L3_otail0:
    v_mfma_f32_16x16x32_bf16 v[124:127], v[72:75], v[56:59], v[124:127]
    v_mfma_f32_16x16x32_bf16 v[124:127], v[76:79], v[60:63], v[124:127]
    v_mfma_f32_16x16x32_bf16 v[120:123], v[76:79], v[52:55], v[120:123]
    v_mfma_f32_16x16x32_bf16 v[120:123], v[72:75], v[48:51], v[120:123]
    v_mfma_f32_16x16x32_bf16 v[116:119], v[72:75], v[40:43], v[116:119]
    v_mfma_f32_16x16x32_bf16 v[116:119], v[76:79], v[44:47], v[116:119]
    v_mfma_f32_16x16x32_bf16 v[112:115], v[76:79], v[36:39], v[112:115]
    v_mfma_f32_16x16x32_bf16 v[112:115], v[72:75], v[32:35], v[112:115]
    v_mfma_f32_16x16x32_bf16 v[128:131], v[80:83], v[32:35], v[128:131]
    v_mfma_f32_16x16x32_bf16 v[128:131], v[84:87], v[36:39], v[128:131]
    v_mfma_f32_16x16x32_bf16 v[132:135], v[84:87], v[44:47], v[132:135]
    v_mfma_f32_16x16x32_bf16 v[132:135], v[80:83], v[40:43], v[132:135]
    v_mfma_f32_16x16x32_bf16 v[136:139], v[80:83], v[48:51], v[136:139]
    v_mfma_f32_16x16x32_bf16 v[136:139], v[84:87], v[52:55], v[136:139]
    v_mfma_f32_16x16x32_bf16 v[140:143], v[84:87], v[60:63], v[140:143]
    v_mfma_f32_16x16x32_bf16 v[140:143], v[80:83], v[56:59], v[140:143]
    v_mfma_f32_16x16x32_bf16 v[156:159], v[88:91], v[56:59], v[156:159]
    v_mfma_f32_16x16x32_bf16 v[156:159], v[92:95], v[60:63], v[156:159]
    v_mfma_f32_16x16x32_bf16 v[152:155], v[92:95], v[52:55], v[152:155]
    v_mfma_f32_16x16x32_bf16 v[152:155], v[88:91], v[48:51], v[152:155]
    v_mfma_f32_16x16x32_bf16 v[148:151], v[88:91], v[40:43], v[148:151]
    v_mfma_f32_16x16x32_bf16 v[148:151], v[92:95], v[44:47], v[148:151]
    v_mfma_f32_16x16x32_bf16 v[144:147], v[92:95], v[36:39], v[144:147]
    v_mfma_f32_16x16x32_bf16 v[144:147], v[88:91], v[32:35], v[144:147]
    s_branch L3_odone
L3_otail1:
    v_mfma_f32_16x16x32_bf16 v[124:127], v[72:75], v[248:251], v[124:127]
    v_mfma_f32_16x16x32_bf16 v[124:127], v[76:79], v[252:255], v[124:127]
    v_mfma_f32_16x16x32_bf16 v[120:123], v[76:79], v[244:247], v[120:123]
    v_mfma_f32_16x16x32_bf16 v[120:123], v[72:75], v[240:243], v[120:123]
    v_mfma_f32_16x16x32_bf16 v[116:119], v[72:75], v[232:235], v[116:119]
    v_mfma_f32_16x16x32_bf16 v[116:119], v[76:79], v[236:239], v[116:119]
    v_mfma_f32_16x16x32_bf16 v[112:115], v[76:79], v[228:231], v[112:115]
    v_mfma_f32_16x16x32_bf16 v[112:115], v[72:75], v[224:227], v[112:115]
    v_mfma_f32_16x16x32_bf16 v[128:131], v[80:83], v[224:227], v[128:131]
    v_mfma_f32_16x16x32_bf16 v[128:131], v[84:87], v[228:231], v[128:131]
    v_mfma_f32_16x16x32_bf16 v[132:135], v[84:87], v[236:239], v[132:135]
    v_mfma_f32_16x16x32_bf16 v[132:135], v[80:83], v[232:235], v[132:135]
    v_mfma_f32_16x16x32_bf16 v[136:139], v[80:83], v[240:243], v[136:139]
    v_mfma_f32_16x16x32_bf16 v[136:139], v[84:87], v[244:247], v[136:139]
    v_mfma_f32_16x16x32_bf16 v[140:143], v[84:87], v[252:255], v[140:143]
    v_mfma_f32_16x16x32_bf16 v[140:143], v[80:83], v[248:251], v[140:143]
    v_mfma_f32_16x16x32_bf16 v[156:159], v[88:91], v[248:251], v[156:159]
    v_mfma_f32_16x16x32_bf16 v[156:159], v[92:95], v[252:255], v[156:159]
    v_mfma_f32_16x16x32_bf16 v[152:155], v[92:95], v[244:247], v[152:155]
    v_mfma_f32_16x16x32_bf16 v[152:155], v[88:91], v[240:243], v[152:155]
    v_mfma_f32_16x16x32_bf16 v[148:151], v[88:91], v[232:235], v[148:151]
    v_mfma_f32_16x16x32_bf16 v[148:151], v[92:95], v[236:239], v[148:151]
    v_mfma_f32_16x16x32_bf16 v[144:147], v[92:95], v[228:231], v[144:147]
    v_mfma_f32_16x16x32_bf16 v[144:147], v[88:91], v[224:227], v[144:147]
L3_odone:
    s_cmp_lg_u32 s27, 0
    s_cbranch_scc1 L3_nox
    ds_read_b64 v[224:225], v28 offset:0
    ds_read_b64 v[226:227], v28 offset:4096
    ds_read_b64 v[228:229], v28 offset:8192
    ds_read_b64 v[230:231], v28 offset:12288
    ds_read_b64 v[232:233], v29 offset:0
    ds_read_b64 v[234:235], v29 offset:4096
    ds_read_b64 v[236:237], v29 offset:8192
    ds_read_b64 v[238:239], v29 offset:12288
    ds_read_b64 v[240:241], v30 offset:0
    ds_read_b64 v[242:243], v30 offset:4096
    ds_read_b64 v[244:245], v30 offset:8192
    ds_read_b64 v[246:247], v30 offset:12288
    s_waitcnt lgkmcnt(8)
    ds_read_b64 v[248:249], v31 offset:0
    ds_read_b64 v[250:251], v31 offset:4096
    ds_read_b64 v[252:253], v31 offset:8192
    ds_read_b64 v[254:255], v31 offset:12288
L3_nox:
    s_nop 7
    v_lshlrev_b32 v5, 4, v2
    v_mov_b32 v9, 0
    s_cmp_eq_u32 s27, 0
    s_cbranch_scc1 L3_finish
    v_cvt_pk_bf16_f32 v160, v96, v97
    v_cvt_pk_bf16_f32 v161, v98, v99
    v_cvt_pk_bf16_f32 v162, v100, v101
    v_cvt_pk_bf16_f32 v163, v102, v103
    buffer_store_dwordx4 v[160:163], v5, s[8:11], s70 offen offset:0 sc1
    v_cvt_pk_bf16_f32 v164, v104, v105
    v_cvt_pk_bf16_f32 v165, v106, v107
    v_cvt_pk_bf16_f32 v166, v108, v109
    v_cvt_pk_bf16_f32 v167, v110, v111
    buffer_store_dwordx4 v[164:167], v5, s[8:11], s70 offen offset:1024 sc1
    v_cvt_pk_bf16_f32 v168, v112, v113
    v_cvt_pk_bf16_f32 v169, v114, v115
    v_cvt_pk_bf16_f32 v170, v116, v117
    v_cvt_pk_bf16_f32 v171, v118, v119
    buffer_store_dwordx4 v[168:171], v5, s[8:11], s70 offen offset:2048 sc1
    v_cvt_pk_bf16_f32 v172, v120, v121
    v_cvt_pk_bf16_f32 v173, v122, v123
    v_cvt_pk_bf16_f32 v174, v124, v125
    v_cvt_pk_bf16_f32 v175, v126, v127
    buffer_store_dwordx4 v[172:175], v5, s[8:11], s70 offen offset:3072 sc1
    s_add_u32 s70, s70, 4096
    v_cvt_pk_bf16_f32 v176, v128, v129
    v_cvt_pk_bf16_f32 v177, v130, v131
    v_cvt_pk_bf16_f32 v178, v132, v133
    v_cvt_pk_bf16_f32 v179, v134, v135
    buffer_store_dwordx4 v[176:179], v5, s[8:11], s70 offen offset:0 sc1
    v_cvt_pk_bf16_f32 v180, v136, v137
    v_cvt_pk_bf16_f32 v181, v138, v139
    v_cvt_pk_bf16_f32 v182, v140, v141
    v_cvt_pk_bf16_f32 v183, v142, v143
    buffer_store_dwordx4 v[180:183], v5, s[8:11], s70 offen offset:1024 sc1
    v_cvt_pk_bf16_f32 v184, v144, v145
    v_cvt_pk_bf16_f32 v185, v146, v147
    v_cvt_pk_bf16_f32 v186, v148, v149
    v_cvt_pk_bf16_f32 v187, v150, v151
    buffer_store_dwordx4 v[184:187], v5, s[8:11], s70 offen offset:2048 sc1
    v_cvt_pk_bf16_f32 v188, v152, v153
    v_cvt_pk_bf16_f32 v189, v154, v155
    v_cvt_pk_bf16_f32 v190, v156, v157
    v_cvt_pk_bf16_f32 v191, v158, v159
    buffer_store_dwordx4 v[188:191], v5, s[8:11], s70 offen offset:3072 sc1
    v_mov_b32 v3, 1
    s_waitcnt vmcnt(0)
    s_mov_b64 exec, 1
    buffer_store_dword v3, v9, s[8:11], s71 offen sc1
    s_mov_b64 exec, -1
    s_branch L3_end
L3_finish:
    s_mov_b32 s16, s58
    s_and_b32 s17, s59, 0xffff
    s_mov_b32 s18, 8388608
    s_mov_b32 s19, 0x20000
    s_lshr_b32 s3, s26, 1
    s_add_u32 s3, s3, 49
    s_and_b32 s3, s3, 3
    s_lshl_b32 s3, s3, 15
    s_and_b32 s4, s26, 1
    s_lshl_b32 s4, s4, 14
    s_add_u32 s3, s3, s4
    v_and_b32 v6, 15, v2
    v_lshrrev_b32 v7, 4, v2
    v_xor_b32 v8, v6, v7
    v_lshl_add_u32 v8, v8, 4, s3
    v_lshl_add_u32 v10, v6, 8, v8
    v_lshl_add_u32 v14, v7, 8, v8
    v_xor_b32 v11, 64, v10
    v_xor_b32 v15, 64, v14
    v_xor_b32 v12, 128, v10
    v_xor_b32 v16, 128, v14
    v_xor_b32 v13, 192, v10
    v_xor_b32 v17, 192, v14
    s_lshl_b32 s3, s30, 7
    s_lshl_b32 s4, s64, 6
    s_add_u32 s3, s3, s4
    v_add_u32 v7, s3, v7
    v_lshlrev_b32 v18, 12, v7
    v_lshl_add_u32 v18, v6, 4, v18
    s_lshl_b32 s3, s31, 9
    s_lshl_b32 s4, s65, 8
    s_add_u32 s3, s3, s4
    v_add_u32 v18, s3, v18
    v_add_u32 v5, s72, v5
    v_mov_b32 v28, 0xbfb8aa3b
    s_waitcnt lgkmcnt(0)
    s_barrier
    ds_read_b128 v[64:67], v5 offset:0
    ds_read_b128 v[68:71], v5 offset:1024
    ds_read_b128 v[72:75], v5 offset:2048
    ds_read_b128 v[76:79], v5 offset:3072
    ds_read_b128 v[80:83], v5 offset:4096
    ds_read_b128 v[84:87], v5 offset:5120
    ds_read_b128 v[88:91], v5 offset:6144
    ds_read_b128 v[92:95], v5 offset:7168
    s_waitcnt lgkmcnt(0)
    v_lshlrev_b32 v32, 16, v64
    v_and_b32 v33, 0xffff0000, v64
    v_lshlrev_b32 v34, 16, v65
    v_and_b32 v35, 0xffff0000, v65
    v_pk_add_f32 v[96:97], v[96:97], v[32:33]
    v_pk_add_f32 v[98:99], v[98:99], v[34:35]
    v_pk_mul_f32 v[32:33], v[96:97], v[28:29] op_sel_hi:[1,0]
    v_pk_mul_f32 v[34:35], v[98:99], v[28:29] op_sel_hi:[1,0]
    v_exp_f32 v32, v32
    v_exp_f32 v33, v33
    v_exp_f32 v34, v34
    v_exp_f32 v35, v35
    v_pk_mul_f32 v[96:97], v[96:97], v[160:161]
    v_pk_mul_f32 v[98:99], v[98:99], v[162:163]
    v_pk_add_f32 v[32:33], v[32:33], 1.0 op_sel_hi:[1,0]
    v_pk_add_f32 v[34:35], v[34:35], 1.0 op_sel_hi:[1,0]
    v_rcp_f32 v32, v32
    v_rcp_f32 v33, v33
    v_rcp_f32 v34, v34
    v_rcp_f32 v35, v35
    v_lshlrev_b32 v160, 16, v224
    v_and_b32 v161, 0xffff0000, v224
    v_lshlrev_b32 v162, 16, v225
    v_and_b32 v163, 0xffff0000, v225
    v_pk_fma_f32 v[160:161], v[96:97], v[32:33], v[160:161]
    v_pk_fma_f32 v[162:163], v[98:99], v[34:35], v[162:163]
    ds_write_b128 v10, v[160:163] offset:0
    v_lshlrev_b32 v36, 16, v72
    v_and_b32 v37, 0xffff0000, v72
    v_lshlrev_b32 v38, 16, v73
    v_and_b32 v39, 0xffff0000, v73
    v_pk_add_f32 v[112:113], v[112:113], v[36:37]
    v_pk_add_f32 v[114:115], v[114:115], v[38:39]
    v_pk_mul_f32 v[36:37], v[112:113], v[28:29] op_sel_hi:[1,0]
    v_pk_mul_f32 v[38:39], v[114:115], v[28:29] op_sel_hi:[1,0]
    v_exp_f32 v36, v36
    v_exp_f32 v37, v37
    v_exp_f32 v38, v38
    v_exp_f32 v39, v39
    v_pk_mul_f32 v[112:113], v[112:113], v[176:177]
    v_pk_mul_f32 v[114:115], v[114:115], v[178:179]
    v_pk_add_f32 v[36:37], v[36:37], 1.0 op_sel_hi:[1,0]
    v_pk_add_f32 v[38:39], v[38:39], 1.0 op_sel_hi:[1,0]
    v_rcp_f32 v36, v36
    v_rcp_f32 v37, v37
    v_rcp_f32 v38, v38
    v_rcp_f32 v39, v39
    v_lshlrev_b32 v176, 16, v232
    v_and_b32 v177, 0xffff0000, v232
    v_lshlrev_b32 v178, 16, v233
    v_and_b32 v179, 0xffff0000, v233
    v_pk_fma_f32 v[176:177], v[112:113], v[36:37], v[176:177]
    v_pk_fma_f32 v[178:179], v[114:115], v[38:39], v[178:179]
    ds_write_b128 v11, v[176:179] offset:0
    v_lshlrev_b32 v40, 16, v80
    v_and_b32 v41, 0xffff0000, v80
    v_lshlrev_b32 v42, 16, v81
    v_and_b32 v43, 0xffff0000, v81
    v_pk_add_f32 v[128:129], v[128:129], v[40:41]
    v_pk_add_f32 v[130:131], v[130:131], v[42:43]
    v_pk_mul_f32 v[40:41], v[128:129], v[28:29] op_sel_hi:[1,0]
    v_pk_mul_f32 v[42:43], v[130:131], v[28:29] op_sel_hi:[1,0]
    v_exp_f32 v40, v40
    v_exp_f32 v41, v41
    v_exp_f32 v42, v42
    v_exp_f32 v43, v43
    v_pk_mul_f32 v[128:129], v[128:129], v[192:193]
    v_pk_mul_f32 v[130:131], v[130:131], v[194:195]
    v_pk_add_f32 v[40:41], v[40:41], 1.0 op_sel_hi:[1,0]
    v_pk_add_f32 v[42:43], v[42:43], 1.0 op_sel_hi:[1,0]
    v_rcp_f32 v40, v40
    v_rcp_f32 v41, v41
    v_rcp_f32 v42, v42
    v_rcp_f32 v43, v43
    v_lshlrev_b32 v192, 16, v240
    v_and_b32 v193, 0xffff0000, v240
    v_lshlrev_b32 v194, 16, v241
    v_and_b32 v195, 0xffff0000, v241
    v_pk_fma_f32 v[192:193], v[128:129], v[40:41], v[192:193]
    v_pk_fma_f32 v[194:195], v[130:131], v[42:43], v[194:195]
    ds_write_b128 v12, v[192:195] offset:0
    v_lshlrev_b32 v44, 16, v88
    v_and_b32 v45, 0xffff0000, v88
    v_lshlrev_b32 v46, 16, v89
    v_and_b32 v47, 0xffff0000, v89
    v_pk_add_f32 v[144:145], v[144:145], v[44:45]
    v_pk_add_f32 v[146:147], v[146:147], v[46:47]
    v_pk_mul_f32 v[44:45], v[144:145], v[28:29] op_sel_hi:[1,0]
    v_pk_mul_f32 v[46:47], v[146:147], v[28:29] op_sel_hi:[1,0]
    v_exp_f32 v44, v44
    v_exp_f32 v45, v45
    v_exp_f32 v46, v46
    v_exp_f32 v47, v47
    v_pk_mul_f32 v[144:145], v[144:145], v[208:209]
    v_pk_mul_f32 v[146:147], v[146:147], v[210:211]
    v_pk_add_f32 v[44:45], v[44:45], 1.0 op_sel_hi:[1,0]
    v_pk_add_f32 v[46:47], v[46:47], 1.0 op_sel_hi:[1,0]
    v_rcp_f32 v44, v44
    v_rcp_f32 v45, v45
    v_rcp_f32 v46, v46
    v_rcp_f32 v47, v47
    v_lshlrev_b32 v208, 16, v248
    v_and_b32 v209, 0xffff0000, v248
    v_lshlrev_b32 v210, 16, v249
    v_and_b32 v211, 0xffff0000, v249
    v_pk_fma_f32 v[208:209], v[144:145], v[44:45], v[208:209]
    v_pk_fma_f32 v[210:211], v[146:147], v[46:47], v[210:211]
    ds_write_b128 v13, v[208:211] offset:0
    ds_read_b128 v[48:51], v14 offset:0
    ds_read_b128 v[52:55], v15 offset:1024
    ds_read_b128 v[56:59], v16 offset:2048
    ds_read_b128 v[60:63], v17 offset:3072
    v_lshlrev_b32 v32, 16, v66
    v_and_b32 v33, 0xffff0000, v66
    v_lshlrev_b32 v34, 16, v67
    v_and_b32 v35, 0xffff0000, v67
    v_pk_add_f32 v[100:101], v[100:101], v[32:33]
    v_pk_add_f32 v[102:103], v[102:103], v[34:35]
    v_pk_mul_f32 v[32:33], v[100:101], v[28:29] op_sel_hi:[1,0]
    v_pk_mul_f32 v[34:35], v[102:103], v[28:29] op_sel_hi:[1,0]
    v_exp_f32 v32, v32
    v_exp_f32 v33, v33
    v_exp_f32 v34, v34
    v_exp_f32 v35, v35
    v_pk_mul_f32 v[100:101], v[100:101], v[164:165]
    v_pk_mul_f32 v[102:103], v[102:103], v[166:167]
    v_pk_add_f32 v[32:33], v[32:33], 1.0 op_sel_hi:[1,0]
    v_pk_add_f32 v[34:35], v[34:35], 1.0 op_sel_hi:[1,0]
    v_rcp_f32 v32, v32
    v_rcp_f32 v33, v33
    v_rcp_f32 v34, v34
    v_rcp_f32 v35, v35
    v_lshlrev_b32 v164, 16, v226
    v_and_b32 v165, 0xffff0000, v226
    v_lshlrev_b32 v166, 16, v227
    v_and_b32 v167, 0xffff0000, v227
    v_pk_fma_f32 v[164:165], v[100:101], v[32:33], v[164:165]
    v_pk_fma_f32 v[166:167], v[102:103], v[34:35], v[166:167]
    s_mov_b32 s3, 0
    s_waitcnt lgkmcnt(3)
    buffer_store_dwordx4 v[48:51], v18, s[16:19], s3 offen sc1
    s_mov_b32 s3, 16384
    s_waitcnt lgkmcnt(2)
    buffer_store_dwordx4 v[52:55], v18, s[16:19], s3 offen sc1
    s_mov_b32 s3, 32768
    s_waitcnt lgkmcnt(1)
    buffer_store_dwordx4 v[56:59], v18, s[16:19], s3 offen sc1
    s_mov_b32 s3, 49152
    s_waitcnt lgkmcnt(0)
    buffer_store_dwordx4 v[60:63], v18, s[16:19], s3 offen sc1
    ds_write_b128 v10, v[164:167] offset:4096
    v_lshlrev_b32 v36, 16, v74
    v_and_b32 v37, 0xffff0000, v74
    v_lshlrev_b32 v38, 16, v75
    v_and_b32 v39, 0xffff0000, v75
    v_pk_add_f32 v[116:117], v[116:117], v[36:37]
    v_pk_add_f32 v[118:119], v[118:119], v[38:39]
    v_pk_mul_f32 v[36:37], v[116:117], v[28:29] op_sel_hi:[1,0]
    v_pk_mul_f32 v[38:39], v[118:119], v[28:29] op_sel_hi:[1,0]
    v_exp_f32 v36, v36
    v_exp_f32 v37, v37
    v_exp_f32 v38, v38
    v_exp_f32 v39, v39
    v_pk_mul_f32 v[116:117], v[116:117], v[180:181]
    v_pk_mul_f32 v[118:119], v[118:119], v[182:183]
    v_pk_add_f32 v[36:37], v[36:37], 1.0 op_sel_hi:[1,0]
    v_pk_add_f32 v[38:39], v[38:39], 1.0 op_sel_hi:[1,0]
    v_rcp_f32 v36, v36
    v_rcp_f32 v37, v37
    v_rcp_f32 v38, v38
    v_rcp_f32 v39, v39
    v_lshlrev_b32 v180, 16, v234
    v_and_b32 v181, 0xffff0000, v234
    v_lshlrev_b32 v182, 16, v235
    v_and_b32 v183, 0xffff0000, v235
    v_pk_fma_f32 v[180:181], v[116:117], v[36:37], v[180:181]
    v_pk_fma_f32 v[182:183], v[118:119], v[38:39], v[182:183]
    ds_write_b128 v11, v[180:183] offset:4096
    v_lshlrev_b32 v40, 16, v82
    v_and_b32 v41, 0xffff0000, v82
    v_lshlrev_b32 v42, 16, v83
    v_and_b32 v43, 0xffff0000, v83
    v_pk_add_f32 v[132:133], v[132:133], v[40:41]
    v_pk_add_f32 v[134:135], v[134:135], v[42:43]
    v_pk_mul_f32 v[40:41], v[132:133], v[28:29] op_sel_hi:[1,0]
    v_pk_mul_f32 v[42:43], v[134:135], v[28:29] op_sel_hi:[1,0]
    v_exp_f32 v40, v40
    v_exp_f32 v41, v41
    v_exp_f32 v42, v42
    v_exp_f32 v43, v43
    v_pk_mul_f32 v[132:133], v[132:133], v[196:197]
    v_pk_mul_f32 v[134:135], v[134:135], v[198:199]
    v_pk_add_f32 v[40:41], v[40:41], 1.0 op_sel_hi:[1,0]
    v_pk_add_f32 v[42:43], v[42:43], 1.0 op_sel_hi:[1,0]
    v_rcp_f32 v40, v40
    v_rcp_f32 v41, v41
    v_rcp_f32 v42, v42
    v_rcp_f32 v43, v43
    v_lshlrev_b32 v196, 16, v242
    v_and_b32 v197, 0xffff0000, v242
    v_lshlrev_b32 v198, 16, v243
    v_and_b32 v199, 0xffff0000, v243
    v_pk_fma_f32 v[196:197], v[132:133], v[40:41], v[196:197]
    v_pk_fma_f32 v[198:199], v[134:135], v[42:43], v[198:199]
    ds_write_b128 v12, v[196:199] offset:4096
    v_lshlrev_b32 v44, 16, v90
    v_and_b32 v45, 0xffff0000, v90
    v_lshlrev_b32 v46, 16, v91
    v_and_b32 v47, 0xffff0000, v91
    v_pk_add_f32 v[148:149], v[148:149], v[44:45]
    v_pk_add_f32 v[150:151], v[150:151], v[46:47]
    v_pk_mul_f32 v[44:45], v[148:149], v[28:29] op_sel_hi:[1,0]
    v_pk_mul_f32 v[46:47], v[150:151], v[28:29] op_sel_hi:[1,0]
    v_exp_f32 v44, v44
    v_exp_f32 v45, v45
    v_exp_f32 v46, v46
    v_exp_f32 v47, v47
    v_pk_mul_f32 v[148:149], v[148:149], v[212:213]
    v_pk_mul_f32 v[150:151], v[150:151], v[214:215]
    v_pk_add_f32 v[44:45], v[44:45], 1.0 op_sel_hi:[1,0]
    v_pk_add_f32 v[46:47], v[46:47], 1.0 op_sel_hi:[1,0]
    v_rcp_f32 v44, v44
    v_rcp_f32 v45, v45
    v_rcp_f32 v46, v46
    v_rcp_f32 v47, v47
    v_lshlrev_b32 v212, 16, v250
    v_and_b32 v213, 0xffff0000, v250
    v_lshlrev_b32 v214, 16, v251
    v_and_b32 v215, 0xffff0000, v251
    v_pk_fma_f32 v[212:213], v[148:149], v[44:45], v[212:213]
    v_pk_fma_f32 v[214:215], v[150:151], v[46:47], v[214:215]
    ds_write_b128 v13, v[212:215] offset:4096
    ds_read_b128 v[48:51], v14 offset:4096
    ds_read_b128 v[52:55], v15 offset:5120
    ds_read_b128 v[56:59], v16 offset:6144
    ds_read_b128 v[60:63], v17 offset:7168
    v_lshlrev_b32 v32, 16, v68
    v_and_b32 v33, 0xffff0000, v68
    v_lshlrev_b32 v34, 16, v69
    v_and_b32 v35, 0xffff0000, v69
    v_pk_add_f32 v[104:105], v[104:105], v[32:33]
    v_pk_add_f32 v[106:107], v[106:107], v[34:35]
    v_pk_mul_f32 v[32:33], v[104:105], v[28:29] op_sel_hi:[1,0]
    v_pk_mul_f32 v[34:35], v[106:107], v[28:29] op_sel_hi:[1,0]
    v_exp_f32 v32, v32
    v_exp_f32 v33, v33
    v_exp_f32 v34, v34
    v_exp_f32 v35, v35
    v_pk_mul_f32 v[104:105], v[104:105], v[168:169]
    v_pk_mul_f32 v[106:107], v[106:107], v[170:171]
    v_pk_add_f32 v[32:33], v[32:33], 1.0 op_sel_hi:[1,0]
    v_pk_add_f32 v[34:35], v[34:35], 1.0 op_sel_hi:[1,0]
    v_rcp_f32 v32, v32
    v_rcp_f32 v33, v33
    v_rcp_f32 v34, v34
    v_rcp_f32 v35, v35
    v_lshlrev_b32 v168, 16, v228
    v_and_b32 v169, 0xffff0000, v228
    v_lshlrev_b32 v170, 16, v229
    v_and_b32 v171, 0xffff0000, v229
    v_pk_fma_f32 v[168:169], v[104:105], v[32:33], v[168:169]
    v_pk_fma_f32 v[170:171], v[106:107], v[34:35], v[170:171]
    s_mov_b32 s3, 65536
    s_waitcnt lgkmcnt(3)
    buffer_store_dwordx4 v[48:51], v18, s[16:19], s3 offen sc1
    s_mov_b32 s3, 81920
    s_waitcnt lgkmcnt(2)
    buffer_store_dwordx4 v[52:55], v18, s[16:19], s3 offen sc1
    s_mov_b32 s3, 98304
    s_waitcnt lgkmcnt(1)
    buffer_store_dwordx4 v[56:59], v18, s[16:19], s3 offen sc1
    s_mov_b32 s3, 114688
    s_waitcnt lgkmcnt(0)
    buffer_store_dwordx4 v[60:63], v18, s[16:19], s3 offen sc1
    ds_write_b128 v10, v[168:171] offset:8192
    v_lshlrev_b32 v36, 16, v76
    v_and_b32 v37, 0xffff0000, v76
    v_lshlrev_b32 v38, 16, v77
    v_and_b32 v39, 0xffff0000, v77
    v_pk_add_f32 v[120:121], v[120:121], v[36:37]
    v_pk_add_f32 v[122:123], v[122:123], v[38:39]
    v_pk_mul_f32 v[36:37], v[120:121], v[28:29] op_sel_hi:[1,0]
    v_pk_mul_f32 v[38:39], v[122:123], v[28:29] op_sel_hi:[1,0]
    v_exp_f32 v36, v36
    v_exp_f32 v37, v37
    v_exp_f32 v38, v38
    v_exp_f32 v39, v39
    v_pk_mul_f32 v[120:121], v[120:121], v[184:185]
    v_pk_mul_f32 v[122:123], v[122:123], v[186:187]
    v_pk_add_f32 v[36:37], v[36:37], 1.0 op_sel_hi:[1,0]
    v_pk_add_f32 v[38:39], v[38:39], 1.0 op_sel_hi:[1,0]
    v_rcp_f32 v36, v36
    v_rcp_f32 v37, v37
    v_rcp_f32 v38, v38
    v_rcp_f32 v39, v39
    v_lshlrev_b32 v184, 16, v236
    v_and_b32 v185, 0xffff0000, v236
    v_lshlrev_b32 v186, 16, v237
    v_and_b32 v187, 0xffff0000, v237
    v_pk_fma_f32 v[184:185], v[120:121], v[36:37], v[184:185]
    v_pk_fma_f32 v[186:187], v[122:123], v[38:39], v[186:187]
    ds_write_b128 v11, v[184:187] offset:8192
    v_lshlrev_b32 v40, 16, v84
    v_and_b32 v41, 0xffff0000, v84
    v_lshlrev_b32 v42, 16, v85
    v_and_b32 v43, 0xffff0000, v85
    v_pk_add_f32 v[136:137], v[136:137], v[40:41]
    v_pk_add_f32 v[138:139], v[138:139], v[42:43]
    v_pk_mul_f32 v[40:41], v[136:137], v[28:29] op_sel_hi:[1,0]
    v_pk_mul_f32 v[42:43], v[138:139], v[28:29] op_sel_hi:[1,0]
    v_exp_f32 v40, v40
    v_exp_f32 v41, v41
    v_exp_f32 v42, v42
    v_exp_f32 v43, v43
    v_pk_mul_f32 v[136:137], v[136:137], v[200:201]
    v_pk_mul_f32 v[138:139], v[138:139], v[202:203]
    v_pk_add_f32 v[40:41], v[40:41], 1.0 op_sel_hi:[1,0]
    v_pk_add_f32 v[42:43], v[42:43], 1.0 op_sel_hi:[1,0]
    v_rcp_f32 v40, v40
    v_rcp_f32 v41, v41
    v_rcp_f32 v42, v42
    v_rcp_f32 v43, v43
    v_lshlrev_b32 v200, 16, v244
    v_and_b32 v201, 0xffff0000, v244
    v_lshlrev_b32 v202, 16, v245
    v_and_b32 v203, 0xffff0000, v245
    v_pk_fma_f32 v[200:201], v[136:137], v[40:41], v[200:201]
    v_pk_fma_f32 v[202:203], v[138:139], v[42:43], v[202:203]
    ds_write_b128 v12, v[200:203] offset:8192
    v_lshlrev_b32 v44, 16, v92
    v_and_b32 v45, 0xffff0000, v92
    v_lshlrev_b32 v46, 16, v93
    v_and_b32 v47, 0xffff0000, v93
    v_pk_add_f32 v[152:153], v[152:153], v[44:45]
    v_pk_add_f32 v[154:155], v[154:155], v[46:47]
    v_pk_mul_f32 v[44:45], v[152:153], v[28:29] op_sel_hi:[1,0]
    v_pk_mul_f32 v[46:47], v[154:155], v[28:29] op_sel_hi:[1,0]
    v_exp_f32 v44, v44
    v_exp_f32 v45, v45
    v_exp_f32 v46, v46
    v_exp_f32 v47, v47
    v_pk_mul_f32 v[152:153], v[152:153], v[216:217]
    v_pk_mul_f32 v[154:155], v[154:155], v[218:219]
    v_pk_add_f32 v[44:45], v[44:45], 1.0 op_sel_hi:[1,0]
    v_pk_add_f32 v[46:47], v[46:47], 1.0 op_sel_hi:[1,0]
    v_rcp_f32 v44, v44
    v_rcp_f32 v45, v45
    v_rcp_f32 v46, v46
    v_rcp_f32 v47, v47
    v_lshlrev_b32 v216, 16, v252
    v_and_b32 v217, 0xffff0000, v252
    v_lshlrev_b32 v218, 16, v253
    v_and_b32 v219, 0xffff0000, v253
    v_pk_fma_f32 v[216:217], v[152:153], v[44:45], v[216:217]
    v_pk_fma_f32 v[218:219], v[154:155], v[46:47], v[218:219]
    ds_write_b128 v13, v[216:219] offset:8192
    ds_read_b128 v[48:51], v14 offset:8192
    ds_read_b128 v[52:55], v15 offset:9216
    ds_read_b128 v[56:59], v16 offset:10240
    ds_read_b128 v[60:63], v17 offset:11264
    v_lshlrev_b32 v32, 16, v70
    v_and_b32 v33, 0xffff0000, v70
    v_lshlrev_b32 v34, 16, v71
    v_and_b32 v35, 0xffff0000, v71
    v_pk_add_f32 v[108:109], v[108:109], v[32:33]
    v_pk_add_f32 v[110:111], v[110:111], v[34:35]
    v_pk_mul_f32 v[32:33], v[108:109], v[28:29] op_sel_hi:[1,0]
    v_pk_mul_f32 v[34:35], v[110:111], v[28:29] op_sel_hi:[1,0]
    v_exp_f32 v32, v32
    v_exp_f32 v33, v33
    v_exp_f32 v34, v34
    v_exp_f32 v35, v35
    v_pk_mul_f32 v[108:109], v[108:109], v[172:173]
    v_pk_mul_f32 v[110:111], v[110:111], v[174:175]
    v_pk_add_f32 v[32:33], v[32:33], 1.0 op_sel_hi:[1,0]
    v_pk_add_f32 v[34:35], v[34:35], 1.0 op_sel_hi:[1,0]
    v_rcp_f32 v32, v32
    v_rcp_f32 v33, v33
    v_rcp_f32 v34, v34
    v_rcp_f32 v35, v35
    v_lshlrev_b32 v172, 16, v230
    v_and_b32 v173, 0xffff0000, v230
    v_lshlrev_b32 v174, 16, v231
    v_and_b32 v175, 0xffff0000, v231
    v_pk_fma_f32 v[172:173], v[108:109], v[32:33], v[172:173]
    v_pk_fma_f32 v[174:175], v[110:111], v[34:35], v[174:175]
    s_mov_b32 s3, 131072
    s_waitcnt lgkmcnt(3)
    buffer_store_dwordx4 v[48:51], v18, s[16:19], s3 offen sc1
    s_mov_b32 s3, 147456
    s_waitcnt lgkmcnt(2)
    buffer_store_dwordx4 v[52:55], v18, s[16:19], s3 offen sc1
    s_mov_b32 s3, 163840
    s_waitcnt lgkmcnt(1)
    buffer_store_dwordx4 v[56:59], v18, s[16:19], s3 offen sc1
    s_mov_b32 s3, 180224
    s_waitcnt lgkmcnt(0)
    buffer_store_dwordx4 v[60:63], v18, s[16:19], s3 offen sc1
    ds_write_b128 v10, v[172:175] offset:12288
    v_lshlrev_b32 v36, 16, v78
    v_and_b32 v37, 0xffff0000, v78
    v_lshlrev_b32 v38, 16, v79
    v_and_b32 v39, 0xffff0000, v79
    v_pk_add_f32 v[124:125], v[124:125], v[36:37]
    v_pk_add_f32 v[126:127], v[126:127], v[38:39]
    v_pk_mul_f32 v[36:37], v[124:125], v[28:29] op_sel_hi:[1,0]
    v_pk_mul_f32 v[38:39], v[126:127], v[28:29] op_sel_hi:[1,0]
    v_exp_f32 v36, v36
    v_exp_f32 v37, v37
    v_exp_f32 v38, v38
    v_exp_f32 v39, v39
    v_pk_mul_f32 v[124:125], v[124:125], v[188:189]
    v_pk_mul_f32 v[126:127], v[126:127], v[190:191]
    v_pk_add_f32 v[36:37], v[36:37], 1.0 op_sel_hi:[1,0]
    v_pk_add_f32 v[38:39], v[38:39], 1.0 op_sel_hi:[1,0]
    v_rcp_f32 v36, v36
    v_rcp_f32 v37, v37
    v_rcp_f32 v38, v38
    v_rcp_f32 v39, v39
    v_lshlrev_b32 v188, 16, v238
    v_and_b32 v189, 0xffff0000, v238
    v_lshlrev_b32 v190, 16, v239
    v_and_b32 v191, 0xffff0000, v239
    v_pk_fma_f32 v[188:189], v[124:125], v[36:37], v[188:189]
    v_pk_fma_f32 v[190:191], v[126:127], v[38:39], v[190:191]
    ds_write_b128 v11, v[188:191] offset:12288
    v_lshlrev_b32 v40, 16, v86
    v_and_b32 v41, 0xffff0000, v86
    v_lshlrev_b32 v42, 16, v87
    v_and_b32 v43, 0xffff0000, v87
    v_pk_add_f32 v[140:141], v[140:141], v[40:41]
    v_pk_add_f32 v[142:143], v[142:143], v[42:43]
    v_pk_mul_f32 v[40:41], v[140:141], v[28:29] op_sel_hi:[1,0]
    v_pk_mul_f32 v[42:43], v[142:143], v[28:29] op_sel_hi:[1,0]
    v_exp_f32 v40, v40
    v_exp_f32 v41, v41
    v_exp_f32 v42, v42
    v_exp_f32 v43, v43
    v_pk_mul_f32 v[140:141], v[140:141], v[204:205]
    v_pk_mul_f32 v[142:143], v[142:143], v[206:207]
    v_pk_add_f32 v[40:41], v[40:41], 1.0 op_sel_hi:[1,0]
    v_pk_add_f32 v[42:43], v[42:43], 1.0 op_sel_hi:[1,0]
    v_rcp_f32 v40, v40
    v_rcp_f32 v41, v41
    v_rcp_f32 v42, v42
    v_rcp_f32 v43, v43
    v_lshlrev_b32 v204, 16, v246
    v_and_b32 v205, 0xffff0000, v246
    v_lshlrev_b32 v206, 16, v247
    v_and_b32 v207, 0xffff0000, v247
    v_pk_fma_f32 v[204:205], v[140:141], v[40:41], v[204:205]
    v_pk_fma_f32 v[206:207], v[142:143], v[42:43], v[206:207]
    ds_write_b128 v12, v[204:207] offset:12288
    v_lshlrev_b32 v44, 16, v94
    v_and_b32 v45, 0xffff0000, v94
    v_lshlrev_b32 v46, 16, v95
    v_and_b32 v47, 0xffff0000, v95
    v_pk_add_f32 v[156:157], v[156:157], v[44:45]
    v_pk_add_f32 v[158:159], v[158:159], v[46:47]
    v_pk_mul_f32 v[44:45], v[156:157], v[28:29] op_sel_hi:[1,0]
    v_pk_mul_f32 v[46:47], v[158:159], v[28:29] op_sel_hi:[1,0]
    v_exp_f32 v44, v44
    v_exp_f32 v45, v45
    v_exp_f32 v46, v46
    v_exp_f32 v47, v47
    v_pk_mul_f32 v[156:157], v[156:157], v[220:221]
    v_pk_mul_f32 v[158:159], v[158:159], v[222:223]
    v_pk_add_f32 v[44:45], v[44:45], 1.0 op_sel_hi:[1,0]
    v_pk_add_f32 v[46:47], v[46:47], 1.0 op_sel_hi:[1,0]
    v_rcp_f32 v44, v44
    v_rcp_f32 v45, v45
    v_rcp_f32 v46, v46
    v_rcp_f32 v47, v47
    v_lshlrev_b32 v220, 16, v254
    v_and_b32 v221, 0xffff0000, v254
    v_lshlrev_b32 v222, 16, v255
    v_and_b32 v223, 0xffff0000, v255
    v_pk_fma_f32 v[220:221], v[156:157], v[44:45], v[220:221]
    v_pk_fma_f32 v[222:223], v[158:159], v[46:47], v[222:223]
    ds_write_b128 v13, v[220:223] offset:12288
    ds_read_b128 v[48:51], v14 offset:12288
    ds_read_b128 v[52:55], v15 offset:13312
    ds_read_b128 v[56:59], v16 offset:14336
    ds_read_b128 v[60:63], v17 offset:15360
    s_mov_b32 s3, 196608
    s_waitcnt lgkmcnt(3)
    buffer_store_dwordx4 v[48:51], v18, s[16:19], s3 offen sc1
    s_mov_b32 s3, 212992
    s_waitcnt lgkmcnt(2)
    buffer_store_dwordx4 v[52:55], v18, s[16:19], s3 offen sc1
    s_mov_b32 s3, 229376
    s_waitcnt lgkmcnt(1)
    buffer_store_dwordx4 v[56:59], v18, s[16:19], s3 offen sc1
    s_mov_b32 s3, 245760
    s_waitcnt lgkmcnt(0)
    buffer_store_dwordx4 v[60:63], v18, s[16:19], s3 offen sc1
    s_branch L3_end
L3_loader:
    s_sub_u32 s26, s26, 4
    s_lshl_b32 s64, s26, 12
    v_lshlrev_b32 v4, 4, v2
    v_add_u32 v3, s64, v4
    v_mov_b32 v22, 0
    v_lshrrev_b32 v5, 4, v2
    v_or_b32 v6, 0, v5
    v_bfe_u32 v7, v2, 1, 3
    v_xor_b32 v7, v7, v6
    v_lshlrev_b32 v7, 5, v7
    v_and_b32 v8, 1, v2
    v_lshl_add_u32 v7, v8, 4, v7
    s_lshl_b32 s3, s26, 4
    s_add_u32 s3, s3, 0
    v_add_u32 v9, s3, v5
    v_lshl_add_u32 v14, v9, 11, v7
    v_or_b32 v6, 0, v5
    v_bfe_u32 v7, v2, 1, 3
    v_xor_b32 v7, v7, v6
    v_lshlrev_b32 v7, 5, v7
    v_and_b32 v8, 1, v2
    v_lshl_add_u32 v7, v8, 4, v7
    s_lshl_b32 s3, s26, 4
    s_add_u32 s3, s3, 4
    v_add_u32 v9, s3, v5
    v_lshl_add_u32 v15, v9, 11, v7
    v_subrev_u32 v15, 1024, v15
    v_or_b32 v6, 4, v5
    v_bfe_u32 v7, v2, 1, 3
    v_xor_b32 v7, v7, v6
    v_lshlrev_b32 v7, 5, v7
    v_and_b32 v8, 1, v2
    v_lshl_add_u32 v7, v8, 4, v7
    s_lshl_b32 s3, s26, 4
    s_add_u32 s3, s3, 8
    v_add_u32 v9, s3, v5
    v_lshl_add_u32 v16, v9, 11, v7
    v_subrev_u32 v16, 2048, v16
    v_or_b32 v6, 4, v5
    v_bfe_u32 v7, v2, 1, 3
    v_xor_b32 v7, v7, v6
    v_lshlrev_b32 v7, 5, v7
    v_and_b32 v8, 1, v2
    v_lshl_add_u32 v7, v8, 4, v7
    s_lshl_b32 s3, s26, 4
    s_add_u32 s3, s3, 12
    v_add_u32 v9, s3, v5
    v_lshl_add_u32 v17, v9, 11, v7
    v_subrev_u32 v17, 3072, v17
    v_and_b32 v6, 15, v2
    v_add_u32 v7, 0, v5
    v_xor_b32 v8, v6, v7
    v_lshlrev_b32 v8, 4, v8
    v_lshl_add_u32 v24, v7, 11, v8
    v_add_u32 v7, 4, v5
    v_xor_b32 v8, v6, v7
    v_lshlrev_b32 v8, 4, v8
    v_lshl_add_u32 v25, v7, 11, v8
    v_subrev_u32 v25, 1024, v25
    v_add_u32 v7, 8, v5
    v_xor_b32 v8, v6, v7
    v_lshlrev_b32 v8, 4, v8
    v_lshl_add_u32 v26, v7, 11, v8
    v_subrev_u32 v26, 2048, v26
    v_add_u32 v7, 12, v5
    v_xor_b32 v8, v6, v7
    v_lshlrev_b32 v8, 4, v8
    v_lshl_add_u32 v27, v7, 11, v8
    v_subrev_u32 v27, 3072, v27
    v_lshrrev_b32 v5, 3, v2
    v_and_b32 v6, 7, v2
    v_xor_b32 v6, v6, v5
    v_lshlrev_b32 v6, 4, v6
    s_lshl_b32 s3, s26, 5
    s_add_u32 s3, s3, 0
    v_add_u32 v9, s3, v5
    v_lshl_add_u32 v10, v9, 11, v6
    s_lshl_b32 s3, s26, 5
    s_add_u32 s3, s3, 8
    v_add_u32 v9, s3, v5
    v_lshl_add_u32 v11, v9, 11, v6
    v_subrev_u32 v11, 1024, v11
    s_lshl_b32 s3, s26, 5
    s_add_u32 s3, s3, 16
    v_add_u32 v9, s3, v5
    v_lshl_add_u32 v12, v9, 11, v6
    v_subrev_u32 v12, 2048, v12
    s_lshl_b32 s3, s26, 5
    s_add_u32 s3, s3, 24
    v_add_u32 v9, s3, v5
    v_lshl_add_u32 v13, v9, 11, v6
    v_subrev_u32 v13, 3072, v13
    s_waitcnt lgkmcnt(0)
    s_mov_b32 s8, s62
    s_and_b32 s9, s63, 0xffff
    s_mov_b32 s10, 67108864
    s_mov_b32 s11, 0x20000
    s_mov_b32 s16, s32
    s_and_b32 s17, s33, 0xffff
    s_mov_b32 s18, 4194304
    s_mov_b32 s19, 0x20000
    s_mov_b32 s15, 0x20000
    s_mov_b32 s69, 0
    s_and_b32 s27, s6, 1
    s_bfe_u32 s28, s6, 0x20001
    s_lshr_b32 s29, s6, 3
    s_and_b32 s30, s28, 1
    s_lshl_b32 s30, s30, 3
    s_and_b32 s31, s29, 7
    s_add_u32 s30, s30, s31
    s_lshr_b32 s31, s28, 1
    s_lshl_b32 s31, s31, 2
    s_lshr_b32 s3, s29, 3
    s_add_u32 s31, s31, s3
    s_lshl_b32 s66, s30, 14
    s_add_u32 s66, s66, 8388608
    s_cmp_lg_u32 s27, 0
    s_cbranch_scc1 L3_lB
    s_mov_b32 s12, s42
    s_and_b32 s13, s43, 0xffff
    s_mov_b32 s14, 2097152
    s_lshl_b32 s67, s31, 18
    s_mov_b32 s68, 128
    s_mov_b32 s65, 0
    s_mov_b32 s24, 44
    s_branch L3_lgo
L3_lB:
    s_mov_b32 s12, s56
    s_and_b32 s13, s57, 0xffff
    s_mov_b32 s14, 7340032
    s_lshl_b32 s67, s31, 8
    s_mov_b32 s68, 131072
    v_mov_b32 v10, v14
    v_mov_b32 v11, v15
    v_mov_b32 v12, v16
    v_mov_b32 v13, v17
    s_add_u32 s67, s67, 2097152
    s_add_u32 s66, s66, 12582912
    s_mov_b32 s65, 1000
    s_mov_b32 s24, 36
L3_lgo:
    s_lshl_b32 s73, s30, 18
    s_lshl_b32 s3, s26, 16
    s_add_u32 s73, s73, s3
    s_lshl_b32 s3, s31, 8
    s_add_u32 s73, s73, s3
    s_lshl_b32 s74, s26, 13
    s_add_u32 s74, s74, 131072
    s_cmp_lg_u32 s27, 0
    s_cbranch_scc1 L3_nx
    s_add_u32 m0, s74, 0
    s_nop 0
    buffer_load_dwordx4 v24, s[16:19], s73 offen offset:0 lds
    buffer_load_dwordx4 v25, s[16:19], s73 offen offset:1024 lds
    buffer_load_dwordx4 v26, s[16:19], s73 offen offset:2048 lds
    buffer_load_dwordx4 v27, s[16:19], s73 offen offset:3072 lds
    s_add_u32 s73, s73, 32768
    s_add_u32 m0, s74, 4096
    s_nop 0
    buffer_load_dwordx4 v24, s[16:19], s73 offen offset:0 lds
    buffer_load_dwordx4 v25, s[16:19], s73 offen offset:1024 lds
    buffer_load_dwordx4 v26, s[16:19], s73 offen offset:2048 lds
    buffer_load_dwordx4 v27, s[16:19], s73 offen offset:3072 lds
    s_add_u32 s73, s73, 32768
L3_nx:
    s_add_u32 m0, s64, 16384
    s_nop 0
    buffer_load_dwordx4 v10, s[12:15], s67 offen offset:0 lds
    buffer_load_dwordx4 v11, s[12:15], s67 offen offset:1024 lds
    buffer_load_dwordx4 v12, s[12:15], s67 offen offset:2048 lds
    buffer_load_dwordx4 v13, s[12:15], s67 offen offset:3072 lds
    s_add_u32 s67, s67, s68
    s_add_u32 m0, s64, 49152
    s_nop 0
    buffer_load_dwordx4 v10, s[12:15], s67 offen offset:0 lds
    buffer_load_dwordx4 v11, s[12:15], s67 offen offset:1024 lds
    buffer_load_dwordx4 v12, s[12:15], s67 offen offset:2048 lds
    buffer_load_dwordx4 v13, s[12:15], s67 offen offset:3072 lds
    s_add_u32 s67, s67, s68
    s_cmp_lg_u32 s27, 0
    s_cbranch_scc1 L3_nx2
    s_waitcnt vmcnt(8)
    s_barrier
L3_nx2:
    s_add_u32 m0, s64, 81920
    s_nop 0
    buffer_load_dwordx4 v10, s[12:15], s67 offen offset:0 lds
    buffer_load_dwordx4 v11, s[12:15], s67 offen offset:1024 lds
    buffer_load_dwordx4 v12, s[12:15], s67 offen offset:2048 lds
    buffer_load_dwordx4 v13, s[12:15], s67 offen offset:3072 lds
    s_add_u32 s67, s67, s68
    s_add_u32 m0, s64, 114688
    s_nop 0
    buffer_load_dwordx4 v10, s[12:15], s67 offen offset:0 lds
    buffer_load_dwordx4 v11, s[12:15], s67 offen offset:1024 lds
    buffer_load_dwordx4 v12, s[12:15], s67 offen offset:2048 lds
    buffer_load_dwordx4 v13, s[12:15], s67 offen offset:3072 lds
    s_add_u32 s67, s67, s68
    s_lshl_b32 s4, s30, 3
    s_add_u32 s4, s4, s31
    s_lshl_b32 s70, s4, 16
    s_lshl_b32 s3, s26, 14
    s_add_u32 s70, s70, s3
    s_add_u32 s70, s70, 33554432
    s_lshl_b32 s71, s4, 6
    s_lshl_b32 s3, s26, 4
    s_add_u32 s71, s71, s3
    s_add_u32 s71, s71, 4390912
    s_lshl_b32 s72, s26, 13
    s_add_u32 s72, s72, 0
    s_cmp_lg_u32 s26, 0
    s_cbranch_scc1 L3_agot
    s_and_b32 s3, s30, 1
    s_lshl_b32 s3, s3, 3
    s_add_u32 s3, s3, s31
    s_lshl_b32 s3, s3, 1
    s_add_u32 s3, s3, s27
    s_and_b32 s3, s3, 7
    s_lshl_b32 s3, s3, 7
    s_lshr_b32 s29, s30, 1
    s_lshl_b32 s29, s29, 12
    s_add_u32 s29, s29, s3
    s_add_u32 s29, s29, 4456448
    s_mov_b32 s5, 0
L3_apoll:
    buffer_load_dword v23, off, s[8:11], s29 sc1
    s_waitcnt vmcnt(0)
    v_readfirstlane_b32 s3, v23
    s_nop 3
    s_cmp_ge_u32 s3, 32
    s_cbranch_scc1 L3_agot
    s_sleep 8
    s_add_u32 s5, s5, 1
    s_cmp_lt_u32 s5, 0x10000
    s_cbranch_scc1 L3_apoll
L3_agot:
    s_barrier
    s_add_u32 m0, s64, 0
    s_nop 0
    buffer_load_dwordx4 v3, s[8:11], s66 offen offset:0 sc1 lds
    buffer_load_dwordx4 v3, s[8:11], s66 offen offset:1024 sc1 lds
    buffer_load_dwordx4 v3, s[8:11], s66 offen offset:2048 sc1 lds
    buffer_load_dwordx4 v3, s[8:11], s66 offen offset:3072 sc1 lds
    s_add_u32 s66, s66, 262144
    s_add_u32 s65, s65, 1
    s_add_u32 m0, s64, 32768
    s_nop 0
    buffer_load_dwordx4 v3, s[8:11], s66 offen offset:0 sc1 lds
    buffer_load_dwordx4 v3, s[8:11], s66 offen offset:1024 sc1 lds
    buffer_load_dwordx4 v3, s[8:11], s66 offen offset:2048 sc1 lds
    buffer_load_dwordx4 v3, s[8:11], s66 offen offset:3072 sc1 lds
    s_add_u32 s66, s66, 262144
    s_add_u32 s65, s65, 1
    s_add_u32 m0, s64, 65536
    s_nop 0
    buffer_load_dwordx4 v3, s[8:11], s66 offen offset:0 sc1 lds
    buffer_load_dwordx4 v3, s[8:11], s66 offen offset:1024 sc1 lds
    buffer_load_dwordx4 v3, s[8:11], s66 offen offset:2048 sc1 lds
    buffer_load_dwordx4 v3, s[8:11], s66 offen offset:3072 sc1 lds
    s_add_u32 s66, s66, 262144
    s_add_u32 s65, s65, 1
    s_add_u32 m0, s64, 98304
    s_nop 0
    buffer_load_dwordx4 v3, s[8:11], s66 offen offset:0 sc1 lds
    buffer_load_dwordx4 v3, s[8:11], s66 offen offset:1024 sc1 lds
    buffer_load_dwordx4 v3, s[8:11], s66 offen offset:2048 sc1 lds
    buffer_load_dwordx4 v3, s[8:11], s66 offen offset:3072 sc1 lds
    s_add_u32 s66, s66, 262144
    s_add_u32 s65, s65, 1
    s_waitcnt vmcnt(12)
    s_barrier
    s_waitcnt vmcnt(8)
    s_barrier
    s_add_u32 m0, s64, s69
    s_nop 0
    buffer_load_dwordx4 v3, s[8:11], s66 offen offset:0 sc1 lds
    buffer_load_dwordx4 v3, s[8:11], s66 offen offset:1024 sc1 lds
    buffer_load_dwordx4 v3, s[8:11], s66 offen offset:2048 sc1 lds
    buffer_load_dwordx4 v3, s[8:11], s66 offen offset:3072 sc1 lds
    s_add_u32 m0, m0, 16384
    s_add_u32 s66, s66, 262144
    buffer_load_dwordx4 v10, s[12:15], s67 offen offset:0 lds
    buffer_load_dwordx4 v11, s[12:15], s67 offen offset:1024 lds
    buffer_load_dwordx4 v12, s[12:15], s67 offen offset:2048 lds
    buffer_load_dwordx4 v13, s[12:15], s67 offen offset:3072 lds
    s_add_u32 s67, s67, s68
    s_add_u32 s69, s69, 32768
    s_and_b32 s69, s69, 0x1ffff
    s_add_u32 s65, s65, 1
    s_waitcnt vmcnt(12)
    s_barrier
    s_add_u32 m0, s64, s69
    s_nop 0
    buffer_load_dwordx4 v3, s[8:11], s66 offen offset:0 sc1 lds
    buffer_load_dwordx4 v3, s[8:11], s66 offen offset:1024 sc1 lds
    buffer_load_dwordx4 v3, s[8:11], s66 offen offset:2048 sc1 lds
    buffer_load_dwordx4 v3, s[8:11], s66 offen offset:3072 sc1 lds
    s_add_u32 m0, m0, 16384
    s_add_u32 s66, s66, 262144
    buffer_load_dwordx4 v10, s[12:15], s67 offen offset:0 lds
    buffer_load_dwordx4 v11, s[12:15], s67 offen offset:1024 lds
    buffer_load_dwordx4 v12, s[12:15], s67 offen offset:2048 lds
    buffer_load_dwordx4 v13, s[12:15], s67 offen offset:3072 lds
    s_add_u32 s67, s67, s68
    s_add_u32 s69, s69, 32768
    s_and_b32 s69, s69, 0x1ffff
    s_add_u32 s65, s65, 1
    s_sub_u32 s24, s24, 2
.p2align 4
L3_lloop:
    s_cmp_eq_u32 s65, 16
    s_cbranch_scc0 L3_ln1
    s_mov_b32 s12, s44
    s_and_b32 s13, s45, 0xffff
    s_lshl_b32 s67, s31, 18
L3_ln1:
    s_cmp_eq_u32 s65, 32
    s_cbranch_scc0 L3_ln2
    s_mov_b32 s12, s56
    s_and_b32 s13, s57, 0xffff
    s_mov_b32 s14, 7340032
    s_lshl_b32 s67, s31, 8
    s_mov_b32 s68, 131072
    v_mov_b32 v10, v14
    v_mov_b32 v11, v15
    v_mov_b32 v12, v16
    v_mov_b32 v13, v17
L3_ln2:
    s_waitcnt vmcnt(16)
    s_barrier
    s_add_u32 m0, s64, s69
    s_nop 0
    buffer_load_dwordx4 v3, s[8:11], s66 offen offset:0 sc1 lds
    buffer_load_dwordx4 v3, s[8:11], s66 offen offset:1024 sc1 lds
    buffer_load_dwordx4 v3, s[8:11], s66 offen offset:2048 sc1 lds
    buffer_load_dwordx4 v3, s[8:11], s66 offen offset:3072 sc1 lds
    s_add_u32 m0, m0, 16384
    s_add_u32 s66, s66, 262144
    buffer_load_dwordx4 v10, s[12:15], s67 offen offset:0 lds
    buffer_load_dwordx4 v11, s[12:15], s67 offen offset:1024 lds
    buffer_load_dwordx4 v12, s[12:15], s67 offen offset:2048 lds
    buffer_load_dwordx4 v13, s[12:15], s67 offen offset:3072 lds
    s_add_u32 s67, s67, s68
    s_add_u32 s69, s69, 32768
    s_and_b32 s69, s69, 0x1ffff
    s_add_u32 s65, s65, 1
    s_cmp_lg_u32 s24, 20
    s_cbranch_scc1 L3_ncr
    s_cmp_lg_u32 s26, 3
    s_cbranch_scc1 L3_ncr
    s_getpc_b64 s[100:101]
L3_pc3:
    s_sub_u32 s100, s100, L3_pc3-recurrent_scan__ssm_conv_s5__glu_gated_geglu__prompt_kernel
    s_subb_u32 s101, s101, 0
    s_lshr_b32 s3, s6, 3
    s_lshl_b32 s3, s3, 4
    v_and_b32 v30, 15, v2
    v_add_u32 v30, s3, v30
    v_lshlrev_b32 v30, 7, v30
    s_mov_b32 s3, L3_end-recurrent_scan__ssm_conv_s5__glu_gated_geglu__prompt_kernel
    v_min_u32 v30, s3, v30
    global_load_dword v31, v30, s[100:101]
L3_ncr:
    s_sub_u32 s24, s24, 1
    s_cmp_lg_u32 s24, 0
    s_cbranch_scc1 L3_lloop
    s_waitcnt vmcnt(16)
    s_barrier
    s_cmp_eq_u32 s27, 0
    s_cbranch_scc1 L3_ltA
    s_waitcnt vmcnt(8)
    s_barrier
    s_waitcnt vmcnt(0)
    s_barrier
    s_branch L3_end
L3_ltA:
    buffer_load_dword v23, v22, s[8:11], s71 offen sc1
    s_waitcnt vmcnt(9)
    s_barrier
    s_waitcnt vmcnt(0)
    v_readfirstlane_b32 s3, v23
    s_nop 3
    s_cmp_eq_u32 s3, 1
    s_cbranch_scc0 L3_llate
    s_add_u32 m0, s72, 0
    s_nop 0
    buffer_load_dwordx4 v4, s[8:11], s70 offen offset:0 sc1 lds
    buffer_load_dwordx4 v4, s[8:11], s70 offen offset:1024 sc1 lds
    buffer_load_dwordx4 v4, s[8:11], s70 offen offset:2048 sc1 lds
    buffer_load_dwordx4 v4, s[8:11], s70 offen offset:3072 sc1 lds
    s_add_u32 m0, s72, 4096
    s_add_u32 s70, s70, 4096
    buffer_load_dwordx4 v4, s[8:11], s70 offen offset:0 sc1 lds
    buffer_load_dwordx4 v4, s[8:11], s70 offen offset:1024 sc1 lds
    buffer_load_dwordx4 v4, s[8:11], s70 offen offset:2048 sc1 lds
    buffer_load_dwordx4 v4, s[8:11], s70 offen offset:3072 sc1 lds
    s_barrier
    s_branch L3_ldone
L3_llate:
    s_barrier
    s_mov_b32 s5, 0
L3_poll:
    buffer_load_dword v23, v22, s[8:11], s71 offen sc1
    s_waitcnt vmcnt(0)
    v_readfirstlane_b32 s3, v23
    s_nop 3
    s_cmp_eq_u32 s3, 1
    s_cbranch_scc1 L3_got
    s_sleep 1
    s_add_u32 s5, s5, 1
    s_cmp_lt_u32 s5, 0x10000
    s_cbranch_scc1 L3_poll
L3_got:
    s_add_u32 m0, s72, 0
    s_nop 0
    buffer_load_dwordx4 v4, s[8:11], s70 offen offset:0 sc1 lds
    buffer_load_dwordx4 v4, s[8:11], s70 offen offset:1024 sc1 lds
    buffer_load_dwordx4 v4, s[8:11], s70 offen offset:2048 sc1 lds
    buffer_load_dwordx4 v4, s[8:11], s70 offen offset:3072 sc1 lds
    s_add_u32 m0, s72, 4096
    s_add_u32 s70, s70, 4096
    buffer_load_dwordx4 v4, s[8:11], s70 offen offset:0 sc1 lds
    buffer_load_dwordx4 v4, s[8:11], s70 offen offset:1024 sc1 lds
    buffer_load_dwordx4 v4, s[8:11], s70 offen offset:2048 sc1 lds
    buffer_load_dwordx4 v4, s[8:11], s70 offen offset:3072 sc1 lds
L3_ldone:
    s_waitcnt vmcnt(0)
    s_barrier
L3_end:
    s_endpgm
.section .rodata,"a"
.p2align 6
.amdhsa_kernel recurrent_scan__ssm_conv_s5__glu_gated_geglu__prompt_kernel
  .amdhsa_next_free_vgpr 256
  .amdhsa_next_free_sgpr 102
  .amdhsa_accum_offset 256
  .amdhsa_group_segment_fixed_size 0
  .amdhsa_kernarg_size 128
  .amdhsa_user_sgpr_count 2
  .amdhsa_user_sgpr_kernarg_segment_ptr 1
  .amdhsa_system_sgpr_workgroup_id_x 1
.end_amdhsa_kernel
```
